```python
import torch

def _softmax(x, axis=-1):
    return torch.softmax(x, dim=axis)
def _gelu(x):
    return torch.nn.functional.gelu(x, approximate="tanh")
def _silu(x):
    return torch.nn.functional.silu(x)
def _sigmoid(x):
    return torch.sigmoid(x)
def _layernorm(x, axis=-1, eps=1e-5):
    m = x.mean(dim=axis, keepdim=True)
    v = x.var(dim=axis, keepdim=True, unbiased=False)
    return (x - m) / torch.sqrt(v + eps)
def _scatter_add(tgt, idx, src, axis=0):
    return tgt.clone().index_add_(axis, idx, src)
def _segment_sum(src, seg, n):
    out = torch.zeros((n,) + src.shape[1:], dtype=src.dtype)
    return out.index_add_(0, seg, src)
def _pad(x, pw):
    flat = tuple(v for pair in reversed(pw) for v in pair)
    return torch.nn.functional.pad(x, flat)

kernel_name = 'interleave_layers__ssm_conv_h3__dense_activation_relu__prompt'

def setup_inputs():

    _w = (lambda a: (lambda t: t.to(torch.bfloat16) if t.is_floating_point() else t)(torch.as_tensor(a)))
    def _A_setup():
        B, S, D = 1, 2048, 640
        ks = 4
        return {
            "q": _w((lambda *s: torch.randn(*s, dtype=torch.bfloat16) * 0.05)(B, S, D)),
            "k": _w((lambda *s: torch.randn(*s, dtype=torch.bfloat16) * 0.8)(B, S, D)),
            "v": _w((lambda *s: torch.randn(*s, dtype=torch.bfloat16) * 0.8)(B, S, D)),
            "shift_k": _w((lambda *s: torch.randn(*s, dtype=torch.bfloat16) * 0.8)(D, ks) * 0.5),
            "ssm_k": _w((lambda *s: torch.randn(*s, dtype=torch.bfloat16) * 0.8)(D, S) * (1.0 / S ** 0.5)),
            "ssm_D": _w((lambda *s: torch.randn(*s, dtype=torch.bfloat16) * 0.8)(D)),
        }
    _A_in = _A_setup()

    def _B_setup():
        B, S, D, Dff = 1, 2048, 640, 1728
        return {
            "x": _w((lambda *s: torch.randn(*s, dtype=torch.bfloat16) * 0.05)(B, S, D)),
            "w1": _w((lambda *s: torch.randn(*s, dtype=torch.bfloat16) * 0.1)(D, Dff)),
            "w2": _w((lambda *s: torch.randn(*s, dtype=torch.bfloat16) * 0.1)(Dff, D)),
        }
    _B_in = _B_setup()

    return {
        "A_q": _A_in["q"],
        "A_k": _A_in["k"],
        "A_v": _A_in["v"],
        "A_shift_k": _A_in["shift_k"],
        "A_ssm_k": _A_in["ssm_k"],
        "A_ssm_D": _A_in["ssm_D"],
        "B_x": _B_in["x"],
        "B_w1": _B_in["w1"],
        "B_w2": _B_in["w2"],
    }

def reference(A_q, A_k, A_v, A_shift_k, A_ssm_k, A_ssm_D, B_x, B_w1, B_w2):
    def _A_ref(q, k, v, shift_k, ssm_k, ssm_D):
        B, S, D = q.shape
        ks = shift_k.shape[-1]
        k_pad = _pad(k, ((0, 0), (ks - 1, 0), (0, 0)))
        k_shift = torch.zeros_like(k)
        for t in range(ks):
            k_shift = k_shift + k_pad[:, t:t + S, :] * shift_k[:, ks - 1 - t][None, None, :]
        kv = k_shift * v
        L = 2 * S
        kv_pad = _pad(kv, ((0, 0), (0, S), (0, 0)))
        kf_pad = _pad(ssm_k, ((0, 0), (0, S)))
        kv_f = (lambda x, axes=(-2,-1): torch.fft.rfft2(x.float(), dim=axes))(kv_pad[:, None, :, :], axes=(1, 2))
        kf_f = (lambda x, axes=(-2,-1): torch.fft.rfft2(x.float(), dim=axes))(kf_pad[:, None, :], axes=(1, 2))
        kf_f = (lambda x, *d: x.permute(*d))(kf_f, 1, 2, 0)
        y_f = kv_f * kf_f[None, :, :, :]
        y = (lambda x, s, axes=(-2,-1): torch.fft.irfft2(x, s=s, dim=axes).to(torch.bfloat16))(y_f, (1, L), axes=(1, 2))[:, 0, :S, :]
        y = y + kv * ssm_D[None, None, :]
        return q * y

    def _B_ref(x, w1, w2):
        h = torch.einsum("bsd,df->bsf", x, w1)
        zero = torch.zeros_like(h)
        h = torch.maximum(h, zero)
        return torch.einsum("bsf,fd->bsd", h, w2)

    x = A_q
    x = x + _A_ref(_layernorm(x, axis=-1), A_k, A_v, A_shift_k, A_ssm_k, A_ssm_D)
    x = x + _B_ref(_layernorm(x, axis=-1), B_w1, B_w2)
    x = x + _A_ref(_layernorm(x, axis=-1), A_k, A_v, A_shift_k, A_ssm_k, A_ssm_D)
    x = x + _B_ref(_layernorm(x, axis=-1), B_w1, B_w2)
    return x
```

```asm
; @launch grid=(256,1,1) block=(256,1,1) lds=163840
.amdgcn_target "amdgcn-amd-amdhsa--gfx950"
.text
.globl interleave_layers__ssm_conv_h3__dense_activation_relu__prompt_kernel
.p2align 8
.type interleave_layers__ssm_conv_h3__dense_activation_relu__prompt_kernel,@function
interleave_layers__ssm_conv_h3__dense_activation_relu__prompt_kernel:
    s_cmp_ge_u32 s2, 256
    s_cbranch_scc1 L_end
    s_getpc_b64 s[66:67]
L_pcref:
    s_sub_u32 s66, s66, (L_pcref - interleave_layers__ssm_conv_h3__dense_activation_relu__prompt_kernel)
    s_subb_u32 s67, s67, 0
    s_lshr_b32 s3, s2, 3
    s_mul_i32 s3, s3, 20
    v_and_b32 v4, 63, v0
    v_add_u32 v4, s3, v4
    v_min_u32 v4, (L_end - interleave_layers__ssm_conv_h3__dense_activation_relu__prompt_kernel) / 128, v4
    v_lshlrev_b32 v4, 7, v4
    v_cmp_gt_u32 vcc, 20, v0
    s_and_saveexec_b64 s[92:93], vcc
    s_nop 3
    s_cbranch_execz L_cpf_1
    global_load_dword a0, v4, s[66:67]
L_cpf_1:
    s_mov_b64 exec, s[92:93]
    s_load_dwordx16 s[16:31], s[0:1], 0
    s_load_dwordx8 s[32:39], s[0:1], 64
    s_and_b32 s4, s2, 7
    s_lshr_b32 s5, s2, 3
    v_lshrrev_b32 v4, 6, v0
    s_nop 0
    v_readfirstlane_b32 s6, v4
    v_and_b32 v1, 63, v0
    v_and_b32 v2, 15, v0
    v_bfe_u32 v3, v0, 4, 2
    s_getreg_b32 s46, hwreg(HW_REG_XCC_ID, 0, 4)
    s_mov_b32 s45, 0xffff0000
    s_lshr_b32 s40, s5, 3
    s_and_b32 s41, s5, 7
    s_lshr_b32 s42, s5, 4
    s_and_b32 s43, s5, 15
    s_mul_i32 s3, s43, 48070
    s_lshr_b32 s3, s3, 16
    s_mul_i32 s44, s43, 6
    s_add_u32 s44, s44, s3
    s_mov_b32 s7, 0
    s_waitcnt lgkmcnt(0)
    s_load_dword s28, s[38:39], 0
    s_mov_b32 s29, 0x5bd1e995
    s_lshl_b32 s3, s4, 8
    s_add_u32 s64, s38, 4096
    s_addc_u32 s65, s39, 0
    s_add_u32 s64, s64, s3
    s_addc_u32 s65, s65, 0
    v_and_b32 v110, 7, v0
    v_lshrrev_b32 v111, 3, v0
    s_lshl_b32 s3, s5, 6
    s_sub_u32 s3, s3, 3
    v_lshlrev_b32 v112, 1, v111
    v_add_u32 v112, s3, v112
    s_movk_i32 s50, 1280
    v_mul_lo_u32 v112, v112, s50
    s_mul_i32 s3, s4, 160
    v_mul_u32_u24 v113, 20, v110
    v_add3_u32 v112, v112, v113, s3
    s_add_u32 s8, s18, 0
    s_addc_u32 s9, s19, 0
    s_and_b32 s9, s9, 0xffff
    s_mov_b32 s10, 2621440
    s_mov_b32 s11, 0x20000
    s_add_u32 s12, s20, 0
    s_addc_u32 s13, s21, 0
    s_and_b32 s13, s13, 0xffff
    s_mov_b32 s14, 2621440
    s_mov_b32 s15, 0x20000
    v_add_u32 v114, 1280, v112
    v_add_u32 v115, 2560, v112
    v_add_u32 v116, 3840, v112
    v_add_u32 v117, 5120, v112
    buffer_load_dwordx4 v[4:7], v112, s[8:11], 0 offen
    buffer_load_dword v8, v112, s[8:11], 0 offen offset:16
    buffer_load_dwordx4 v[10:13], v114, s[8:11], 0 offen
    buffer_load_dword v14, v114, s[8:11], 0 offen offset:16
    buffer_load_dwordx4 v[16:19], v115, s[8:11], 0 offen
    buffer_load_dword v20, v115, s[8:11], 0 offen offset:16
    buffer_load_dwordx4 v[22:25], v116, s[8:11], 0 offen
    buffer_load_dword v26, v116, s[8:11], 0 offen offset:16
    buffer_load_dwordx4 v[28:31], v117, s[8:11], 0 offen
    buffer_load_dword v32, v117, s[8:11], 0 offen offset:16
    buffer_load_dwordx4 v[34:37], v116, s[12:15], 0 offen
    buffer_load_dword v38, v116, s[12:15], 0 offen offset:16
    buffer_load_dwordx4 v[40:43], v117, s[12:15], 0 offen
    buffer_load_dword v44, v117, s[12:15], 0 offen offset:16
    s_mul_i32 s3, s4, 640
    v_mul_u32_u24 v119, 80, v110
    v_add_u32 v119, s3, v119
    global_load_dwordx4 v[46:49], v119, s[22:23] offset:0
    global_load_dwordx4 v[50:53], v119, s[22:23] offset:16
    global_load_dwordx4 v[54:57], v119, s[22:23] offset:32
    global_load_dwordx4 v[58:61], v119, s[22:23] offset:48
    global_load_dwordx4 v[62:65], v119, s[22:23] offset:64
    s_lshl_b32 s3, s6, 5
    s_add_u32 s3, s3, s5
    s_cmp_lt_u32 s3, 80
    s_cselect_b32 s48, 1, 0
    s_cselect_b32 s3, s3, 0
    s_mul_i32 s47, s4, 80
    s_add_u32 s47, s47, s3
    s_mul_i32 s70, s6, 37888
    s_cmp_lt_u32 s6, 3
    s_cselect_b32 s70, s70, 0
    s_lshl_b32 s3, s47, 1
    s_and_b32 s3, s3, 0xfffffffc
    s_load_dword s49, s[26:27], s3
    s_lshl_b32 s3, s47, 12
    s_add_u32 s52, s24, 0
    s_addc_u32 s53, s25, 0
    s_add_u32 s52, s52, s3
    s_addc_u32 s53, s53, 0
    s_and_b32 s53, s53, 0xffff
    s_mov_b32 s54, 4096
    s_mov_b32 s55, 0x20000
    s_cmp_eq_u32 s6, 3
    s_cbranch_scc1 L_iw_2
    v_lshlrev_b32 v122, 4, v1
    v_add_u32 v123, 4294967280, v122
    buffer_load_dwordx4 v[66:69], v123, s[52:55], 0 offen
    buffer_load_dwordx4 v[70:73], v122, s[52:55], 0 offen offset:0
    v_add_u32 v123, 1008, v122
    buffer_load_dwordx4 v[74:77], v123, s[52:55], 0 offen
    buffer_load_dwordx4 v[78:81], v122, s[52:55], 0 offen offset:1024
    v_add_u32 v123, 2032, v122
    buffer_load_dwordx4 v[82:85], v123, s[52:55], 0 offen
    buffer_load_dwordx4 v[86:89], v122, s[52:55], 0 offen offset:2048
    v_add_u32 v123, 3056, v122
    buffer_load_dwordx4 v[90:93], v123, s[52:55], 0 offen
    buffer_load_dwordx4 v[94:97], v122, s[52:55], 0 offen offset:3072
L_iw_2:
    s_cmp_ge_u32 s6, 2
    s_cbranch_scc1 L_pt_3
    s_lshl_b32 s3, s6, 6
    v_add_u32 v122, s3, v1
    v_min_u32 v122, 79, v122
    v_lshlrev_b32 v122, 12, v122
    s_mul_i32 s3, s4, 327680
    s_sub_u32 s50, 31, s5
    s_lshl_b32 s50, s50, 7
    s_add_u32 s3, s3, s50
    s_add_u32 s3, s3, 2097152
    v_add_u32 v122, s3, v122
    global_load_dword a0, v122, s[38:39]
    s_nop 0
    s_branch L_ptd_4
L_pt_3:
    v_and_b32 v122, 1, v1
    v_lshlrev_b32 v122, 7, v122
    global_load_dword a0, v122, s[64:65]
    s_nop 0
L_ptd_4:
    s_cmp_lg_u32 s6, 3
    s_cbranch_scc1 L_iw_5
    v_lshrrev_b32 v100, 3, v1
    v_and_b32 v101, 7, v1
    v_lshlrev_b32 v101, 4, v101
    v_mul_u32_u24 v103, 1280, v100
    v_add_u32 v103, v103, v101
    s_add_u32 s53, s2, 0
    s_mul_hi_u32 s50, s53, 429496730
    s_mul_i32 s51, s50, 10
    s_sub_u32 s51, s53, s51
    s_mul_i32 s3, s50, 40960
    s_lshl_b32 s52, s51, 7
    s_add_u32 s3, s3, s52
    s_add_u32 s66, s32, 0
    s_addc_u32 s67, s33, 0
    s_add_u32 s66, s66, s3
    s_addc_u32 s67, s67, 0
    s_mul_i32 s3, s50, 40
    s_lshl_b32 s51, s51, 2
    s_add_u32 s3, s3, s51
    s_lshl_b32 s3, s3, 10
    s_add_u32 s74, s3, 11534336
    v_mov_b32 v102, v103
    s_mov_b32 m0, 125184
    s_nop 0
    global_load_lds_dwordx4 v102, s[66:67] nt
    s_mov_b32 m0, 126208
    v_add_u32 v102, 10240, v102
    global_load_lds_dwordx4 v102, s[66:67] nt
    s_mov_b32 m0, 127232
    v_add_u32 v102, 10240, v102
    global_load_lds_dwordx4 v102, s[66:67] nt
    s_mov_b32 m0, 128256
    v_add_u32 v102, 10240, v102
    global_load_lds_dwordx4 v102, s[66:67] nt
    s_add_u32 s53, s2, 256
    s_mul_hi_u32 s50, s53, 429496730
    s_mul_i32 s51, s50, 10
    s_sub_u32 s51, s53, s51
    s_mul_i32 s3, s50, 40960
    s_lshl_b32 s52, s51, 7
    s_add_u32 s3, s3, s52
    s_add_u32 s66, s32, 0
    s_addc_u32 s67, s33, 0
    s_add_u32 s66, s66, s3
    s_addc_u32 s67, s67, 0
    s_mul_i32 s3, s50, 40
    s_lshl_b32 s51, s51, 2
    s_add_u32 s3, s3, s51
    s_lshl_b32 s3, s3, 10
    s_add_u32 s75, s3, 11534336
    v_mov_b32 v102, v103
    s_mov_b32 m0, 129280
    s_nop 0
    global_load_lds_dwordx4 v102, s[66:67] nt
    s_mov_b32 m0, 130304
    v_add_u32 v102, 10240, v102
    global_load_lds_dwordx4 v102, s[66:67] nt
    s_mov_b32 m0, 131328
    v_add_u32 v102, 10240, v102
    global_load_lds_dwordx4 v102, s[66:67] nt
    s_mov_b32 m0, 132352
    v_add_u32 v102, 10240, v102
    global_load_lds_dwordx4 v102, s[66:67] nt
    s_cmp_ge_u32 s2, 28
    s_cbranch_scc1 L_rp3_6
    s_add_u32 s53, s2, 512
    s_mul_hi_u32 s50, s53, 429496730
    s_mul_i32 s51, s50, 10
    s_sub_u32 s51, s53, s51
    s_mul_i32 s3, s50, 40960
    s_lshl_b32 s52, s51, 7
    s_add_u32 s3, s3, s52
    s_add_u32 s66, s32, 0
    s_addc_u32 s67, s33, 0
    s_add_u32 s66, s66, s3
    s_addc_u32 s67, s67, 0
    s_mul_i32 s3, s50, 40
    s_lshl_b32 s51, s51, 2
    s_add_u32 s3, s3, s51
    s_lshl_b32 s3, s3, 10
    s_add_u32 s76, s3, 11534336
    v_mov_b32 v102, v103
    s_mov_b32 m0, 133376
    s_nop 0
    global_load_lds_dwordx4 v102, s[66:67] nt
    s_mov_b32 m0, 134400
    v_add_u32 v102, 10240, v102
    global_load_lds_dwordx4 v102, s[66:67] nt
    s_mov_b32 m0, 135424
    v_add_u32 v102, 10240, v102
    global_load_lds_dwordx4 v102, s[66:67] nt
    s_mov_b32 m0, 136448
    v_add_u32 v102, 10240, v102
    global_load_lds_dwordx4 v102, s[66:67] nt
    s_nop 0
L_rp3_6:
    s_lshl_b32 s3, s4, 8
    s_lshl_b32 s50, s40, 6
    s_add_u32 s3, s3, s50
    s_mul_i32 s3, s3, 1280
    s_mul_i32 s50, s41, 160
    s_add_u32 s3, s3, s50
    s_add_u32 s66, s16, 0
    s_addc_u32 s67, s17, 0
    s_add_u32 s66, s66, s3
    s_addc_u32 s67, s67, 0
    s_mov_b32 s50, 429496730
    v_add_u32 v102, 0, v1
    v_mul_hi_u32 v100, v102, s50
    v_mul_u32_u24 v101, 10, v100
    v_sub_u32 v101, v102, v101
    v_mul_u32_u24 v100, 1280, v100
    v_lshl_add_u32 v102, v101, 4, v100
    s_mov_b32 m0, 137472
    s_nop 0
    global_load_lds_dwordx4 v102, s[66:67]
    v_add_u32 v102, 64, v1
    v_mul_hi_u32 v100, v102, s50
    v_mul_u32_u24 v101, 10, v100
    v_sub_u32 v101, v102, v101
    v_mul_u32_u24 v100, 1280, v100
    v_lshl_add_u32 v102, v101, 4, v100
    s_mov_b32 m0, 138496
    s_nop 0
    global_load_lds_dwordx4 v102, s[66:67]
    v_add_u32 v102, 128, v1
    v_mul_hi_u32 v100, v102, s50
    v_mul_u32_u24 v101, 10, v100
    v_sub_u32 v101, v102, v101
    v_mul_u32_u24 v100, 1280, v100
    v_lshl_add_u32 v102, v101, 4, v100
    s_mov_b32 m0, 139520
    s_nop 0
    global_load_lds_dwordx4 v102, s[66:67]
    v_add_u32 v102, 192, v1
    v_mul_hi_u32 v100, v102, s50
    v_mul_u32_u24 v101, 10, v100
    v_sub_u32 v101, v102, v101
    v_mul_u32_u24 v100, 1280, v100
    v_lshl_add_u32 v102, v101, 4, v100
    s_mov_b32 m0, 140544
    s_nop 0
    global_load_lds_dwordx4 v102, s[66:67]
    v_add_u32 v102, 256, v1
    v_mul_hi_u32 v100, v102, s50
    v_mul_u32_u24 v101, 10, v100
    v_sub_u32 v101, v102, v101
    v_mul_u32_u24 v100, 1280, v100
    v_lshl_add_u32 v102, v101, 4, v100
    s_mov_b32 m0, 141568
    s_nop 0
    global_load_lds_dwordx4 v102, s[66:67]
    v_add_u32 v102, 320, v1
    v_mul_hi_u32 v100, v102, s50
    v_mul_u32_u24 v101, 10, v100
    v_sub_u32 v101, v102, v101
    v_mul_u32_u24 v100, 1280, v100
    v_lshl_add_u32 v102, v101, 4, v100
    s_mov_b32 m0, 142592
    s_nop 0
    global_load_lds_dwordx4 v102, s[66:67]
    v_add_u32 v102, 384, v1
    v_mul_hi_u32 v100, v102, s50
    v_mul_u32_u24 v101, 10, v100
    v_sub_u32 v101, v102, v101
    v_mul_u32_u24 v100, 1280, v100
    v_lshl_add_u32 v102, v101, 4, v100
    s_mov_b32 m0, 143616
    s_nop 0
    global_load_lds_dwordx4 v102, s[66:67]
    v_add_u32 v102, 448, v1
    v_mul_hi_u32 v100, v102, s50
    v_mul_u32_u24 v101, 10, v100
    v_sub_u32 v101, v102, v101
    v_mul_u32_u24 v100, 1280, v100
    v_lshl_add_u32 v102, v101, 4, v100
    s_mov_b32 m0, 144640
    s_nop 0
    global_load_lds_dwordx4 v102, s[66:67]
    v_add_u32 v102, 512, v1
    v_mul_hi_u32 v100, v102, s50
    v_mul_u32_u24 v101, 10, v100
    v_sub_u32 v101, v102, v101
    v_mul_u32_u24 v100, 1280, v100
    v_lshl_add_u32 v102, v101, 4, v100
    s_mov_b32 m0, 145664
    s_nop 0
    global_load_lds_dwordx4 v102, s[66:67]
    v_add_u32 v102, 576, v1
    v_mul_hi_u32 v100, v102, s50
    v_mul_u32_u24 v101, 10, v100
    v_sub_u32 v101, v102, v101
    v_mul_u32_u24 v100, 1280, v100
    v_lshl_add_u32 v102, v101, 4, v100
    s_mov_b32 m0, 146688
    s_nop 0
    global_load_lds_dwordx4 v102, s[66:67]
L_iw_5:
    s_waitcnt lgkmcnt(0)
    s_add_u32 s28, s28, 0x9e3779b9
    s_cmp_lg_u32 s6, 0
    s_cbranch_scc1 L_iw_7
    s_lshl_b32 s50, s4, 8
    s_lshl_b32 s51, s5, 3
    s_add_u32 s50, s50, s51
    s_add_u32 s50, s50, 1024
    s_add_u32 s3, s28, s46
    v_mov_b32 v176, s3
    s_xor_b32 s3, s3, s29
    v_mov_b32 v177, s3
    v_mov_b32 v178, s50
    s_mov_b64 s[92:93], exec
    s_mov_b64 exec, 1
    global_store_dwordx2 v178, v[176:177], s[38:39] sc0 sc1
    s_mov_b64 exec, s[92:93]
L_iw_7:
    v_and_b32 v158, 7, v0
    v_mul_u32_u24 v158, 1440, v158
    v_lshrrev_b32 v159, 3, v0
    v_lshlrev_b32 v159, 2, v159
    v_sub_u32 v158, v158, v159
    v_add_u32 v158, 113788, v158
    s_cmp_eq_u32 s6, 3
    s_nop 0
    s_cbranch_scc1 L_w3_8
    s_waitcnt vmcnt(8)
    s_branch L_w3d_9
L_w3_8:
    s_waitcnt vmcnt(18)
L_w3d_9:
    s_lshl_b32 s3, s4, 8
    s_add_u32 s68, s38, 1024
    s_addc_u32 s69, s39, 0
    s_add_u32 s68, s68, s3
    s_addc_u32 s69, s69, 0
    v_and_b32 v180, 31, v1
    v_lshlrev_b32 v180, 3, v180
    v_lshlrev_b32 v124, 16, v4
    v_and_b32 v125, s45, v4
    v_lshlrev_b32 v126, 16, v10
    v_and_b32 v127, s45, v10
    v_lshlrev_b32 v128, 16, v16
    v_and_b32 v129, s45, v16
    v_lshlrev_b32 v130, 16, v22
    v_and_b32 v131, s45, v22
    v_lshlrev_b32 v132, 16, v28
    v_and_b32 v133, s45, v28
    v_lshlrev_b32 v134, 16, v46
    v_lshlrev_b32 v135, 16, v48
    v_and_b32 v136, s45, v46
    v_and_b32 v137, s45, v48
    v_lshlrev_b32 v138, 16, v47
    v_lshlrev_b32 v139, 16, v49
    v_and_b32 v140, s45, v47
    v_and_b32 v141, s45, v49
    v_lshlrev_b32 v142, 16, v34
    v_and_b32 v143, s45, v34
    v_lshlrev_b32 v144, 16, v40
    v_and_b32 v145, s45, v40
    v_pk_mul_f32 v[146:147], v[124:125], v[140:141]
    v_pk_mul_f32 v[148:149], v[126:127], v[140:141]
    v_cvt_pk_bf16_f32 v154, v146, v147
    v_lshlrev_b32 v146, 16, v154
    v_and_b32 v147, s45, v154
    v_cvt_pk_bf16_f32 v155, v148, v149
    v_lshlrev_b32 v148, 16, v155
    v_and_b32 v149, s45, v155
    v_pk_mul_f32 v[150:151], v[126:127], v[138:139]
    v_pk_mul_f32 v[152:153], v[128:129], v[138:139]
    v_cvt_pk_bf16_f32 v154, v150, v151
    v_lshlrev_b32 v150, 16, v154
    v_and_b32 v151, s45, v154
    v_cvt_pk_bf16_f32 v155, v152, v153
    v_lshlrev_b32 v152, 16, v155
    v_and_b32 v153, s45, v155
    v_pk_add_f32 v[146:147], v[146:147], v[150:151]
    v_pk_add_f32 v[148:149], v[148:149], v[152:153]
    v_cvt_pk_bf16_f32 v154, v146, v147
    v_lshlrev_b32 v146, 16, v154
    v_and_b32 v147, s45, v154
    v_cvt_pk_bf16_f32 v155, v148, v149
    v_lshlrev_b32 v148, 16, v155
    v_and_b32 v149, s45, v155
    v_pk_mul_f32 v[150:151], v[128:129], v[136:137]
    v_pk_mul_f32 v[152:153], v[130:131], v[136:137]
    v_cvt_pk_bf16_f32 v154, v150, v151
    v_lshlrev_b32 v150, 16, v154
    v_and_b32 v151, s45, v154
    v_cvt_pk_bf16_f32 v155, v152, v153
    v_lshlrev_b32 v152, 16, v155
    v_and_b32 v153, s45, v155
    v_pk_add_f32 v[146:147], v[146:147], v[150:151]
    v_pk_add_f32 v[148:149], v[148:149], v[152:153]
    v_cvt_pk_bf16_f32 v154, v146, v147
    v_lshlrev_b32 v146, 16, v154
    v_and_b32 v147, s45, v154
    v_cvt_pk_bf16_f32 v155, v148, v149
    v_lshlrev_b32 v148, 16, v155
    v_and_b32 v149, s45, v155
    v_pk_mul_f32 v[150:151], v[130:131], v[134:135]
    v_pk_mul_f32 v[152:153], v[132:133], v[134:135]
    v_cvt_pk_bf16_f32 v154, v150, v151
    v_lshlrev_b32 v150, 16, v154
    v_and_b32 v151, s45, v154
    v_cvt_pk_bf16_f32 v155, v152, v153
    v_lshlrev_b32 v152, 16, v155
    v_and_b32 v153, s45, v155
    v_pk_add_f32 v[146:147], v[146:147], v[150:151]
    v_pk_add_f32 v[148:149], v[148:149], v[152:153]
    v_cvt_pk_bf16_f32 v154, v146, v147
    v_lshlrev_b32 v146, 16, v154
    v_and_b32 v147, s45, v154
    v_cvt_pk_bf16_f32 v155, v148, v149
    v_lshlrev_b32 v148, 16, v155
    v_and_b32 v149, s45, v155
    v_pk_mul_f32 v[146:147], v[146:147], v[142:143]
    v_pk_mul_f32 v[148:149], v[148:149], v[144:145]
    v_cvt_pk_bf16_f32 v156, v148, v146
    v_cvt_pk_bf16_f32 v157, v149, v147
    ds_write_b32 v158, v156 offset:0
    ds_write_b32 v158, v157 offset:144
    v_lshlrev_b32 v124, 16, v5
    v_and_b32 v125, s45, v5
    v_lshlrev_b32 v126, 16, v11
    v_and_b32 v127, s45, v11
    v_lshlrev_b32 v128, 16, v17
    v_and_b32 v129, s45, v17
    v_lshlrev_b32 v130, 16, v23
    v_and_b32 v131, s45, v23
    v_lshlrev_b32 v132, 16, v29
    v_and_b32 v133, s45, v29
    v_lshlrev_b32 v134, 16, v50
    v_lshlrev_b32 v135, 16, v52
    v_and_b32 v136, s45, v50
    v_and_b32 v137, s45, v52
    v_lshlrev_b32 v138, 16, v51
    v_lshlrev_b32 v139, 16, v53
    v_and_b32 v140, s45, v51
    v_and_b32 v141, s45, v53
    v_lshlrev_b32 v142, 16, v35
    v_and_b32 v143, s45, v35
    v_lshlrev_b32 v144, 16, v41
    v_and_b32 v145, s45, v41
    v_pk_mul_f32 v[146:147], v[124:125], v[140:141]
    v_pk_mul_f32 v[148:149], v[126:127], v[140:141]
    v_cvt_pk_bf16_f32 v154, v146, v147
    v_lshlrev_b32 v146, 16, v154
    v_and_b32 v147, s45, v154
    v_cvt_pk_bf16_f32 v155, v148, v149
    v_lshlrev_b32 v148, 16, v155
    v_and_b32 v149, s45, v155
    v_pk_mul_f32 v[150:151], v[126:127], v[138:139]
    v_pk_mul_f32 v[152:153], v[128:129], v[138:139]
    v_cvt_pk_bf16_f32 v154, v150, v151
    v_lshlrev_b32 v150, 16, v154
    v_and_b32 v151, s45, v154
    v_cvt_pk_bf16_f32 v155, v152, v153
    v_lshlrev_b32 v152, 16, v155
    v_and_b32 v153, s45, v155
    v_pk_add_f32 v[146:147], v[146:147], v[150:151]
    v_pk_add_f32 v[148:149], v[148:149], v[152:153]
    v_cvt_pk_bf16_f32 v154, v146, v147
    v_lshlrev_b32 v146, 16, v154
    v_and_b32 v147, s45, v154
    v_cvt_pk_bf16_f32 v155, v148, v149
    v_lshlrev_b32 v148, 16, v155
    v_and_b32 v149, s45, v155
    v_pk_mul_f32 v[150:151], v[128:129], v[136:137]
    v_pk_mul_f32 v[152:153], v[130:131], v[136:137]
    v_cvt_pk_bf16_f32 v154, v150, v151
    v_lshlrev_b32 v150, 16, v154
    v_and_b32 v151, s45, v154
    v_cvt_pk_bf16_f32 v155, v152, v153
    v_lshlrev_b32 v152, 16, v155
    v_and_b32 v153, s45, v155
    v_pk_add_f32 v[146:147], v[146:147], v[150:151]
    v_pk_add_f32 v[148:149], v[148:149], v[152:153]
    v_cvt_pk_bf16_f32 v154, v146, v147
    v_lshlrev_b32 v146, 16, v154
    v_and_b32 v147, s45, v154
    v_cvt_pk_bf16_f32 v155, v148, v149
    v_lshlrev_b32 v148, 16, v155
    v_and_b32 v149, s45, v155
    v_pk_mul_f32 v[150:151], v[130:131], v[134:135]
    v_pk_mul_f32 v[152:153], v[132:133], v[134:135]
    v_cvt_pk_bf16_f32 v154, v150, v151
    v_lshlrev_b32 v150, 16, v154
    v_and_b32 v151, s45, v154
    v_cvt_pk_bf16_f32 v155, v152, v153
    v_lshlrev_b32 v152, 16, v155
    v_and_b32 v153, s45, v155
    v_pk_add_f32 v[146:147], v[146:147], v[150:151]
    v_pk_add_f32 v[148:149], v[148:149], v[152:153]
    v_cvt_pk_bf16_f32 v154, v146, v147
    v_lshlrev_b32 v146, 16, v154
    v_and_b32 v147, s45, v154
    v_cvt_pk_bf16_f32 v155, v148, v149
    v_lshlrev_b32 v148, 16, v155
    v_and_b32 v149, s45, v155
    v_pk_mul_f32 v[146:147], v[146:147], v[142:143]
    v_pk_mul_f32 v[148:149], v[148:149], v[144:145]
    v_cvt_pk_bf16_f32 v156, v148, v146
    v_cvt_pk_bf16_f32 v157, v149, v147
    ds_write_b32 v158, v156 offset:288
    ds_write_b32 v158, v157 offset:432
    v_lshlrev_b32 v124, 16, v6
    v_and_b32 v125, s45, v6
    v_lshlrev_b32 v126, 16, v12
    v_and_b32 v127, s45, v12
    v_lshlrev_b32 v128, 16, v18
    v_and_b32 v129, s45, v18
    v_lshlrev_b32 v130, 16, v24
    v_and_b32 v131, s45, v24
    v_lshlrev_b32 v132, 16, v30
    v_and_b32 v133, s45, v30
    v_lshlrev_b32 v134, 16, v54
    v_lshlrev_b32 v135, 16, v56
    v_and_b32 v136, s45, v54
    v_and_b32 v137, s45, v56
    v_lshlrev_b32 v138, 16, v55
    v_lshlrev_b32 v139, 16, v57
    v_and_b32 v140, s45, v55
    v_and_b32 v141, s45, v57
    v_lshlrev_b32 v142, 16, v36
    v_and_b32 v143, s45, v36
    v_lshlrev_b32 v144, 16, v42
    v_and_b32 v145, s45, v42
    v_pk_mul_f32 v[146:147], v[124:125], v[140:141]
    v_pk_mul_f32 v[148:149], v[126:127], v[140:141]
    v_cvt_pk_bf16_f32 v154, v146, v147
    v_lshlrev_b32 v146, 16, v154
    v_and_b32 v147, s45, v154
    v_cvt_pk_bf16_f32 v155, v148, v149
    v_lshlrev_b32 v148, 16, v155
    v_and_b32 v149, s45, v155
    v_pk_mul_f32 v[150:151], v[126:127], v[138:139]
    v_pk_mul_f32 v[152:153], v[128:129], v[138:139]
    v_cvt_pk_bf16_f32 v154, v150, v151
    v_lshlrev_b32 v150, 16, v154
    v_and_b32 v151, s45, v154
    v_cvt_pk_bf16_f32 v155, v152, v153
    v_lshlrev_b32 v152, 16, v155
    v_and_b32 v153, s45, v155
    v_pk_add_f32 v[146:147], v[146:147], v[150:151]
    v_pk_add_f32 v[148:149], v[148:149], v[152:153]
    v_cvt_pk_bf16_f32 v154, v146, v147
    v_lshlrev_b32 v146, 16, v154
    v_and_b32 v147, s45, v154
    v_cvt_pk_bf16_f32 v155, v148, v149
    v_lshlrev_b32 v148, 16, v155
    v_and_b32 v149, s45, v155
    v_pk_mul_f32 v[150:151], v[128:129], v[136:137]
    v_pk_mul_f32 v[152:153], v[130:131], v[136:137]
    v_cvt_pk_bf16_f32 v154, v150, v151
    v_lshlrev_b32 v150, 16, v154
    v_and_b32 v151, s45, v154
    v_cvt_pk_bf16_f32 v155, v152, v153
    v_lshlrev_b32 v152, 16, v155
    v_and_b32 v153, s45, v155
    v_pk_add_f32 v[146:147], v[146:147], v[150:151]
    v_pk_add_f32 v[148:149], v[148:149], v[152:153]
    v_cvt_pk_bf16_f32 v154, v146, v147
    v_lshlrev_b32 v146, 16, v154
    v_and_b32 v147, s45, v154
    v_cvt_pk_bf16_f32 v155, v148, v149
    v_lshlrev_b32 v148, 16, v155
    v_and_b32 v149, s45, v155
    v_pk_mul_f32 v[150:151], v[130:131], v[134:135]
    v_pk_mul_f32 v[152:153], v[132:133], v[134:135]
    v_cvt_pk_bf16_f32 v154, v150, v151
    v_lshlrev_b32 v150, 16, v154
    v_and_b32 v151, s45, v154
    v_cvt_pk_bf16_f32 v155, v152, v153
    v_lshlrev_b32 v152, 16, v155
    v_and_b32 v153, s45, v155
    v_pk_add_f32 v[146:147], v[146:147], v[150:151]
    v_pk_add_f32 v[148:149], v[148:149], v[152:153]
    v_cvt_pk_bf16_f32 v154, v146, v147
    v_lshlrev_b32 v146, 16, v154
    v_and_b32 v147, s45, v154
    v_cvt_pk_bf16_f32 v155, v148, v149
    v_lshlrev_b32 v148, 16, v155
    v_and_b32 v149, s45, v155
    v_pk_mul_f32 v[146:147], v[146:147], v[142:143]
    v_pk_mul_f32 v[148:149], v[148:149], v[144:145]
    v_cvt_pk_bf16_f32 v156, v148, v146
    v_cvt_pk_bf16_f32 v157, v149, v147
    ds_write_b32 v158, v156 offset:576
    ds_write_b32 v158, v157 offset:720
    v_lshlrev_b32 v124, 16, v7
    v_and_b32 v125, s45, v7
    v_lshlrev_b32 v126, 16, v13
    v_and_b32 v127, s45, v13
    v_lshlrev_b32 v128, 16, v19
    v_and_b32 v129, s45, v19
    v_lshlrev_b32 v130, 16, v25
    v_and_b32 v131, s45, v25
    v_lshlrev_b32 v132, 16, v31
    v_and_b32 v133, s45, v31
    v_lshlrev_b32 v134, 16, v58
    v_lshlrev_b32 v135, 16, v60
    v_and_b32 v136, s45, v58
    v_and_b32 v137, s45, v60
    v_lshlrev_b32 v138, 16, v59
    v_lshlrev_b32 v139, 16, v61
    v_and_b32 v140, s45, v59
    v_and_b32 v141, s45, v61
    v_lshlrev_b32 v142, 16, v37
    v_and_b32 v143, s45, v37
    v_lshlrev_b32 v144, 16, v43
    v_and_b32 v145, s45, v43
    v_pk_mul_f32 v[146:147], v[124:125], v[140:141]
    v_pk_mul_f32 v[148:149], v[126:127], v[140:141]
    v_cvt_pk_bf16_f32 v154, v146, v147
    v_lshlrev_b32 v146, 16, v154
    v_and_b32 v147, s45, v154
    v_cvt_pk_bf16_f32 v155, v148, v149
    v_lshlrev_b32 v148, 16, v155
    v_and_b32 v149, s45, v155
    v_pk_mul_f32 v[150:151], v[126:127], v[138:139]
    v_pk_mul_f32 v[152:153], v[128:129], v[138:139]
    v_cvt_pk_bf16_f32 v154, v150, v151
    v_lshlrev_b32 v150, 16, v154
    v_and_b32 v151, s45, v154
    v_cvt_pk_bf16_f32 v155, v152, v153
    v_lshlrev_b32 v152, 16, v155
    v_and_b32 v153, s45, v155
    v_pk_add_f32 v[146:147], v[146:147], v[150:151]
    v_pk_add_f32 v[148:149], v[148:149], v[152:153]
    v_cvt_pk_bf16_f32 v154, v146, v147
    v_lshlrev_b32 v146, 16, v154
    v_and_b32 v147, s45, v154
    v_cvt_pk_bf16_f32 v155, v148, v149
    v_lshlrev_b32 v148, 16, v155
    v_and_b32 v149, s45, v155
    v_pk_mul_f32 v[150:151], v[128:129], v[136:137]
    v_pk_mul_f32 v[152:153], v[130:131], v[136:137]
    v_cvt_pk_bf16_f32 v154, v150, v151
    v_lshlrev_b32 v150, 16, v154
    v_and_b32 v151, s45, v154
    v_cvt_pk_bf16_f32 v155, v152, v153
    v_lshlrev_b32 v152, 16, v155
    v_and_b32 v153, s45, v155
    v_pk_add_f32 v[146:147], v[146:147], v[150:151]
    v_pk_add_f32 v[148:149], v[148:149], v[152:153]
    v_cvt_pk_bf16_f32 v154, v146, v147
    v_lshlrev_b32 v146, 16, v154
    v_and_b32 v147, s45, v154
    v_cvt_pk_bf16_f32 v155, v148, v149
    v_lshlrev_b32 v148, 16, v155
    v_and_b32 v149, s45, v155
    v_pk_mul_f32 v[150:151], v[130:131], v[134:135]
    v_pk_mul_f32 v[152:153], v[132:133], v[134:135]
    v_cvt_pk_bf16_f32 v154, v150, v151
    v_lshlrev_b32 v150, 16, v154
    v_and_b32 v151, s45, v154
    v_cvt_pk_bf16_f32 v155, v152, v153
    v_lshlrev_b32 v152, 16, v155
    v_and_b32 v153, s45, v155
    v_pk_add_f32 v[146:147], v[146:147], v[150:151]
    v_pk_add_f32 v[148:149], v[148:149], v[152:153]
    v_cvt_pk_bf16_f32 v154, v146, v147
    v_lshlrev_b32 v146, 16, v154
    v_and_b32 v147, s45, v154
    v_cvt_pk_bf16_f32 v155, v148, v149
    v_lshlrev_b32 v148, 16, v155
    v_and_b32 v149, s45, v155
    v_pk_mul_f32 v[146:147], v[146:147], v[142:143]
    v_pk_mul_f32 v[148:149], v[148:149], v[144:145]
    v_cvt_pk_bf16_f32 v156, v148, v146
    v_cvt_pk_bf16_f32 v157, v149, v147
    ds_write_b32 v158, v156 offset:864
    ds_write_b32 v158, v157 offset:1008
    v_lshlrev_b32 v124, 16, v8
    v_and_b32 v125, s45, v8
    v_lshlrev_b32 v126, 16, v14
    v_and_b32 v127, s45, v14
    v_lshlrev_b32 v128, 16, v20
    v_and_b32 v129, s45, v20
    v_lshlrev_b32 v130, 16, v26
    v_and_b32 v131, s45, v26
    v_lshlrev_b32 v132, 16, v32
    v_and_b32 v133, s45, v32
    v_lshlrev_b32 v134, 16, v62
    v_lshlrev_b32 v135, 16, v64
    v_and_b32 v136, s45, v62
    v_and_b32 v137, s45, v64
    v_lshlrev_b32 v138, 16, v63
    v_lshlrev_b32 v139, 16, v65
    v_and_b32 v140, s45, v63
    v_and_b32 v141, s45, v65
    v_lshlrev_b32 v142, 16, v38
    v_and_b32 v143, s45, v38
    v_lshlrev_b32 v144, 16, v44
    v_and_b32 v145, s45, v44
    v_pk_mul_f32 v[146:147], v[124:125], v[140:141]
    v_pk_mul_f32 v[148:149], v[126:127], v[140:141]
    v_cvt_pk_bf16_f32 v154, v146, v147
    v_lshlrev_b32 v146, 16, v154
    v_and_b32 v147, s45, v154
    v_cvt_pk_bf16_f32 v155, v148, v149
    v_lshlrev_b32 v148, 16, v155
    v_and_b32 v149, s45, v155
    v_pk_mul_f32 v[150:151], v[126:127], v[138:139]
    v_pk_mul_f32 v[152:153], v[128:129], v[138:139]
    v_cvt_pk_bf16_f32 v154, v150, v151
    v_lshlrev_b32 v150, 16, v154
    v_and_b32 v151, s45, v154
    v_cvt_pk_bf16_f32 v155, v152, v153
    v_lshlrev_b32 v152, 16, v155
    v_and_b32 v153, s45, v155
    v_pk_add_f32 v[146:147], v[146:147], v[150:151]
    v_pk_add_f32 v[148:149], v[148:149], v[152:153]
    v_cvt_pk_bf16_f32 v154, v146, v147
    v_lshlrev_b32 v146, 16, v154
    v_and_b32 v147, s45, v154
    v_cvt_pk_bf16_f32 v155, v148, v149
    v_lshlrev_b32 v148, 16, v155
    v_and_b32 v149, s45, v155
    v_pk_mul_f32 v[150:151], v[128:129], v[136:137]
    v_pk_mul_f32 v[152:153], v[130:131], v[136:137]
    v_cvt_pk_bf16_f32 v154, v150, v151
    v_lshlrev_b32 v150, 16, v154
    v_and_b32 v151, s45, v154
    v_cvt_pk_bf16_f32 v155, v152, v153
    v_lshlrev_b32 v152, 16, v155
    v_and_b32 v153, s45, v155
    v_pk_add_f32 v[146:147], v[146:147], v[150:151]
    v_pk_add_f32 v[148:149], v[148:149], v[152:153]
    v_cvt_pk_bf16_f32 v154, v146, v147
    v_lshlrev_b32 v146, 16, v154
    v_and_b32 v147, s45, v154
    v_cvt_pk_bf16_f32 v155, v148, v149
    v_lshlrev_b32 v148, 16, v155
    v_and_b32 v149, s45, v155
    v_pk_mul_f32 v[150:151], v[130:131], v[134:135]
    v_pk_mul_f32 v[152:153], v[132:133], v[134:135]
    v_cvt_pk_bf16_f32 v154, v150, v151
    v_lshlrev_b32 v150, 16, v154
    v_and_b32 v151, s45, v154
    v_cvt_pk_bf16_f32 v155, v152, v153
    v_lshlrev_b32 v152, 16, v155
    v_and_b32 v153, s45, v155
    v_pk_add_f32 v[146:147], v[146:147], v[150:151]
    v_pk_add_f32 v[148:149], v[148:149], v[152:153]
    v_cvt_pk_bf16_f32 v154, v146, v147
    v_lshlrev_b32 v146, 16, v154
    v_and_b32 v147, s45, v154
    v_cvt_pk_bf16_f32 v155, v148, v149
    v_lshlrev_b32 v148, 16, v155
    v_and_b32 v149, s45, v155
    v_pk_mul_f32 v[146:147], v[146:147], v[142:143]
    v_pk_mul_f32 v[148:149], v[148:149], v[144:145]
    v_cvt_pk_bf16_f32 v156, v148, v146
    v_cvt_pk_bf16_f32 v157, v149, v147
    ds_write_b32 v158, v156 offset:1152
    ds_write_b32 v158, v157 offset:1296
    s_cmp_lg_u32 s6, 0
    s_cbranch_scc1 L_iw_10
    s_add_u32 s55, s28, 0
    s_mov_b32 s71, 400000
L_poll_12:
    global_load_dwordx2 v[176:177], v180, s[68:69] sc1
    s_sub_u32 s71, s71, 1
    s_cmp_eq_u32 s71, 0
    s_cbranch_scc1 L_abort
    s_waitcnt vmcnt(0)
    v_subrev_u32 v178, s55, v176
    v_cmp_lt_u32 vcc, 7, v178
    v_xor_b32 v178, v176, v177
    v_cmp_ne_u32 s[88:89], s29, v178
    s_or_b64 s[88:89], vcc, s[88:89]
    s_nop 3
    s_cbranch_scc1 L_poll_12
L_mok_11:
    s_add_u32 s3, s28, s46
    v_cmp_ne_u32 vcc, s3, v176
    s_nop 1
    s_cmp_lg_u64 vcc, 0
    s_cselect_b32 s7, 1, 0
    v_mov_b32 v176, s7
    v_mov_b32 v177, 163824
    ds_write_b32 v177, v176
    s_nop 0
L_iw_10:
    s_waitcnt lgkmcnt(0)
    s_barrier
    v_mov_b32 v177, 163824
    ds_read_b32 v176, v177
    s_waitcnt lgkmcnt(0)
    v_readfirstlane_b32 s7, v176
    s_mov_b32 s90, 2097152
    s_mov_b32 s91, 2097152
    s_mov_b32 s96, 20971520
    s_cmp_eq_u32 s7, 0
    s_nop 0
    s_cbranch_scc1 L_al_13
    s_mov_b32 s90, 14680064
    s_mov_b32 s91, 17825792
    s_mov_b32 s96, 28311552
L_al_13:
    s_cmp_eq_u32 s6, 3
    s_cbranch_scc1 L_iw_14
    v_lshrrev_b32 v100, 3, v0
    v_and_b32 v101, 7, v0
    v_lshlrev_b32 v101, 4, v101
    v_mul_u32_u24 v102, 144, v100
    v_add3_u32 v102, v102, v101, 0
    v_add_u32 v102, 113664, v102
    s_mul_i32 s3, s4, 327680
    s_sub_u32 s50, 31, s5
    s_lshl_b32 s50, s50, 7
    s_add_u32 s3, s3, s50
    s_add_u32 s3, s3, 2097152
    v_lshlrev_b32 v103, 12, v100
    v_add3_u32 v103, v103, v101, s3
    ds_read_b128 v[104:107], v102 offset:0
    ds_read_b128 v[108:111], v102 offset:3456
    ds_read_b128 v[112:115], v102 offset:6912
    s_cmp_lg_u32 s6, 0
    s_cbranch_scc1 L_iw_15
    ds_read_b128 v[116:119], v102 offset:10368
L_iw_15:
    v_add_u32 v120, 98304, v103
    v_add_u32 v121, 196608, v103
    v_add_u32 v122, 294912, v103
    s_waitcnt lgkmcnt(0)
    s_cmp_eq_u32 s7, 0
    s_cbranch_scc0 L_slow_16
    global_store_dwordx4 v103, v[104:107], s[38:39]
    global_store_dwordx4 v120, v[108:111], s[38:39]
    global_store_dwordx4 v121, v[112:115], s[38:39]
    s_nop 1
    s_branch L_sd_17
L_slow_16:
    global_store_dwordx4 v103, v[104:107], s[38:39] sc0 sc1
    global_store_dwordx4 v120, v[108:111], s[38:39] sc0 sc1
    global_store_dwordx4 v121, v[112:115], s[38:39] sc0 sc1
    s_nop 1
L_sd_17:
    s_cmp_lg_u32 s6, 0
    s_cbranch_scc1 L_iw_18
    s_cmp_eq_u32 s7, 0
    s_cbranch_scc0 L_slow_19
    global_store_dwordx4 v122, v[116:119], s[38:39]
    s_nop 1
    s_branch L_sd_20
L_slow_19:
    global_store_dwordx4 v122, v[116:119], s[38:39] sc0 sc1
    s_nop 1
L_sd_20:
L_iw_18:
    s_waitcnt vmcnt(0)
L_iw_14:
    s_barrier
    s_cmp_lg_u32 s6, 0
    s_cbranch_scc1 L_iw_21
    s_lshl_b32 s50, s5, 3
    s_add_u32 s3, s28, 1
    v_mov_b32 v176, s3
    s_xor_b32 s3, s3, s29
    v_mov_b32 v177, s3
    v_mov_b32 v178, s50
    s_mov_b64 s[92:93], exec
    s_mov_b64 exec, 1
    s_cmp_eq_u32 s7, 0
    s_cbranch_scc0 L_slow_22
    global_store_dwordx2 v178, v[176:177], s[64:65]
    s_branch L_sd_23
L_slow_22:
    global_store_dwordx2 v178, v[176:177], s[64:65] sc0 sc1
L_sd_23:
    s_mov_b64 exec, s[92:93]
L_iw_21:
    s_cmp_eq_u32 s48, 0
    s_cbranch_scc1 L_kc_24
    v_lshlrev_b32 v128, 4, v1
    s_add_u32 s3, s70, 16
    v_add_u32 v128, s3, v128
    v_alignbit_b32 v110, v67, v66, 16
    v_alignbit_b32 v111, v68, v67, 16
    v_alignbit_b32 v112, v69, v68, 16
    v_alignbit_b32 v113, v70, v69, 16
    v_alignbit_b32 v114, v71, v70, 16
    v_alignbit_b32 v115, v72, v71, 16
    v_alignbit_b32 v116, v68, v67, 16
    v_alignbit_b32 v117, v69, v68, 16
    v_alignbit_b32 v118, v70, v69, 16
    v_alignbit_b32 v119, v71, v70, 16
    v_alignbit_b32 v120, v72, v71, 16
    v_alignbit_b32 v121, v73, v72, 16
    v_mov_b32 v122, v67
    v_mov_b32 v123, v68
    v_mov_b32 v124, v69
    v_mov_b32 v125, v70
    v_mov_b32 v126, v71
    v_mov_b32 v127, v72
    ds_write_b128 v128, v[110:113] offset:0
    ds_write_b128 v128, v[122:125] offset:4160
    ds_write_b128 v128, v[116:119] offset:8320
    ds_write_b128 v128, v[68:71] offset:12480
    ds_write_b128 v128, v[112:115] offset:16640
    ds_write_b128 v128, v[124:127] offset:20800
    ds_write_b128 v128, v[118:121] offset:24960
    ds_write_b128 v128, v[70:73] offset:29120
    v_alignbit_b32 v134, v75, v74, 16
    v_alignbit_b32 v135, v76, v75, 16
    v_alignbit_b32 v136, v77, v76, 16
    v_alignbit_b32 v137, v78, v77, 16
    v_alignbit_b32 v138, v79, v78, 16
    v_alignbit_b32 v139, v80, v79, 16
    v_alignbit_b32 v140, v76, v75, 16
    v_alignbit_b32 v141, v77, v76, 16
    v_alignbit_b32 v142, v78, v77, 16
    v_alignbit_b32 v143, v79, v78, 16
    v_alignbit_b32 v144, v80, v79, 16
    v_alignbit_b32 v145, v81, v80, 16
    v_mov_b32 v146, v75
    v_mov_b32 v147, v76
    v_mov_b32 v148, v77
    v_mov_b32 v149, v78
    v_mov_b32 v150, v79
    v_mov_b32 v151, v80
    ds_write_b128 v128, v[134:137] offset:1024
    ds_write_b128 v128, v[146:149] offset:5184
    ds_write_b128 v128, v[140:143] offset:9344
    ds_write_b128 v128, v[76:79] offset:13504
    ds_write_b128 v128, v[136:139] offset:17664
    ds_write_b128 v128, v[148:151] offset:21824
    ds_write_b128 v128, v[142:145] offset:25984
    ds_write_b128 v128, v[78:81] offset:30144
    s_waitcnt lgkmcnt(8)
    v_alignbit_b32 v110, v83, v82, 16
    v_alignbit_b32 v111, v84, v83, 16
    v_alignbit_b32 v112, v85, v84, 16
    v_alignbit_b32 v113, v86, v85, 16
    v_alignbit_b32 v114, v87, v86, 16
    v_alignbit_b32 v115, v88, v87, 16
    v_alignbit_b32 v116, v84, v83, 16
    v_alignbit_b32 v117, v85, v84, 16
    v_alignbit_b32 v118, v86, v85, 16
    v_alignbit_b32 v119, v87, v86, 16
    v_alignbit_b32 v120, v88, v87, 16
    v_alignbit_b32 v121, v89, v88, 16
    v_mov_b32 v122, v83
    v_mov_b32 v123, v84
    v_mov_b32 v124, v85
    v_mov_b32 v125, v86
    v_mov_b32 v126, v87
    v_mov_b32 v127, v88
    ds_write_b128 v128, v[110:113] offset:2048
    ds_write_b128 v128, v[122:125] offset:6208
    ds_write_b128 v128, v[116:119] offset:10368
    ds_write_b128 v128, v[84:87] offset:14528
    ds_write_b128 v128, v[112:115] offset:18688
    ds_write_b128 v128, v[124:127] offset:22848
    ds_write_b128 v128, v[118:121] offset:27008
    ds_write_b128 v128, v[86:89] offset:31168
    s_waitcnt lgkmcnt(8)
    v_alignbit_b32 v134, v91, v90, 16
    v_alignbit_b32 v135, v92, v91, 16
    v_alignbit_b32 v136, v93, v92, 16
    v_alignbit_b32 v137, v94, v93, 16
    v_alignbit_b32 v138, v95, v94, 16
    v_alignbit_b32 v139, v96, v95, 16
    v_alignbit_b32 v140, v92, v91, 16
    v_alignbit_b32 v141, v93, v92, 16
    v_alignbit_b32 v142, v94, v93, 16
    v_alignbit_b32 v143, v95, v94, 16
    v_alignbit_b32 v144, v96, v95, 16
    v_alignbit_b32 v145, v97, v96, 16
    v_mov_b32 v146, v91
    v_mov_b32 v147, v92
    v_mov_b32 v148, v93
    v_mov_b32 v149, v94
    v_mov_b32 v150, v95
    v_mov_b32 v151, v96
    ds_write_b128 v128, v[134:137] offset:3072
    ds_write_b128 v128, v[146:149] offset:7232
    ds_write_b128 v128, v[140:143] offset:11392
    ds_write_b128 v128, v[92:95] offset:15552
    ds_write_b128 v128, v[136:139] offset:19712
    ds_write_b128 v128, v[148:151] offset:23872
    ds_write_b128 v128, v[142:145] offset:28032
    ds_write_b128 v128, v[94:97] offset:32192
    v_mov_b32 v130, 0
    v_mov_b32 v131, 0
    v_mov_b32 v132, 0
    v_mov_b32 v133, 0
    v_mul_u32_u24 v129, 4160, v1
    v_add_u32 v129, s70, v129
    s_mov_b64 s[92:93], exec
    s_mov_b64 exec, 0xff
    ds_write_b128 v129, v[130:133]
    s_mov_b64 exec, 0x3fffffff
    v_lshlrev_b32 v129, 4, v1
    s_add_u32 s3, s70, 37376
    v_add_u32 v129, s3, v129
    ds_write_b128 v129, v[130:133]
    s_mov_b64 exec, s[92:93]
L_kc_24:
    s_waitcnt lgkmcnt(0)
    s_add_u32 s12, s30, 0
    s_addc_u32 s13, s31, 0
    s_and_b32 s13, s13, 0xffff
    s_mov_b32 s14, 2211840
    s_mov_b32 s15, 0x20000
    s_lshl_b32 s3, s6, 6
    v_add_u32 v181, s3, v1
    s_mov_b32 s50, 306783379
    s_movk_i32 s52, 3456
    v_mul_hi_u32 v182, v181, s50
    v_mul_u32_u24 v183, 14, v182
    v_sub_u32 v183, v181, v183
    v_mul_lo_u32 v174, v182, s52
    v_lshl_add_u32 v174, v183, 4, v174
    v_add_u32 v181, 256, v181
    v_mul_hi_u32 v182, v181, s50
    v_mul_u32_u24 v183, 14, v182
    v_sub_u32 v183, v181, v183
    v_mul_lo_u32 v175, v182, s52
    v_lshl_add_u32 v175, v183, 4, v175
    v_add_u32 v181, 256, v181
    v_mul_hi_u32 v182, v181, s50
    v_mul_u32_u24 v183, 14, v182
    v_sub_u32 v183, v181, v183
    v_mul_lo_u32 v176, v182, s52
    v_lshl_add_u32 v176, v183, 4, v176
    v_add_u32 v181, 256, v181
    v_mul_hi_u32 v182, v181, s50
    v_mul_u32_u24 v183, 14, v182
    v_sub_u32 v183, v181, v183
    v_mul_lo_u32 v177, v182, s52
    v_lshl_add_u32 v177, v183, 4, v177
    v_add_u32 v181, 256, v181
    v_mul_hi_u32 v182, v181, s50
    v_mul_u32_u24 v183, 14, v182
    v_sub_u32 v183, v181, v183
    v_mul_lo_u32 v178, v182, s52
    v_lshl_add_u32 v178, v183, 4, v178
    v_add_u32 v181, 256, v181
    v_mul_hi_u32 v182, v181, s50
    v_mul_u32_u24 v183, 14, v182
    v_sub_u32 v183, v181, v183
    v_mul_lo_u32 v179, v182, s52
    v_lshl_add_u32 v179, v183, 4, v179
    v_add_u32 v181, 256, v181
    v_mul_hi_u32 v182, v181, s50
    v_mul_u32_u24 v183, 14, v182
    v_sub_u32 v183, v181, v183
    v_mul_lo_u32 v180, v182, s52
    v_lshl_add_u32 v180, v183, 4, v180
    v_add_u32 v181, 256, v181
    s_lshl_b32 s62, s44, 5
    s_add_u32 s56, s38, 11534336
    s_addc_u32 s57, s39, 0
    s_and_b32 s57, s57, 0xffff
    s_mov_b32 s58, 2211840
    s_mov_b32 s59, 0x20000
    s_mul_i32 s3, s6, 560
    s_mul_i32 s50, s41, 5
    s_add_u32 s3, s3, s50
    s_lshl_b32 s60, s3, 10
    s_cmp_lg_u32 s6, 3
    s_cbranch_scc1 L_iw_25
    s_waitcnt vmcnt(0)
L_iw_25:
    s_cmp_lg_u32 s6, 0
    s_cbranch_scc1 L_iw_26
    v_and_b32 v180, 31, v1
    v_lshlrev_b32 v180, 3, v180
    s_add_u32 s55, s28, 1
    s_mov_b32 s71, 400000
L_poll_27:
    global_load_dwordx2 v[176:177], v180, s[64:65] sc1
    s_sub_u32 s71, s71, 1
    s_cmp_eq_u32 s71, 0
    s_cbranch_scc1 L_abort
    s_waitcnt vmcnt(0)
    v_subrev_u32 v178, s55, v176
    v_cmp_lt_u32 vcc, 6, v178
    v_xor_b32 v178, v176, v177
    v_cmp_ne_u32 s[88:89], s29, v178
    s_or_b64 s[88:89], vcc, s[88:89]
    s_nop 3
    s_cbranch_scc1 L_poll_27
L_iw_26:
    s_barrier
    s_cmp_eq_u32 s48, 0
    s_cbranch_scc1 L_conv_skip_28
    s_lshl_b32 s3, s47, 12
    s_add_u32 s66, s38, 2097152
    s_addc_u32 s67, s39, 0
    s_add_u32 s66, s66, s3
    s_addc_u32 s67, s67, 0
    v_lshlrev_b32 v164, 4, v1
    s_add_u32 m0, s70, 33280
    v_add_u32 v165, 0, v164
    global_load_lds_dwordx4 v165, s[66:67]
    s_add_u32 m0, s70, 34304
    v_add_u32 v165, 1024, v164
    global_load_lds_dwordx4 v165, s[66:67]
    s_add_u32 m0, s70, 35328
    v_add_u32 v165, 2048, v164
    global_load_lds_dwordx4 v165, s[66:67]
    s_add_u32 m0, s70, 36352
    v_add_u32 v165, 3072, v164
    global_load_lds_dwordx4 v165, s[66:67]
    s_and_b32 s3, s47, 1
    s_lshl_b32 s50, s49, 16
    s_and_b32 s49, s49, 0xffff0000
    s_cmp_eq_u32 s3, 0
    s_cselect_b32 s49, s50, s49
    v_and_b32 v166, 7, v2
    v_mul_u32_u24 v166, 4160, v166
    v_lshrrev_b32 v168, 3, v2
    v_add_u32 v168, v168, v3
    v_lshl_add_u32 v166, v168, 4, v166
    v_add_u32 v166, s70, v166
    v_lshlrev_b32 v167, 5, v2
    v_lshlrev_b32 v168, 4, v3
    v_sub_u32 v167, v168, v167
    s_add_u32 s3, s70, 33760
    v_add_u32 v167, s3, v167
    ds_read_b128 v[36:39], v166 offset:0
    ds_read_b128 v[40:43], v166 offset:512
    ds_read_b128 v[44:47], v166 offset:1024
    ds_read_b128 v[48:51], v166 offset:1536
    ds_read_b128 v[52:55], v166 offset:2048
    ds_read_b128 v[56:59], v166 offset:2560
    ds_read_b128 v[60:63], v166 offset:3072
    ds_read_b128 v[64:67], v166 offset:3584
    v_lshlrev_b32 v169, 5, v2
    v_lshl_add_u32 v169, v3, 3, v169
    s_add_u32 s3, s70, 33784
    v_sub_u32 v168, s3, v169
    s_lshl_b32 s3, s47, 12
    s_add_u32 s3, s3, 5242880
    v_and_b32 v170, 1, v3
    v_lshlrev_b32 v170, 9, v170
    v_lshrrev_b32 v171, 1, v3
    v_lshl_add_u32 v170, v171, 4, v170
    v_lshl_add_u32 v169, v2, 5, v170
    v_add_u32 v169, s3, v169
    v_mov_b32 v170, s49
    v_lshlrev_b32 v171, 4, v1
    s_waitcnt vmcnt(0)
    ds_read_b128 v[68:71], v167 offset:3584
    ds_read_b128 v[72:75], v167 offset:3072
    ds_read_b128 v[76:79], v167 offset:2560
    ds_read_b128 v[80:83], v167 offset:2048
    ds_read_b128 v[84:87], v167 offset:1536
    ds_read_b128 v[88:91], v167 offset:1024
    ds_read_b128 v[92:95], v167 offset:512
    ds_read_b128 v[96:99], v167 offset:0
    s_waitcnt lgkmcnt(0)
    v_mfma_f32_16x16x32_bf16 v[4:7], v[36:39], v[68:71], 0
    ds_read_b128 v[100:103], v166 offset:64
    v_mfma_f32_16x16x32_bf16 v[8:11], v[36:39], v[72:75], 0
    ds_read_b128 v[132:135], v167 offset:3648
    v_mfma_f32_16x16x32_bf16 v[12:15], v[36:39], v[76:79], 0
    ds_read_b128 v[104:107], v166 offset:576
    v_mfma_f32_16x16x32_bf16 v[16:19], v[36:39], v[80:83], 0
    ds_read_b128 v[136:139], v167 offset:3136
    v_mfma_f32_16x16x32_bf16 v[20:23], v[36:39], v[84:87], 0
    ds_read_b128 v[108:111], v166 offset:1088
    v_mfma_f32_16x16x32_bf16 v[24:27], v[36:39], v[88:91], 0
    ds_read_b128 v[140:143], v167 offset:2624
    v_mfma_f32_16x16x32_bf16 v[28:31], v[36:39], v[92:95], 0
    ds_read_b128 v[112:115], v166 offset:1600
    v_mfma_f32_16x16x32_bf16 v[32:35], v[36:39], v[96:99], 0
    ds_read_b128 v[144:147], v167 offset:2112
    v_mfma_f32_16x16x32_bf16 v[8:11], v[40:43], v[68:71], v[8:11]
    ds_read_b128 v[116:119], v166 offset:2112
    v_mfma_f32_16x16x32_bf16 v[12:15], v[40:43], v[72:75], v[12:15]
    ds_read_b128 v[148:151], v167 offset:1600
    v_mfma_f32_16x16x32_bf16 v[16:19], v[40:43], v[76:79], v[16:19]
    ds_read_b128 v[120:123], v166 offset:2624
    v_mfma_f32_16x16x32_bf16 v[20:23], v[40:43], v[80:83], v[20:23]
    ds_read_b128 v[152:155], v167 offset:1088
    v_mfma_f32_16x16x32_bf16 v[24:27], v[40:43], v[84:87], v[24:27]
    ds_read_b128 v[124:127], v166 offset:3136
    v_mfma_f32_16x16x32_bf16 v[28:31], v[40:43], v[88:91], v[28:31]
    ds_read_b128 v[156:159], v167 offset:576
    v_mfma_f32_16x16x32_bf16 v[32:35], v[40:43], v[92:95], v[32:35]
    ds_read_b128 v[128:131], v166 offset:3648
    v_mfma_f32_16x16x32_bf16 v[12:15], v[44:47], v[68:71], v[12:15]
    ds_read_b128 v[160:163], v167 offset:64
    v_mfma_f32_16x16x32_bf16 v[16:19], v[44:47], v[72:75], v[16:19]
    v_mfma_f32_16x16x32_bf16 v[20:23], v[44:47], v[76:79], v[20:23]
    v_mfma_f32_16x16x32_bf16 v[24:27], v[44:47], v[80:83], v[24:27]
    v_mfma_f32_16x16x32_bf16 v[28:31], v[44:47], v[84:87], v[28:31]
    v_mfma_f32_16x16x32_bf16 v[32:35], v[44:47], v[88:91], v[32:35]
    v_mfma_f32_16x16x32_bf16 v[16:19], v[48:51], v[68:71], v[16:19]
    v_mfma_f32_16x16x32_bf16 v[20:23], v[48:51], v[72:75], v[20:23]
    v_mfma_f32_16x16x32_bf16 v[24:27], v[48:51], v[76:79], v[24:27]
    v_mfma_f32_16x16x32_bf16 v[28:31], v[48:51], v[80:83], v[28:31]
    v_mfma_f32_16x16x32_bf16 v[32:35], v[48:51], v[84:87], v[32:35]
    v_mfma_f32_16x16x32_bf16 v[20:23], v[52:55], v[68:71], v[20:23]
    v_mfma_f32_16x16x32_bf16 v[24:27], v[52:55], v[72:75], v[24:27]
    v_mfma_f32_16x16x32_bf16 v[28:31], v[52:55], v[76:79], v[28:31]
    v_mfma_f32_16x16x32_bf16 v[32:35], v[52:55], v[80:83], v[32:35]
    v_mfma_f32_16x16x32_bf16 v[24:27], v[56:59], v[68:71], v[24:27]
    v_mfma_f32_16x16x32_bf16 v[28:31], v[56:59], v[72:75], v[28:31]
    v_mfma_f32_16x16x32_bf16 v[32:35], v[56:59], v[76:79], v[32:35]
    v_mfma_f32_16x16x32_bf16 v[28:31], v[60:63], v[68:71], v[28:31]
    v_mfma_f32_16x16x32_bf16 v[32:35], v[60:63], v[72:75], v[32:35]
    v_mfma_f32_16x16x32_bf16 v[32:35], v[64:67], v[68:71], v[32:35]
    s_waitcnt lgkmcnt(0)
    v_mfma_f32_16x16x32_bf16 v[4:7], v[100:103], v[132:135], v[4:7]
    ds_read_b128 v[36:39], v166 offset:128
    v_mfma_f32_16x16x32_bf16 v[8:11], v[100:103], v[136:139], v[8:11]
    ds_read_b128 v[68:71], v167 offset:3712
    v_mfma_f32_16x16x32_bf16 v[12:15], v[100:103], v[140:143], v[12:15]
    ds_read_b128 v[40:43], v166 offset:640
    v_mfma_f32_16x16x32_bf16 v[16:19], v[100:103], v[144:147], v[16:19]
    ds_read_b128 v[72:75], v167 offset:3200
    v_mfma_f32_16x16x32_bf16 v[20:23], v[100:103], v[148:151], v[20:23]
    ds_read_b128 v[44:47], v166 offset:1152
    v_mfma_f32_16x16x32_bf16 v[24:27], v[100:103], v[152:155], v[24:27]
    ds_read_b128 v[76:79], v167 offset:2688
    v_mfma_f32_16x16x32_bf16 v[28:31], v[100:103], v[156:159], v[28:31]
    ds_read_b128 v[48:51], v166 offset:1664
    v_mfma_f32_16x16x32_bf16 v[32:35], v[100:103], v[160:163], v[32:35]
    ds_read_b128 v[80:83], v167 offset:2176
    v_mfma_f32_16x16x32_bf16 v[8:11], v[104:107], v[132:135], v[8:11]
    ds_read_b128 v[52:55], v166 offset:2176
    v_mfma_f32_16x16x32_bf16 v[12:15], v[104:107], v[136:139], v[12:15]
    ds_read_b128 v[84:87], v167 offset:1664
    v_mfma_f32_16x16x32_bf16 v[16:19], v[104:107], v[140:143], v[16:19]
    ds_read_b128 v[56:59], v166 offset:2688
    v_mfma_f32_16x16x32_bf16 v[20:23], v[104:107], v[144:147], v[20:23]
    ds_read_b128 v[88:91], v167 offset:1152
    v_mfma_f32_16x16x32_bf16 v[24:27], v[104:107], v[148:151], v[24:27]
    ds_read_b128 v[60:63], v166 offset:3200
    v_mfma_f32_16x16x32_bf16 v[28:31], v[104:107], v[152:155], v[28:31]
    ds_read_b128 v[92:95], v167 offset:640
    v_mfma_f32_16x16x32_bf16 v[32:35], v[104:107], v[156:159], v[32:35]
    ds_read_b128 v[64:67], v166 offset:3712
    v_mfma_f32_16x16x32_bf16 v[12:15], v[108:111], v[132:135], v[12:15]
    ds_read_b128 v[96:99], v167 offset:128
    v_mfma_f32_16x16x32_bf16 v[16:19], v[108:111], v[136:139], v[16:19]
    v_mfma_f32_16x16x32_bf16 v[20:23], v[108:111], v[140:143], v[20:23]
    v_mfma_f32_16x16x32_bf16 v[24:27], v[108:111], v[144:147], v[24:27]
    v_mfma_f32_16x16x32_bf16 v[28:31], v[108:111], v[148:151], v[28:31]
    v_mfma_f32_16x16x32_bf16 v[32:35], v[108:111], v[152:155], v[32:35]
    v_mfma_f32_16x16x32_bf16 v[16:19], v[112:115], v[132:135], v[16:19]
    v_mfma_f32_16x16x32_bf16 v[20:23], v[112:115], v[136:139], v[20:23]
    v_mfma_f32_16x16x32_bf16 v[24:27], v[112:115], v[140:143], v[24:27]
    v_mfma_f32_16x16x32_bf16 v[28:31], v[112:115], v[144:147], v[28:31]
    v_mfma_f32_16x16x32_bf16 v[32:35], v[112:115], v[148:151], v[32:35]
    v_mfma_f32_16x16x32_bf16 v[20:23], v[116:119], v[132:135], v[20:23]
    v_mfma_f32_16x16x32_bf16 v[24:27], v[116:119], v[136:139], v[24:27]
    v_mfma_f32_16x16x32_bf16 v[28:31], v[116:119], v[140:143], v[28:31]
    v_mfma_f32_16x16x32_bf16 v[32:35], v[116:119], v[144:147], v[32:35]
    v_mfma_f32_16x16x32_bf16 v[24:27], v[120:123], v[132:135], v[24:27]
    v_mfma_f32_16x16x32_bf16 v[28:31], v[120:123], v[136:139], v[28:31]
    v_mfma_f32_16x16x32_bf16 v[32:35], v[120:123], v[140:143], v[32:35]
    v_mfma_f32_16x16x32_bf16 v[28:31], v[124:127], v[132:135], v[28:31]
    v_mfma_f32_16x16x32_bf16 v[32:35], v[124:127], v[136:139], v[32:35]
    v_mfma_f32_16x16x32_bf16 v[32:35], v[128:131], v[132:135], v[32:35]
    s_waitcnt lgkmcnt(0)
    v_mfma_f32_16x16x32_bf16 v[4:7], v[36:39], v[68:71], v[4:7]
    ds_read_b128 v[100:103], v166 offset:192
    v_mfma_f32_16x16x32_bf16 v[8:11], v[36:39], v[72:75], v[8:11]
    ds_read_b128 v[132:135], v167 offset:3776
    v_mfma_f32_16x16x32_bf16 v[12:15], v[36:39], v[76:79], v[12:15]
    ds_read_b128 v[104:107], v166 offset:704
    v_mfma_f32_16x16x32_bf16 v[16:19], v[36:39], v[80:83], v[16:19]
    ds_read_b128 v[136:139], v167 offset:3264
    v_mfma_f32_16x16x32_bf16 v[20:23], v[36:39], v[84:87], v[20:23]
    ds_read_b128 v[108:111], v166 offset:1216
    v_mfma_f32_16x16x32_bf16 v[24:27], v[36:39], v[88:91], v[24:27]
    ds_read_b128 v[140:143], v167 offset:2752
    v_mfma_f32_16x16x32_bf16 v[28:31], v[36:39], v[92:95], v[28:31]
    ds_read_b128 v[112:115], v166 offset:1728
    v_mfma_f32_16x16x32_bf16 v[32:35], v[36:39], v[96:99], v[32:35]
    ds_read_b128 v[144:147], v167 offset:2240
    v_mfma_f32_16x16x32_bf16 v[8:11], v[40:43], v[68:71], v[8:11]
    ds_read_b128 v[116:119], v166 offset:2240
    v_mfma_f32_16x16x32_bf16 v[12:15], v[40:43], v[72:75], v[12:15]
    ds_read_b128 v[148:151], v167 offset:1728
    v_mfma_f32_16x16x32_bf16 v[16:19], v[40:43], v[76:79], v[16:19]
    ds_read_b128 v[120:123], v166 offset:2752
    v_mfma_f32_16x16x32_bf16 v[20:23], v[40:43], v[80:83], v[20:23]
    ds_read_b128 v[152:155], v167 offset:1216
    v_mfma_f32_16x16x32_bf16 v[24:27], v[40:43], v[84:87], v[24:27]
    ds_read_b128 v[124:127], v166 offset:3264
    v_mfma_f32_16x16x32_bf16 v[28:31], v[40:43], v[88:91], v[28:31]
    ds_read_b128 v[156:159], v167 offset:704
    v_mfma_f32_16x16x32_bf16 v[32:35], v[40:43], v[92:95], v[32:35]
    ds_read_b128 v[128:131], v166 offset:3776
    v_mfma_f32_16x16x32_bf16 v[12:15], v[44:47], v[68:71], v[12:15]
    ds_read_b128 v[160:163], v167 offset:192
    v_mfma_f32_16x16x32_bf16 v[16:19], v[44:47], v[72:75], v[16:19]
    v_mfma_f32_16x16x32_bf16 v[20:23], v[44:47], v[76:79], v[20:23]
    v_mfma_f32_16x16x32_bf16 v[24:27], v[44:47], v[80:83], v[24:27]
    v_mfma_f32_16x16x32_bf16 v[28:31], v[44:47], v[84:87], v[28:31]
    v_mfma_f32_16x16x32_bf16 v[32:35], v[44:47], v[88:91], v[32:35]
    v_mfma_f32_16x16x32_bf16 v[16:19], v[48:51], v[68:71], v[16:19]
    v_mfma_f32_16x16x32_bf16 v[20:23], v[48:51], v[72:75], v[20:23]
    v_mfma_f32_16x16x32_bf16 v[24:27], v[48:51], v[76:79], v[24:27]
    v_mfma_f32_16x16x32_bf16 v[28:31], v[48:51], v[80:83], v[28:31]
    v_mfma_f32_16x16x32_bf16 v[32:35], v[48:51], v[84:87], v[32:35]
    v_mfma_f32_16x16x32_bf16 v[20:23], v[52:55], v[68:71], v[20:23]
    v_mfma_f32_16x16x32_bf16 v[24:27], v[52:55], v[72:75], v[24:27]
    v_mfma_f32_16x16x32_bf16 v[28:31], v[52:55], v[76:79], v[28:31]
    v_mfma_f32_16x16x32_bf16 v[32:35], v[52:55], v[80:83], v[32:35]
    v_mfma_f32_16x16x32_bf16 v[24:27], v[56:59], v[68:71], v[24:27]
    v_mfma_f32_16x16x32_bf16 v[28:31], v[56:59], v[72:75], v[28:31]
    v_mfma_f32_16x16x32_bf16 v[32:35], v[56:59], v[76:79], v[32:35]
    v_mfma_f32_16x16x32_bf16 v[28:31], v[60:63], v[68:71], v[28:31]
    v_mfma_f32_16x16x32_bf16 v[32:35], v[60:63], v[72:75], v[32:35]
    v_mfma_f32_16x16x32_bf16 v[32:35], v[64:67], v[68:71], v[32:35]
    s_waitcnt lgkmcnt(0)
    v_mfma_f32_16x16x32_bf16 v[4:7], v[100:103], v[132:135], v[4:7]
    ds_read_b128 v[36:39], v166 offset:256
    v_mfma_f32_16x16x32_bf16 v[8:11], v[100:103], v[136:139], v[8:11]
    ds_read_b128 v[68:71], v167 offset:3840
    v_mfma_f32_16x16x32_bf16 v[12:15], v[100:103], v[140:143], v[12:15]
    ds_read_b128 v[40:43], v166 offset:768
    v_mfma_f32_16x16x32_bf16 v[16:19], v[100:103], v[144:147], v[16:19]
    ds_read_b128 v[72:75], v167 offset:3328
    v_mfma_f32_16x16x32_bf16 v[20:23], v[100:103], v[148:151], v[20:23]
    ds_read_b128 v[44:47], v166 offset:1280
    v_mfma_f32_16x16x32_bf16 v[24:27], v[100:103], v[152:155], v[24:27]
    ds_read_b128 v[76:79], v167 offset:2816
    v_mfma_f32_16x16x32_bf16 v[28:31], v[100:103], v[156:159], v[28:31]
    ds_read_b128 v[48:51], v166 offset:1792
    v_mfma_f32_16x16x32_bf16 v[32:35], v[100:103], v[160:163], v[32:35]
    ds_read_b128 v[80:83], v167 offset:2304
    v_mfma_f32_16x16x32_bf16 v[8:11], v[104:107], v[132:135], v[8:11]
    ds_read_b128 v[52:55], v166 offset:2304
    v_mfma_f32_16x16x32_bf16 v[12:15], v[104:107], v[136:139], v[12:15]
    ds_read_b128 v[84:87], v167 offset:1792
    v_mfma_f32_16x16x32_bf16 v[16:19], v[104:107], v[140:143], v[16:19]
    ds_read_b128 v[56:59], v166 offset:2816
    v_mfma_f32_16x16x32_bf16 v[20:23], v[104:107], v[144:147], v[20:23]
    ds_read_b128 v[88:91], v167 offset:1280
    v_mfma_f32_16x16x32_bf16 v[24:27], v[104:107], v[148:151], v[24:27]
    ds_read_b128 v[60:63], v166 offset:3328
    v_mfma_f32_16x16x32_bf16 v[28:31], v[104:107], v[152:155], v[28:31]
    ds_read_b128 v[92:95], v167 offset:768
    v_mfma_f32_16x16x32_bf16 v[32:35], v[104:107], v[156:159], v[32:35]
    ds_read_b128 v[64:67], v166 offset:3840
    v_mfma_f32_16x16x32_bf16 v[12:15], v[108:111], v[132:135], v[12:15]
    ds_read_b128 v[96:99], v167 offset:256
    v_mfma_f32_16x16x32_bf16 v[16:19], v[108:111], v[136:139], v[16:19]
    v_mfma_f32_16x16x32_bf16 v[20:23], v[108:111], v[140:143], v[20:23]
    v_mfma_f32_16x16x32_bf16 v[24:27], v[108:111], v[144:147], v[24:27]
    v_mfma_f32_16x16x32_bf16 v[28:31], v[108:111], v[148:151], v[28:31]
    v_mfma_f32_16x16x32_bf16 v[32:35], v[108:111], v[152:155], v[32:35]
    v_mfma_f32_16x16x32_bf16 v[16:19], v[112:115], v[132:135], v[16:19]
    v_mfma_f32_16x16x32_bf16 v[20:23], v[112:115], v[136:139], v[20:23]
    v_mfma_f32_16x16x32_bf16 v[24:27], v[112:115], v[140:143], v[24:27]
    v_mfma_f32_16x16x32_bf16 v[28:31], v[112:115], v[144:147], v[28:31]
    v_mfma_f32_16x16x32_bf16 v[32:35], v[112:115], v[148:151], v[32:35]
    v_mfma_f32_16x16x32_bf16 v[20:23], v[116:119], v[132:135], v[20:23]
    v_mfma_f32_16x16x32_bf16 v[24:27], v[116:119], v[136:139], v[24:27]
    v_mfma_f32_16x16x32_bf16 v[28:31], v[116:119], v[140:143], v[28:31]
    v_mfma_f32_16x16x32_bf16 v[32:35], v[116:119], v[144:147], v[32:35]
    v_mfma_f32_16x16x32_bf16 v[24:27], v[120:123], v[132:135], v[24:27]
    v_mfma_f32_16x16x32_bf16 v[28:31], v[120:123], v[136:139], v[28:31]
    v_mfma_f32_16x16x32_bf16 v[32:35], v[120:123], v[140:143], v[32:35]
    v_mfma_f32_16x16x32_bf16 v[28:31], v[124:127], v[132:135], v[28:31]
    v_mfma_f32_16x16x32_bf16 v[32:35], v[124:127], v[136:139], v[32:35]
    v_mfma_f32_16x16x32_bf16 v[32:35], v[128:131], v[132:135], v[32:35]
    s_waitcnt lgkmcnt(0)
    v_mfma_f32_16x16x32_bf16 v[4:7], v[36:39], v[68:71], v[4:7]
    ds_read_b128 v[100:103], v166 offset:320
    v_mfma_f32_16x16x32_bf16 v[8:11], v[36:39], v[72:75], v[8:11]
    ds_read_b128 v[132:135], v167 offset:3904
    v_mfma_f32_16x16x32_bf16 v[12:15], v[36:39], v[76:79], v[12:15]
    ds_read_b128 v[104:107], v166 offset:832
    v_mfma_f32_16x16x32_bf16 v[16:19], v[36:39], v[80:83], v[16:19]
    ds_read_b128 v[136:139], v167 offset:3392
    v_mfma_f32_16x16x32_bf16 v[20:23], v[36:39], v[84:87], v[20:23]
    ds_read_b128 v[108:111], v166 offset:1344
    v_mfma_f32_16x16x32_bf16 v[24:27], v[36:39], v[88:91], v[24:27]
    ds_read_b128 v[140:143], v167 offset:2880
    v_mfma_f32_16x16x32_bf16 v[28:31], v[36:39], v[92:95], v[28:31]
    ds_read_b128 v[112:115], v166 offset:1856
    v_mfma_f32_16x16x32_bf16 v[32:35], v[36:39], v[96:99], v[32:35]
    ds_read_b128 v[144:147], v167 offset:2368
    v_mfma_f32_16x16x32_bf16 v[8:11], v[40:43], v[68:71], v[8:11]
    ds_read_b128 v[116:119], v166 offset:2368
    v_mfma_f32_16x16x32_bf16 v[12:15], v[40:43], v[72:75], v[12:15]
    ds_read_b128 v[148:151], v167 offset:1856
    v_mfma_f32_16x16x32_bf16 v[16:19], v[40:43], v[76:79], v[16:19]
    ds_read_b128 v[120:123], v166 offset:2880
    v_mfma_f32_16x16x32_bf16 v[20:23], v[40:43], v[80:83], v[20:23]
    ds_read_b128 v[152:155], v167 offset:1344
    v_mfma_f32_16x16x32_bf16 v[24:27], v[40:43], v[84:87], v[24:27]
    ds_read_b128 v[124:127], v166 offset:3392
    v_mfma_f32_16x16x32_bf16 v[28:31], v[40:43], v[88:91], v[28:31]
    ds_read_b128 v[156:159], v167 offset:832
    v_mfma_f32_16x16x32_bf16 v[32:35], v[40:43], v[92:95], v[32:35]
    ds_read_b128 v[128:131], v166 offset:3904
    v_mfma_f32_16x16x32_bf16 v[12:15], v[44:47], v[68:71], v[12:15]
    ds_read_b128 v[160:163], v167 offset:320
    v_mfma_f32_16x16x32_bf16 v[16:19], v[44:47], v[72:75], v[16:19]
    v_mfma_f32_16x16x32_bf16 v[20:23], v[44:47], v[76:79], v[20:23]
    v_mfma_f32_16x16x32_bf16 v[24:27], v[44:47], v[80:83], v[24:27]
    v_mfma_f32_16x16x32_bf16 v[28:31], v[44:47], v[84:87], v[28:31]
    v_mfma_f32_16x16x32_bf16 v[32:35], v[44:47], v[88:91], v[32:35]
    v_mfma_f32_16x16x32_bf16 v[16:19], v[48:51], v[68:71], v[16:19]
    v_mfma_f32_16x16x32_bf16 v[20:23], v[48:51], v[72:75], v[20:23]
    v_mfma_f32_16x16x32_bf16 v[24:27], v[48:51], v[76:79], v[24:27]
    v_mfma_f32_16x16x32_bf16 v[28:31], v[48:51], v[80:83], v[28:31]
    v_mfma_f32_16x16x32_bf16 v[32:35], v[48:51], v[84:87], v[32:35]
    v_mfma_f32_16x16x32_bf16 v[20:23], v[52:55], v[68:71], v[20:23]
    v_mfma_f32_16x16x32_bf16 v[24:27], v[52:55], v[72:75], v[24:27]
    v_mfma_f32_16x16x32_bf16 v[28:31], v[52:55], v[76:79], v[28:31]
    v_mfma_f32_16x16x32_bf16 v[32:35], v[52:55], v[80:83], v[32:35]
    v_mfma_f32_16x16x32_bf16 v[24:27], v[56:59], v[68:71], v[24:27]
    v_mfma_f32_16x16x32_bf16 v[28:31], v[56:59], v[72:75], v[28:31]
    v_mfma_f32_16x16x32_bf16 v[32:35], v[56:59], v[76:79], v[32:35]
    v_mfma_f32_16x16x32_bf16 v[28:31], v[60:63], v[68:71], v[28:31]
    v_mfma_f32_16x16x32_bf16 v[32:35], v[60:63], v[72:75], v[32:35]
    v_mfma_f32_16x16x32_bf16 v[32:35], v[64:67], v[68:71], v[32:35]
    s_waitcnt lgkmcnt(0)
    v_mfma_f32_16x16x32_bf16 v[4:7], v[100:103], v[132:135], v[4:7]
    ds_read_b128 v[36:39], v166 offset:384
    v_mfma_f32_16x16x32_bf16 v[8:11], v[100:103], v[136:139], v[8:11]
    ds_read_b128 v[68:71], v167 offset:3968
    v_mfma_f32_16x16x32_bf16 v[12:15], v[100:103], v[140:143], v[12:15]
    ds_read_b128 v[40:43], v166 offset:896
    v_mfma_f32_16x16x32_bf16 v[16:19], v[100:103], v[144:147], v[16:19]
    ds_read_b128 v[72:75], v167 offset:3456
    v_mfma_f32_16x16x32_bf16 v[20:23], v[100:103], v[148:151], v[20:23]
    ds_read_b128 v[44:47], v166 offset:1408
    v_mfma_f32_16x16x32_bf16 v[24:27], v[100:103], v[152:155], v[24:27]
    ds_read_b128 v[76:79], v167 offset:2944
    v_mfma_f32_16x16x32_bf16 v[28:31], v[100:103], v[156:159], v[28:31]
    ds_read_b128 v[48:51], v166 offset:1920
    v_mfma_f32_16x16x32_bf16 v[32:35], v[100:103], v[160:163], v[32:35]
    ds_read_b128 v[80:83], v167 offset:2432
    v_mfma_f32_16x16x32_bf16 v[8:11], v[104:107], v[132:135], v[8:11]
    ds_read_b128 v[52:55], v166 offset:2432
    v_mfma_f32_16x16x32_bf16 v[12:15], v[104:107], v[136:139], v[12:15]
    ds_read_b128 v[84:87], v167 offset:1920
    v_mfma_f32_16x16x32_bf16 v[16:19], v[104:107], v[140:143], v[16:19]
    ds_read_b128 v[56:59], v166 offset:2944
    v_mfma_f32_16x16x32_bf16 v[20:23], v[104:107], v[144:147], v[20:23]
    ds_read_b128 v[88:91], v167 offset:1408
    v_mfma_f32_16x16x32_bf16 v[24:27], v[104:107], v[148:151], v[24:27]
    ds_read_b128 v[60:63], v166 offset:3456
    v_mfma_f32_16x16x32_bf16 v[28:31], v[104:107], v[152:155], v[28:31]
    ds_read_b128 v[92:95], v167 offset:896
    v_mfma_f32_16x16x32_bf16 v[32:35], v[104:107], v[156:159], v[32:35]
    ds_read_b128 v[64:67], v166 offset:3968
    v_mfma_f32_16x16x32_bf16 v[12:15], v[108:111], v[132:135], v[12:15]
    ds_read_b128 v[96:99], v167 offset:384
    v_mfma_f32_16x16x32_bf16 v[16:19], v[108:111], v[136:139], v[16:19]
    v_mfma_f32_16x16x32_bf16 v[20:23], v[108:111], v[140:143], v[20:23]
    v_mfma_f32_16x16x32_bf16 v[24:27], v[108:111], v[144:147], v[24:27]
    v_mfma_f32_16x16x32_bf16 v[28:31], v[108:111], v[148:151], v[28:31]
    v_mfma_f32_16x16x32_bf16 v[32:35], v[108:111], v[152:155], v[32:35]
    v_mfma_f32_16x16x32_bf16 v[16:19], v[112:115], v[132:135], v[16:19]
    v_mfma_f32_16x16x32_bf16 v[20:23], v[112:115], v[136:139], v[20:23]
    v_mfma_f32_16x16x32_bf16 v[24:27], v[112:115], v[140:143], v[24:27]
    v_mfma_f32_16x16x32_bf16 v[28:31], v[112:115], v[144:147], v[28:31]
    v_mfma_f32_16x16x32_bf16 v[32:35], v[112:115], v[148:151], v[32:35]
    v_mfma_f32_16x16x32_bf16 v[20:23], v[116:119], v[132:135], v[20:23]
    v_mfma_f32_16x16x32_bf16 v[24:27], v[116:119], v[136:139], v[24:27]
    v_mfma_f32_16x16x32_bf16 v[28:31], v[116:119], v[140:143], v[28:31]
    v_mfma_f32_16x16x32_bf16 v[32:35], v[116:119], v[144:147], v[32:35]
    v_mfma_f32_16x16x32_bf16 v[24:27], v[120:123], v[132:135], v[24:27]
    v_mfma_f32_16x16x32_bf16 v[28:31], v[120:123], v[136:139], v[28:31]
    v_mfma_f32_16x16x32_bf16 v[32:35], v[120:123], v[140:143], v[32:35]
    v_mfma_f32_16x16x32_bf16 v[28:31], v[124:127], v[132:135], v[28:31]
    v_mfma_f32_16x16x32_bf16 v[32:35], v[124:127], v[136:139], v[32:35]
    v_mfma_f32_16x16x32_bf16 v[32:35], v[128:131], v[132:135], v[32:35]
    s_waitcnt lgkmcnt(0)
    v_mfma_f32_16x16x32_bf16 v[4:7], v[36:39], v[68:71], v[4:7]
    ds_read_b128 v[100:103], v166 offset:448
    v_mfma_f32_16x16x32_bf16 v[8:11], v[36:39], v[72:75], v[8:11]
    ds_read_b128 v[132:135], v167 offset:4032
    v_mfma_f32_16x16x32_bf16 v[12:15], v[36:39], v[76:79], v[12:15]
    ds_read_b128 v[104:107], v166 offset:960
    v_mfma_f32_16x16x32_bf16 v[16:19], v[36:39], v[80:83], v[16:19]
    ds_read_b128 v[136:139], v167 offset:3520
    v_mfma_f32_16x16x32_bf16 v[20:23], v[36:39], v[84:87], v[20:23]
    ds_read_b128 v[108:111], v166 offset:1472
    v_mfma_f32_16x16x32_bf16 v[24:27], v[36:39], v[88:91], v[24:27]
    ds_read_b128 v[140:143], v167 offset:3008
    v_mfma_f32_16x16x32_bf16 v[28:31], v[36:39], v[92:95], v[28:31]
    ds_read_b128 v[112:115], v166 offset:1984
    v_mfma_f32_16x16x32_bf16 v[32:35], v[36:39], v[96:99], v[32:35]
    ds_read_b128 v[144:147], v167 offset:2496
    v_mfma_f32_16x16x32_bf16 v[8:11], v[40:43], v[68:71], v[8:11]
    ds_read_b128 v[116:119], v166 offset:2496
    v_mfma_f32_16x16x32_bf16 v[12:15], v[40:43], v[72:75], v[12:15]
    ds_read_b128 v[148:151], v167 offset:1984
    v_mfma_f32_16x16x32_bf16 v[16:19], v[40:43], v[76:79], v[16:19]
    ds_read_b128 v[120:123], v166 offset:3008
    v_mfma_f32_16x16x32_bf16 v[20:23], v[40:43], v[80:83], v[20:23]
    ds_read_b128 v[152:155], v167 offset:1472
    v_mfma_f32_16x16x32_bf16 v[24:27], v[40:43], v[84:87], v[24:27]
    ds_read_b128 v[124:127], v166 offset:3520
    v_mfma_f32_16x16x32_bf16 v[28:31], v[40:43], v[88:91], v[28:31]
    ds_read_b128 v[156:159], v167 offset:960
    v_mfma_f32_16x16x32_bf16 v[32:35], v[40:43], v[92:95], v[32:35]
    ds_read_b128 v[128:131], v166 offset:4032
    v_mfma_f32_16x16x32_bf16 v[12:15], v[44:47], v[68:71], v[12:15]
    ds_read_b128 v[160:163], v167 offset:448
    v_mfma_f32_16x16x32_bf16 v[16:19], v[44:47], v[72:75], v[16:19]
    v_mfma_f32_16x16x32_bf16 v[20:23], v[44:47], v[76:79], v[20:23]
    v_mfma_f32_16x16x32_bf16 v[24:27], v[44:47], v[80:83], v[24:27]
    v_mfma_f32_16x16x32_bf16 v[28:31], v[44:47], v[84:87], v[28:31]
    v_mfma_f32_16x16x32_bf16 v[32:35], v[44:47], v[88:91], v[32:35]
    v_mfma_f32_16x16x32_bf16 v[16:19], v[48:51], v[68:71], v[16:19]
    v_mfma_f32_16x16x32_bf16 v[20:23], v[48:51], v[72:75], v[20:23]
    v_mfma_f32_16x16x32_bf16 v[24:27], v[48:51], v[76:79], v[24:27]
    v_mfma_f32_16x16x32_bf16 v[28:31], v[48:51], v[80:83], v[28:31]
    v_mfma_f32_16x16x32_bf16 v[32:35], v[48:51], v[84:87], v[32:35]
    v_mfma_f32_16x16x32_bf16 v[20:23], v[52:55], v[68:71], v[20:23]
    v_mfma_f32_16x16x32_bf16 v[24:27], v[52:55], v[72:75], v[24:27]
    v_mfma_f32_16x16x32_bf16 v[28:31], v[52:55], v[76:79], v[28:31]
    v_mfma_f32_16x16x32_bf16 v[32:35], v[52:55], v[80:83], v[32:35]
    v_mfma_f32_16x16x32_bf16 v[24:27], v[56:59], v[68:71], v[24:27]
    v_mfma_f32_16x16x32_bf16 v[28:31], v[56:59], v[72:75], v[28:31]
    v_mfma_f32_16x16x32_bf16 v[32:35], v[56:59], v[76:79], v[32:35]
    v_mfma_f32_16x16x32_bf16 v[28:31], v[60:63], v[68:71], v[28:31]
    v_mfma_f32_16x16x32_bf16 v[32:35], v[60:63], v[72:75], v[32:35]
    v_mfma_f32_16x16x32_bf16 v[32:35], v[64:67], v[68:71], v[32:35]
    s_waitcnt lgkmcnt(0)
    v_mfma_f32_16x16x32_bf16 v[4:7], v[100:103], v[132:135], v[4:7]
    v_mfma_f32_16x16x32_bf16 v[8:11], v[100:103], v[136:139], v[8:11]
    v_mfma_f32_16x16x32_bf16 v[12:15], v[100:103], v[140:143], v[12:15]
    v_mfma_f32_16x16x32_bf16 v[16:19], v[100:103], v[144:147], v[16:19]
    v_mfma_f32_16x16x32_bf16 v[20:23], v[100:103], v[148:151], v[20:23]
    v_mfma_f32_16x16x32_bf16 v[24:27], v[100:103], v[152:155], v[24:27]
    v_mfma_f32_16x16x32_bf16 v[28:31], v[100:103], v[156:159], v[28:31]
    v_mfma_f32_16x16x32_bf16 v[32:35], v[100:103], v[160:163], v[32:35]
    v_mfma_f32_16x16x32_bf16 v[8:11], v[104:107], v[132:135], v[8:11]
    v_mfma_f32_16x16x32_bf16 v[12:15], v[104:107], v[136:139], v[12:15]
    v_mfma_f32_16x16x32_bf16 v[16:19], v[104:107], v[140:143], v[16:19]
    v_mfma_f32_16x16x32_bf16 v[20:23], v[104:107], v[144:147], v[20:23]
    v_mfma_f32_16x16x32_bf16 v[24:27], v[104:107], v[148:151], v[24:27]
    v_mfma_f32_16x16x32_bf16 v[28:31], v[104:107], v[152:155], v[28:31]
    v_mfma_f32_16x16x32_bf16 v[32:35], v[104:107], v[156:159], v[32:35]
    v_mfma_f32_16x16x32_bf16 v[12:15], v[108:111], v[132:135], v[12:15]
    v_mfma_f32_16x16x32_bf16 v[16:19], v[108:111], v[136:139], v[16:19]
    v_mfma_f32_16x16x32_bf16 v[20:23], v[108:111], v[140:143], v[20:23]
    v_mfma_f32_16x16x32_bf16 v[24:27], v[108:111], v[144:147], v[24:27]
    v_mfma_f32_16x16x32_bf16 v[28:31], v[108:111], v[148:151], v[28:31]
    v_mfma_f32_16x16x32_bf16 v[32:35], v[108:111], v[152:155], v[32:35]
    v_mfma_f32_16x16x32_bf16 v[16:19], v[112:115], v[132:135], v[16:19]
    v_mfma_f32_16x16x32_bf16 v[20:23], v[112:115], v[136:139], v[20:23]
    v_mfma_f32_16x16x32_bf16 v[24:27], v[112:115], v[140:143], v[24:27]
    v_mfma_f32_16x16x32_bf16 v[28:31], v[112:115], v[144:147], v[28:31]
    v_mfma_f32_16x16x32_bf16 v[32:35], v[112:115], v[148:151], v[32:35]
    v_mfma_f32_16x16x32_bf16 v[20:23], v[116:119], v[132:135], v[20:23]
    v_mfma_f32_16x16x32_bf16 v[24:27], v[116:119], v[136:139], v[24:27]
    v_mfma_f32_16x16x32_bf16 v[28:31], v[116:119], v[140:143], v[28:31]
    v_mfma_f32_16x16x32_bf16 v[32:35], v[116:119], v[144:147], v[32:35]
    v_mfma_f32_16x16x32_bf16 v[24:27], v[120:123], v[132:135], v[24:27]
    v_mfma_f32_16x16x32_bf16 v[28:31], v[120:123], v[136:139], v[28:31]
    v_mfma_f32_16x16x32_bf16 v[32:35], v[120:123], v[140:143], v[32:35]
    v_mfma_f32_16x16x32_bf16 v[28:31], v[124:127], v[132:135], v[28:31]
    v_mfma_f32_16x16x32_bf16 v[32:35], v[124:127], v[136:139], v[32:35]
    v_mfma_f32_16x16x32_bf16 v[32:35], v[128:131], v[132:135], v[32:35]
    ds_read_b64 v[36:37], v168 offset:3584
    ds_read_b64 v[38:39], v168 offset:3072
    ds_read_b64 v[40:41], v168 offset:2560
    ds_read_b64 v[42:43], v168 offset:2048
    ds_read_b64 v[44:45], v168 offset:1536
    ds_read_b64 v[46:47], v168 offset:1024
    ds_read_b64 v[48:49], v168 offset:512
    ds_read_b64 v[50:51], v168 offset:0
    s_waitcnt lgkmcnt(0)
    v_and_b32 v56, s45, v37
    v_lshlrev_b32 v57, 16, v37
    v_and_b32 v58, s45, v36
    v_lshlrev_b32 v59, 16, v36
    v_pk_mul_f32 v[56:57], v[56:57], v[170:171] op_sel_hi:[1,0]
    v_pk_mul_f32 v[58:59], v[58:59], v[170:171] op_sel_hi:[1,0]
    v_cvt_pk_bf16_f32 v60, v56, v57
    v_lshlrev_b32 v56, 16, v60
    v_and_b32 v57, s45, v60
    v_cvt_pk_bf16_f32 v61, v58, v59
    v_lshlrev_b32 v58, 16, v61
    v_and_b32 v59, s45, v61
    v_cvt_pk_bf16_f32 v60, v4, v5
    v_lshlrev_b32 v4, 16, v60
    v_and_b32 v5, s45, v60
    v_cvt_pk_bf16_f32 v61, v6, v7
    v_lshlrev_b32 v6, 16, v61
    v_and_b32 v7, s45, v61
    v_pk_add_f32 v[4:5], v[4:5], v[56:57]
    v_pk_add_f32 v[6:7], v[6:7], v[58:59]
    v_cvt_pk_bf16_f32 v64, v4, v5
    v_cvt_pk_bf16_f32 v65, v6, v7
    v_and_b32 v56, s45, v39
    v_lshlrev_b32 v57, 16, v39
    v_and_b32 v58, s45, v38
    v_lshlrev_b32 v59, 16, v38
    v_pk_mul_f32 v[56:57], v[56:57], v[170:171] op_sel_hi:[1,0]
    v_pk_mul_f32 v[58:59], v[58:59], v[170:171] op_sel_hi:[1,0]
    v_cvt_pk_bf16_f32 v60, v56, v57
    v_lshlrev_b32 v56, 16, v60
    v_and_b32 v57, s45, v60
    v_cvt_pk_bf16_f32 v61, v58, v59
    v_lshlrev_b32 v58, 16, v61
    v_and_b32 v59, s45, v61
    v_cvt_pk_bf16_f32 v60, v8, v9
    v_lshlrev_b32 v8, 16, v60
    v_and_b32 v9, s45, v60
    v_cvt_pk_bf16_f32 v61, v10, v11
    v_lshlrev_b32 v10, 16, v61
    v_and_b32 v11, s45, v61
    v_pk_add_f32 v[8:9], v[8:9], v[56:57]
    v_pk_add_f32 v[10:11], v[10:11], v[58:59]
    v_cvt_pk_bf16_f32 v66, v8, v9
    v_cvt_pk_bf16_f32 v67, v10, v11
    s_nop 0
    v_permlane16_swap_b32 v64, v66
    v_permlane16_swap_b32 v65, v67
    global_store_dwordx4 v169, v[64:67], s[38:39] offset:0 sc0 sc1
    v_and_b32 v56, s45, v41
    v_lshlrev_b32 v57, 16, v41
    v_and_b32 v58, s45, v40
    v_lshlrev_b32 v59, 16, v40
    v_pk_mul_f32 v[56:57], v[56:57], v[170:171] op_sel_hi:[1,0]
    v_pk_mul_f32 v[58:59], v[58:59], v[170:171] op_sel_hi:[1,0]
    v_cvt_pk_bf16_f32 v60, v56, v57
    v_lshlrev_b32 v56, 16, v60
    v_and_b32 v57, s45, v60
    v_cvt_pk_bf16_f32 v61, v58, v59
    v_lshlrev_b32 v58, 16, v61
    v_and_b32 v59, s45, v61
    v_cvt_pk_bf16_f32 v60, v12, v13
    v_lshlrev_b32 v12, 16, v60
    v_and_b32 v13, s45, v60
    v_cvt_pk_bf16_f32 v61, v14, v15
    v_lshlrev_b32 v14, 16, v61
    v_and_b32 v15, s45, v61
    v_pk_add_f32 v[12:13], v[12:13], v[56:57]
    v_pk_add_f32 v[14:15], v[14:15], v[58:59]
    v_cvt_pk_bf16_f32 v68, v12, v13
    v_cvt_pk_bf16_f32 v69, v14, v15
    v_and_b32 v56, s45, v43
    v_lshlrev_b32 v57, 16, v43
    v_and_b32 v58, s45, v42
    v_lshlrev_b32 v59, 16, v42
    v_pk_mul_f32 v[56:57], v[56:57], v[170:171] op_sel_hi:[1,0]
    v_pk_mul_f32 v[58:59], v[58:59], v[170:171] op_sel_hi:[1,0]
    v_cvt_pk_bf16_f32 v60, v56, v57
    v_lshlrev_b32 v56, 16, v60
    v_and_b32 v57, s45, v60
    v_cvt_pk_bf16_f32 v61, v58, v59
    v_lshlrev_b32 v58, 16, v61
    v_and_b32 v59, s45, v61
    v_cvt_pk_bf16_f32 v60, v16, v17
    v_lshlrev_b32 v16, 16, v60
    v_and_b32 v17, s45, v60
    v_cvt_pk_bf16_f32 v61, v18, v19
    v_lshlrev_b32 v18, 16, v61
    v_and_b32 v19, s45, v61
    v_pk_add_f32 v[16:17], v[16:17], v[56:57]
    v_pk_add_f32 v[18:19], v[18:19], v[58:59]
    v_cvt_pk_bf16_f32 v70, v16, v17
    v_cvt_pk_bf16_f32 v71, v18, v19
    s_nop 0
    v_permlane16_swap_b32 v68, v70
    v_permlane16_swap_b32 v69, v71
    global_store_dwordx4 v169, v[68:71], s[38:39] offset:1024 sc0 sc1
    v_and_b32 v56, s45, v45
    v_lshlrev_b32 v57, 16, v45
    v_and_b32 v58, s45, v44
    v_lshlrev_b32 v59, 16, v44
    v_pk_mul_f32 v[56:57], v[56:57], v[170:171] op_sel_hi:[1,0]
    v_pk_mul_f32 v[58:59], v[58:59], v[170:171] op_sel_hi:[1,0]
    v_cvt_pk_bf16_f32 v60, v56, v57
    v_lshlrev_b32 v56, 16, v60
    v_and_b32 v57, s45, v60
    v_cvt_pk_bf16_f32 v61, v58, v59
    v_lshlrev_b32 v58, 16, v61
    v_and_b32 v59, s45, v61
    v_cvt_pk_bf16_f32 v60, v20, v21
    v_lshlrev_b32 v20, 16, v60
    v_and_b32 v21, s45, v60
    v_cvt_pk_bf16_f32 v61, v22, v23
    v_lshlrev_b32 v22, 16, v61
    v_and_b32 v23, s45, v61
    v_pk_add_f32 v[20:21], v[20:21], v[56:57]
    v_pk_add_f32 v[22:23], v[22:23], v[58:59]
    v_cvt_pk_bf16_f32 v72, v20, v21
    v_cvt_pk_bf16_f32 v73, v22, v23
    v_and_b32 v56, s45, v47
    v_lshlrev_b32 v57, 16, v47
    v_and_b32 v58, s45, v46
    v_lshlrev_b32 v59, 16, v46
    v_pk_mul_f32 v[56:57], v[56:57], v[170:171] op_sel_hi:[1,0]
    v_pk_mul_f32 v[58:59], v[58:59], v[170:171] op_sel_hi:[1,0]
    v_cvt_pk_bf16_f32 v60, v56, v57
    v_lshlrev_b32 v56, 16, v60
    v_and_b32 v57, s45, v60
    v_cvt_pk_bf16_f32 v61, v58, v59
    v_lshlrev_b32 v58, 16, v61
    v_and_b32 v59, s45, v61
    v_cvt_pk_bf16_f32 v60, v24, v25
    v_lshlrev_b32 v24, 16, v60
    v_and_b32 v25, s45, v60
    v_cvt_pk_bf16_f32 v61, v26, v27
    v_lshlrev_b32 v26, 16, v61
    v_and_b32 v27, s45, v61
    v_pk_add_f32 v[24:25], v[24:25], v[56:57]
    v_pk_add_f32 v[26:27], v[26:27], v[58:59]
    v_cvt_pk_bf16_f32 v74, v24, v25
    v_cvt_pk_bf16_f32 v75, v26, v27
    s_nop 0
    v_permlane16_swap_b32 v72, v74
    v_permlane16_swap_b32 v73, v75
    global_store_dwordx4 v169, v[72:75], s[38:39] offset:2048 sc0 sc1
    v_and_b32 v56, s45, v49
    v_lshlrev_b32 v57, 16, v49
    v_and_b32 v58, s45, v48
    v_lshlrev_b32 v59, 16, v48
    v_pk_mul_f32 v[56:57], v[56:57], v[170:171] op_sel_hi:[1,0]
    v_pk_mul_f32 v[58:59], v[58:59], v[170:171] op_sel_hi:[1,0]
    v_cvt_pk_bf16_f32 v60, v56, v57
    v_lshlrev_b32 v56, 16, v60
    v_and_b32 v57, s45, v60
    v_cvt_pk_bf16_f32 v61, v58, v59
    v_lshlrev_b32 v58, 16, v61
    v_and_b32 v59, s45, v61
    v_cvt_pk_bf16_f32 v60, v28, v29
    v_lshlrev_b32 v28, 16, v60
    v_and_b32 v29, s45, v60
    v_cvt_pk_bf16_f32 v61, v30, v31
    v_lshlrev_b32 v30, 16, v61
    v_and_b32 v31, s45, v61
    v_pk_add_f32 v[28:29], v[28:29], v[56:57]
    v_pk_add_f32 v[30:31], v[30:31], v[58:59]
    v_cvt_pk_bf16_f32 v76, v28, v29
    v_cvt_pk_bf16_f32 v77, v30, v31
    v_and_b32 v56, s45, v51
    v_lshlrev_b32 v57, 16, v51
    v_and_b32 v58, s45, v50
    v_lshlrev_b32 v59, 16, v50
    v_pk_mul_f32 v[56:57], v[56:57], v[170:171] op_sel_hi:[1,0]
    v_pk_mul_f32 v[58:59], v[58:59], v[170:171] op_sel_hi:[1,0]
    v_cvt_pk_bf16_f32 v60, v56, v57
    v_lshlrev_b32 v56, 16, v60
    v_and_b32 v57, s45, v60
    v_cvt_pk_bf16_f32 v61, v58, v59
    v_lshlrev_b32 v58, 16, v61
    v_and_b32 v59, s45, v61
    v_cvt_pk_bf16_f32 v60, v32, v33
    v_lshlrev_b32 v32, 16, v60
    v_and_b32 v33, s45, v60
    v_cvt_pk_bf16_f32 v61, v34, v35
    v_lshlrev_b32 v34, 16, v61
    v_and_b32 v35, s45, v61
    v_pk_add_f32 v[32:33], v[32:33], v[56:57]
    v_pk_add_f32 v[34:35], v[34:35], v[58:59]
    v_cvt_pk_bf16_f32 v78, v32, v33
    v_cvt_pk_bf16_f32 v79, v34, v35
    s_nop 0
    v_permlane16_swap_b32 v76, v78
    v_permlane16_swap_b32 v77, v79
    global_store_dwordx4 v169, v[76:79], s[38:39] offset:3072 sc0 sc1
    s_nop 1
    s_branch L_conv_done_29
L_conv_skip_28:
    s_cmp_lg_u32 s6, 3
    s_cbranch_scc1 L_iw_30
    s_waitcnt vmcnt(0)
    v_bfe_u32 v100, v1, 2, 2
    v_lshl_add_u32 v100, v3, 2, v100
    v_lshlrev_b32 v100, 7, v100
    v_and_b32 v101, 3, v1
    v_lshl_add_u32 v100, v101, 3, v100
    v_add_u32 v100, 125184, v100
    ds_read_b64_tr_b16 v[104:105], v100 offset:0
    ds_read_b64_tr_b16 v[106:107], v100 offset:2048
    ds_read_b64_tr_b16 v[108:109], v100 offset:32
    ds_read_b64_tr_b16 v[110:111], v100 offset:2080
    ds_read_b64_tr_b16 v[112:113], v100 offset:64
    ds_read_b64_tr_b16 v[114:115], v100 offset:2112
    ds_read_b64_tr_b16 v[116:117], v100 offset:96
    ds_read_b64_tr_b16 v[118:119], v100 offset:2144
    v_lshlrev_b32 v101, 4, v1
    v_add_u32 v101, s74, v101
    s_waitcnt lgkmcnt(0)
    global_store_dwordx4 v101, v[104:107], s[38:39] offset:0 sc0 sc1
    global_store_dwordx4 v101, v[108:111], s[38:39] offset:1024 sc0 sc1
    global_store_dwordx4 v101, v[112:115], s[38:39] offset:2048 sc0 sc1
    global_store_dwordx4 v101, v[116:119], s[38:39] offset:3072 sc0 sc1
    ds_read_b64_tr_b16 v[120:121], v100 offset:4096
    ds_read_b64_tr_b16 v[122:123], v100 offset:6144
    ds_read_b64_tr_b16 v[124:125], v100 offset:4128
    ds_read_b64_tr_b16 v[126:127], v100 offset:6176
    ds_read_b64_tr_b16 v[128:129], v100 offset:4160
    ds_read_b64_tr_b16 v[130:131], v100 offset:6208
    ds_read_b64_tr_b16 v[132:133], v100 offset:4192
    ds_read_b64_tr_b16 v[134:135], v100 offset:6240
    v_lshlrev_b32 v101, 4, v1
    v_add_u32 v101, s75, v101
    s_waitcnt lgkmcnt(0)
    global_store_dwordx4 v101, v[120:123], s[38:39] offset:0 sc0 sc1
    global_store_dwordx4 v101, v[124:127], s[38:39] offset:1024 sc0 sc1
    global_store_dwordx4 v101, v[128:131], s[38:39] offset:2048 sc0 sc1
    global_store_dwordx4 v101, v[132:135], s[38:39] offset:3072 sc0 sc1
    s_cmp_ge_u32 s2, 28
    s_nop 0
    s_cbranch_scc1 L_rf3_31
    ds_read_b64_tr_b16 v[136:137], v100 offset:8192
    ds_read_b64_tr_b16 v[138:139], v100 offset:10240
    ds_read_b64_tr_b16 v[140:141], v100 offset:8224
    ds_read_b64_tr_b16 v[142:143], v100 offset:10272
    ds_read_b64_tr_b16 v[144:145], v100 offset:8256
    ds_read_b64_tr_b16 v[146:147], v100 offset:10304
    ds_read_b64_tr_b16 v[148:149], v100 offset:8288
    ds_read_b64_tr_b16 v[150:151], v100 offset:10336
    v_lshlrev_b32 v101, 4, v1
    v_add_u32 v101, s76, v101
    s_waitcnt lgkmcnt(0)
    global_store_dwordx4 v101, v[136:139], s[38:39] offset:0 sc0 sc1
    global_store_dwordx4 v101, v[140:143], s[38:39] offset:1024 sc0 sc1
    global_store_dwordx4 v101, v[144:147], s[38:39] offset:2048 sc0 sc1
    global_store_dwordx4 v101, v[148:151], s[38:39] offset:3072 sc0 sc1
    s_nop 1
L_rf3_31:
    s_waitcnt vmcnt(0)
    s_lshl_b32 s50, s4, 8
    s_lshl_b32 s51, s5, 3
    s_add_u32 s50, s50, s51
    s_add_u32 s50, s50, 12288
    s_add_u32 s3, s28, 1
    v_mov_b32 v176, s3
    s_xor_b32 s3, s3, s29
    v_mov_b32 v177, s3
    v_mov_b32 v178, s50
    s_mov_b64 s[92:93], exec
    s_mov_b64 exec, 1
    global_store_dwordx2 v178, v[176:177], s[38:39] sc0 sc1
    s_mov_b64 exec, s[92:93]
    s_lshl_b32 s3, s4, 8
    s_lshl_b32 s50, s40, 6
    s_add_u32 s3, s3, s50
    s_lshl_b32 s50, s41, 3
    s_add_u32 s3, s3, s50
    v_and_b32 v160, 7, v1
    v_add_u32 v160, s3, v160
    v_lshlrev_b32 v160, 7, v160
    v_bfe_u32 v161, v1, 3, 2
    v_mul_u32_u24 v161, 262144, v161
    v_add_u32 v160, v160, v161
    v_add_u32 v160, 1048576, v160
    global_load_dword a0, v160, s[38:39]
    s_add_u32 s8, s30, 0
    s_addc_u32 s9, s31, 0
    s_and_b32 s9, s9, 0xffff
    s_mov_b32 s10, 2211840
    s_mov_b32 s11, 0x20000
    s_mul_i32 s3, s5, 69120
    v_lshlrev_b32 v160, 7, v1
    v_add_u32 v160, s3, v160
    buffer_load_dword a0, v160, s[8:11], 0 offen
    v_add_u32 v160, 8192, v160
    buffer_load_dword a0, v160, s[8:11], 0 offen
    v_add_u32 v160, 8192, v160
    buffer_load_dword a0, v160, s[8:11], 0 offen
    v_add_u32 v160, 8192, v160
    buffer_load_dword a0, v160, s[8:11], 0 offen
    v_add_u32 v160, 8192, v160
    buffer_load_dword a0, v160, s[8:11], 0 offen
    v_add_u32 v160, 8192, v160
    buffer_load_dword a0, v160, s[8:11], 0 offen
    v_add_u32 v160, 8192, v160
    buffer_load_dword a0, v160, s[8:11], 0 offen
    v_add_u32 v160, 8192, v160
    buffer_load_dword a0, v160, s[8:11], 0 offen
    v_add_u32 v160, 8192, v160
    s_mov_b64 s[92:93], exec
    s_mov_b64 exec, 0xfffffff
    buffer_load_dword a0, v160, s[8:11], 0 offen
    s_mov_b64 exec, s[92:93]
L_iw_30:
L_conv_done_29:
    v_lshlrev_b32 v160, 4, v2
    s_lshl_b32 s3, s6, 4
    v_add_u32 v160, s3, v2
    v_mul_u32_u24 v160, 160, v160
    v_lshl_add_u32 v160, v3, 3, v160
    v_add_u32 v160, 137472, v160
    ds_read_b64 v[222:223], v160 offset:0
    ds_read_b64 v[224:225], v160 offset:32
    ds_read_b64 v[226:227], v160 offset:64
    ds_read_b64 v[228:229], v160 offset:96
    ds_read_b64 v[230:231], v160 offset:128
    s_waitcnt lgkmcnt(0)
    v_lshlrev_b32 v124, 16, v222
    v_and_b32 v125, s45, v222
    v_lshlrev_b32 v126, 16, v223
    v_and_b32 v127, s45, v223
    v_lshlrev_b32 v128, 16, v224
    v_and_b32 v129, s45, v224
    v_lshlrev_b32 v130, 16, v225
    v_and_b32 v131, s45, v225
    v_lshlrev_b32 v132, 16, v226
    v_and_b32 v133, s45, v226
    v_lshlrev_b32 v134, 16, v227
    v_and_b32 v135, s45, v227
    v_lshlrev_b32 v136, 16, v228
    v_and_b32 v137, s45, v228
    v_lshlrev_b32 v138, 16, v229
    v_and_b32 v139, s45, v229
    v_lshlrev_b32 v140, 16, v230
    v_and_b32 v141, s45, v230
    v_lshlrev_b32 v142, 16, v231
    v_and_b32 v143, s45, v231
    v_pk_add_f32 v[144:145], v[124:125], v[126:127]
    v_pk_add_f32 v[146:147], v[128:129], v[130:131]
    v_pk_add_f32 v[144:145], v[144:145], v[132:133]
    v_pk_add_f32 v[146:147], v[146:147], v[134:135]
    v_pk_add_f32 v[144:145], v[144:145], v[136:137]
    v_pk_add_f32 v[146:147], v[146:147], v[138:139]
    v_pk_add_f32 v[144:145], v[144:145], v[140:141]
    v_pk_add_f32 v[146:147], v[146:147], v[142:143]
    v_pk_add_f32 v[144:145], v[144:145], v[146:147]
    v_add_f32 v144, v144, v145
    v_mov_b32 v148, v144
    s_nop 1
    v_permlane16_swap_b32 v144, v148
    v_add_f32 v144, v144, v148
    v_mov_b32 v148, v144
    s_nop 1
    v_permlane32_swap_b32 v144, v148
    v_add_f32 v144, v144, v148
    v_mul_f32 v144, 0x3c4ccccd, v144
    v_pk_add_f32 v[150:151], v[124:125], v[144:145] op_sel_hi:[1,0] neg_lo:[0,1] neg_hi:[0,1]
    v_pk_add_f32 v[152:153], v[126:127], v[144:145] op_sel_hi:[1,0] neg_lo:[0,1] neg_hi:[0,1]
    v_pk_add_f32 v[154:155], v[128:129], v[144:145] op_sel_hi:[1,0] neg_lo:[0,1] neg_hi:[0,1]
    v_pk_add_f32 v[156:157], v[130:131], v[144:145] op_sel_hi:[1,0] neg_lo:[0,1] neg_hi:[0,1]
    v_pk_add_f32 v[158:159], v[132:133], v[144:145] op_sel_hi:[1,0] neg_lo:[0,1] neg_hi:[0,1]
    v_pk_add_f32 v[160:161], v[134:135], v[144:145] op_sel_hi:[1,0] neg_lo:[0,1] neg_hi:[0,1]
    v_pk_add_f32 v[162:163], v[136:137], v[144:145] op_sel_hi:[1,0] neg_lo:[0,1] neg_hi:[0,1]
    v_pk_add_f32 v[164:165], v[138:139], v[144:145] op_sel_hi:[1,0] neg_lo:[0,1] neg_hi:[0,1]
    v_pk_add_f32 v[166:167], v[140:141], v[144:145] op_sel_hi:[1,0] neg_lo:[0,1] neg_hi:[0,1]
    v_pk_add_f32 v[168:169], v[142:143], v[144:145] op_sel_hi:[1,0] neg_lo:[0,1] neg_hi:[0,1]
    v_pk_mul_f32 v[170:171], v[150:151], v[150:151]
    v_pk_mul_f32 v[146:147], v[152:153], v[152:153]
    v_pk_fma_f32 v[170:171], v[154:155], v[154:155], v[170:171]
    v_pk_fma_f32 v[146:147], v[156:157], v[156:157], v[146:147]
    v_pk_fma_f32 v[170:171], v[158:159], v[158:159], v[170:171]
    v_pk_fma_f32 v[146:147], v[160:161], v[160:161], v[146:147]
    v_pk_fma_f32 v[170:171], v[162:163], v[162:163], v[170:171]
    v_pk_fma_f32 v[146:147], v[164:165], v[164:165], v[146:147]
    v_pk_fma_f32 v[170:171], v[166:167], v[166:167], v[170:171]
    v_pk_fma_f32 v[146:147], v[168:169], v[168:169], v[146:147]
    v_pk_add_f32 v[170:171], v[170:171], v[146:147]
    v_add_f32 v145, v170, v171
    s_add_u32 s3, s28, 0
    v_mov_b32 v146, s3
    v_mov_b32 v148, v145
    s_nop 1
    v_permlane16_swap_b32 v145, v148
    v_add_f32 v145, v145, v148
    v_mov_b32 v148, v145
    s_nop 1
    v_permlane32_swap_b32 v145, v148
    v_add_f32 v145, v145, v148
    s_xor_b32 s3, s3, s29
    v_mov_b32 v147, s3
    s_lshl_b32 s97, s4, 8
    s_lshl_b32 s100, s40, 6
    s_add_u32 s97, s97, s100
    s_lshl_b32 s100, s6, 4
    s_add_u32 s97, s97, s100
    v_add_u32 v149, s97, v2
    v_lshlrev_b32 v149, 7, v149
    s_lshl_b32 s100, s41, 4
    v_add_u32 v148, s100, v149
    v_lshl_add_u32 v149, v3, 5, v149
    s_add_u32 s66, s38, 1048576
    s_addc_u32 s67, s39, 0
    s_mov_b64 s[92:93], exec
    s_mov_b64 exec, 0xffff
    s_cmp_eq_u32 s7, 0
    s_cbranch_scc0 L_slow_32
    global_store_dwordx4 v148, v[144:147], s[66:67]
    s_nop 1
    s_branch L_sd_33
L_slow_32:
    global_store_dwordx4 v148, v[144:147], s[66:67] sc0 sc1
    s_nop 1
L_sd_33:
    s_mov_b64 exec, s[92:93]
    s_waitcnt lgkmcnt(0)
    s_cmp_eq_u32 s6, 3
    s_cbranch_scc1 L_iw_34
    s_waitcnt vmcnt(0)
L_iw_34:
    s_barrier
    s_cmp_lg_u32 s6, 0
    s_cbranch_scc1 L_iw_35
    s_lshl_b32 s50, s5, 3
    s_add_u32 s3, s28, 2
    v_mov_b32 v176, s3
    s_xor_b32 s3, s3, s29
    v_mov_b32 v177, s3
    v_mov_b32 v178, s50
    s_mov_b64 s[92:93], exec
    s_mov_b64 exec, 1
    s_cmp_eq_u32 s7, 0
    s_cbranch_scc0 L_slow_36
    global_store_dwordx2 v178, v[176:177], s[64:65]
    s_branch L_sd_37
L_slow_36:
    global_store_dwordx2 v178, v[176:177], s[64:65] sc0 sc1
L_sd_37:
    s_mov_b64 exec, s[92:93]
L_iw_35:
    s_lshl_b32 s3, s4, 8
    s_lshl_b32 s50, s40, 6
    s_add_u32 s3, s3, s50
    s_lshl_b32 s50, s6, 4
    s_add_u32 s3, s3, s50
    s_lshl_b32 s3, s3, 7
    s_add_u32 s3, s3, 1048576
    v_lshlrev_b32 v68, 7, v2
    v_lshl_add_u32 v68, v3, 5, v68
    v_add_u32 v68, s3, v68
    global_load_dwordx4 v[60:63], v68, s[38:39] offset:0 sc1
    global_load_dwordx4 v[64:67], v68, s[38:39] offset:16 sc1
    s_cmp_eq_u32 s6, 3
    s_cbranch_scc1 L_pc3_38
    s_cmp_lg_u32 s6, 1
    s_cbranch_scc1 L_iw_40
    s_add_u32 s66, s38, 12288
    s_addc_u32 s67, s39, 0
    v_lshlrev_b32 v159, 5, v1
    s_add_u32 s55, s28, 1
    s_mov_b32 s71, 400000
L_poll_41:
    global_load_dwordx4 v[144:147], v159, s[66:67] offset:0 sc1
    global_load_dwordx4 v[148:151], v159, s[66:67] offset:16 sc1
    s_sub_u32 s71, s71, 1
    s_cmp_eq_u32 s71, 0
    s_cbranch_scc1 L_abort
    s_waitcnt vmcnt(0)
    v_subrev_u32 v152, s55, v144
    v_cmp_lt_u32 vcc, 0, v152
    v_xor_b32 v152, v144, v145
    v_cmp_ne_u32 s[88:89], s29, v152
    s_or_b64 s[88:89], vcc, s[88:89]
    s_nop 3
    s_cbranch_scc1 L_poll_41
    v_subrev_u32 v152, s55, v146
    v_cmp_lt_u32 vcc, 0, v152
    v_xor_b32 v152, v146, v147
    v_cmp_ne_u32 s[88:89], s29, v152
    s_or_b64 s[88:89], vcc, s[88:89]
    s_nop 3
    s_cbranch_scc1 L_poll_41
    v_subrev_u32 v152, s55, v148
    v_cmp_lt_u32 vcc, 0, v152
    v_xor_b32 v152, v148, v149
    v_cmp_ne_u32 s[88:89], s29, v152
    s_or_b64 s[88:89], vcc, s[88:89]
    s_nop 3
    s_cbranch_scc1 L_poll_41
    v_subrev_u32 v152, s55, v150
    v_cmp_lt_u32 vcc, 0, v152
    v_xor_b32 v152, v150, v151
    v_cmp_ne_u32 s[88:89], s29, v152
    s_or_b64 s[88:89], vcc, s[88:89]
    s_nop 3
    s_cbranch_scc1 L_poll_41
L_iw_40:
    s_add_u32 s12, s30, 0
    s_addc_u32 s13, s31, 0
    s_and_b32 s13, s13, 0xffff
    s_mov_b32 s14, 2211840
    s_mov_b32 s15, 0x20000
    s_lshl_b32 s3, s6, 6
    s_add_u32 s3, s3, 0
    v_add_u32 v160, s3, v1
    s_mov_b32 s50, 306783379
    s_lshl_b32 s51, s44, 5
    s_movk_i32 s52, 3456
    s_lshl_b32 s53, s6, 10
    v_mul_hi_u32 v161, v160, s50
    v_mul_u32_u24 v162, 14, v161
    v_sub_u32 v162, v160, v162
    v_mul_lo_u32 v163, v161, s52
    v_lshl_add_u32 v163, v162, 4, v163
    s_add_u32 m0, s53, 0
    v_add_u32 v160, 192, v160
    buffer_load_dwordx4 v163, s[12:15], s51 offen lds
    v_mul_hi_u32 v161, v160, s50
    v_mul_u32_u24 v162, 14, v161
    v_sub_u32 v162, v160, v162
    v_mul_lo_u32 v163, v161, s52
    v_lshl_add_u32 v163, v162, 4, v163
    s_add_u32 m0, s53, 3072
    v_add_u32 v160, 192, v160
    buffer_load_dwordx4 v163, s[12:15], s51 offen lds
    v_mul_hi_u32 v161, v160, s50
    v_mul_u32_u24 v162, 14, v161
    v_sub_u32 v162, v160, v162
    v_mul_lo_u32 v163, v161, s52
    v_lshl_add_u32 v163, v162, 4, v163
    s_add_u32 m0, s53, 6144
    v_add_u32 v160, 192, v160
    buffer_load_dwordx4 v163, s[12:15], s51 offen lds
    v_mul_hi_u32 v161, v160, s50
    v_mul_u32_u24 v162, 14, v161
    v_sub_u32 v162, v160, v162
    v_mul_lo_u32 v163, v161, s52
    v_lshl_add_u32 v163, v162, 4, v163
    s_add_u32 m0, s53, 9216
    v_add_u32 v160, 192, v160
    buffer_load_dwordx4 v163, s[12:15], s51 offen lds
    v_mul_hi_u32 v161, v160, s50
    v_mul_u32_u24 v162, 14, v161
    v_sub_u32 v162, v160, v162
    v_mul_lo_u32 v163, v161, s52
    v_lshl_add_u32 v163, v162, 4, v163
    s_add_u32 m0, s53, 12288
    v_add_u32 v160, 192, v160
    buffer_load_dwordx4 v163, s[12:15], s51 offen lds
    v_mul_hi_u32 v161, v160, s50
    v_mul_u32_u24 v162, 14, v161
    v_sub_u32 v162, v160, v162
    v_mul_lo_u32 v163, v161, s52
    v_lshl_add_u32 v163, v162, 4, v163
    s_add_u32 m0, s53, 15360
    v_add_u32 v160, 192, v160
    buffer_load_dwordx4 v163, s[12:15], s51 offen lds
    v_mul_hi_u32 v161, v160, s50
    v_mul_u32_u24 v162, 14, v161
    v_sub_u32 v162, v160, v162
    v_mul_lo_u32 v163, v161, s52
    v_lshl_add_u32 v163, v162, 4, v163
    s_add_u32 m0, s53, 18432
    v_add_u32 v160, 192, v160
    buffer_load_dwordx4 v163, s[12:15], s51 offen lds
    v_mul_hi_u32 v161, v160, s50
    v_mul_u32_u24 v162, 14, v161
    v_sub_u32 v162, v160, v162
    v_mul_lo_u32 v163, v161, s52
    v_lshl_add_u32 v163, v162, 4, v163
    s_add_u32 m0, s53, 21504
    v_add_u32 v160, 192, v160
    buffer_load_dwordx4 v163, s[12:15], s51 offen lds
    v_mul_hi_u32 v161, v160, s50
    v_mul_u32_u24 v162, 14, v161
    v_sub_u32 v162, v160, v162
    v_mul_lo_u32 v163, v161, s52
    v_lshl_add_u32 v163, v162, 4, v163
    s_add_u32 m0, s53, 24576
    v_add_u32 v160, 192, v160
    buffer_load_dwordx4 v163, s[12:15], s51 offen lds
    v_mul_hi_u32 v161, v160, s50
    v_mul_u32_u24 v162, 14, v161
    v_sub_u32 v162, v160, v162
    v_mul_lo_u32 v163, v161, s52
    v_lshl_add_u32 v163, v162, 4, v163
    s_add_u32 m0, s53, 27648
    v_add_u32 v160, 192, v160
    buffer_load_dwordx4 v163, s[12:15], s51 offen lds
    v_mul_hi_u32 v161, v160, s50
    v_mul_u32_u24 v162, 14, v161
    v_sub_u32 v162, v160, v162
    v_mul_lo_u32 v163, v161, s52
    v_lshl_add_u32 v163, v162, 4, v163
    s_add_u32 m0, s53, 30720
    v_add_u32 v160, 192, v160
    buffer_load_dwordx4 v163, s[12:15], s51 offen lds
    v_mul_hi_u32 v161, v160, s50
    v_mul_u32_u24 v162, 14, v161
    v_sub_u32 v162, v160, v162
    v_mul_lo_u32 v163, v161, s52
    v_lshl_add_u32 v163, v162, 4, v163
    s_add_u32 m0, s53, 33792
    v_add_u32 v160, 192, v160
    buffer_load_dwordx4 v163, s[12:15], s51 offen lds
    v_mul_hi_u32 v161, v160, s50
    v_mul_u32_u24 v162, 14, v161
    v_sub_u32 v162, v160, v162
    v_mul_lo_u32 v163, v161, s52
    v_lshl_add_u32 v163, v162, 4, v163
    s_add_u32 m0, s53, 36864
    v_add_u32 v160, 192, v160
    buffer_load_dwordx4 v163, s[12:15], s51 offen lds
    v_mul_hi_u32 v161, v160, s50
    v_mul_u32_u24 v162, 14, v161
    v_sub_u32 v162, v160, v162
    v_mul_lo_u32 v163, v161, s52
    v_lshl_add_u32 v163, v162, 4, v163
    s_add_u32 m0, s53, 39936
    v_add_u32 v160, 192, v160
    buffer_load_dwordx4 v163, s[12:15], s51 offen lds
    v_mul_hi_u32 v161, v160, s50
    v_mul_u32_u24 v162, 14, v161
    v_sub_u32 v162, v160, v162
    v_mul_lo_u32 v163, v161, s52
    v_lshl_add_u32 v163, v162, 4, v163
    s_add_u32 m0, s53, 43008
    v_add_u32 v160, 192, v160
    buffer_load_dwordx4 v163, s[12:15], s51 offen lds
    v_mul_hi_u32 v161, v160, s50
    v_mul_u32_u24 v162, 14, v161
    v_sub_u32 v162, v160, v162
    v_mul_lo_u32 v163, v161, s52
    v_lshl_add_u32 v163, v162, 4, v163
    s_add_u32 m0, s53, 46080
    v_add_u32 v160, 192, v160
    buffer_load_dwordx4 v163, s[12:15], s51 offen lds
    v_mul_hi_u32 v161, v160, s50
    v_mul_u32_u24 v162, 14, v161
    v_sub_u32 v162, v160, v162
    v_mul_lo_u32 v163, v161, s52
    v_lshl_add_u32 v163, v162, 4, v163
    s_add_u32 m0, s53, 49152
    v_add_u32 v160, 192, v160
    buffer_load_dwordx4 v163, s[12:15], s51 offen lds
    v_mul_hi_u32 v161, v160, s50
    v_mul_u32_u24 v162, 14, v161
    v_sub_u32 v162, v160, v162
    v_mul_lo_u32 v163, v161, s52
    v_lshl_add_u32 v163, v162, 4, v163
    s_add_u32 m0, s53, 52224
    v_add_u32 v160, 192, v160
    buffer_load_dwordx4 v163, s[12:15], s51 offen lds
    v_mul_hi_u32 v161, v160, s50
    v_mul_u32_u24 v162, 14, v161
    v_sub_u32 v162, v160, v162
    v_mul_lo_u32 v163, v161, s52
    v_lshl_add_u32 v163, v162, 4, v163
    s_add_u32 m0, s53, 55296
    v_add_u32 v160, 192, v160
    buffer_load_dwordx4 v163, s[12:15], s51 offen lds
    v_mul_hi_u32 v161, v160, s50
    v_mul_u32_u24 v162, 14, v161
    v_sub_u32 v162, v160, v162
    v_mul_lo_u32 v163, v161, s52
    v_lshl_add_u32 v163, v162, 4, v163
    s_add_u32 m0, s53, 58368
    v_add_u32 v160, 192, v160
    buffer_load_dwordx4 v163, s[12:15], s51 offen lds
    v_mul_hi_u32 v161, v160, s50
    v_mul_u32_u24 v162, 14, v161
    v_sub_u32 v162, v160, v162
    v_mul_lo_u32 v163, v161, s52
    v_lshl_add_u32 v163, v162, 4, v163
    s_add_u32 m0, s53, 61440
    v_add_u32 v160, 192, v160
    buffer_load_dwordx4 v163, s[12:15], s51 offen lds
    v_mul_hi_u32 v161, v160, s50
    v_mul_u32_u24 v162, 14, v161
    v_sub_u32 v162, v160, v162
    v_mul_lo_u32 v163, v161, s52
    v_lshl_add_u32 v163, v162, 4, v163
    s_add_u32 m0, s53, 64512
    v_add_u32 v160, 192, v160
    buffer_load_dwordx4 v163, s[12:15], s51 offen lds
    v_mul_hi_u32 v161, v160, s50
    v_mul_u32_u24 v162, 14, v161
    v_sub_u32 v162, v160, v162
    v_mul_lo_u32 v163, v161, s52
    v_lshl_add_u32 v163, v162, 4, v163
    s_add_u32 m0, s53, 67584
    v_add_u32 v160, 192, v160
    buffer_load_dwordx4 v163, s[12:15], s51 offen lds
    v_mul_hi_u32 v161, v160, s50
    v_mul_u32_u24 v162, 14, v161
    v_sub_u32 v162, v160, v162
    v_mul_lo_u32 v163, v161, s52
    v_lshl_add_u32 v163, v162, 4, v163
    s_add_u32 m0, s53, 70656
    v_add_u32 v160, 192, v160
    buffer_load_dwordx4 v163, s[12:15], s51 offen lds
    v_mul_hi_u32 v161, v160, s50
    v_mul_u32_u24 v162, 14, v161
    v_sub_u32 v162, v160, v162
    v_mul_lo_u32 v163, v161, s52
    v_lshl_add_u32 v163, v162, 4, v163
    s_add_u32 m0, s53, 73728
    v_add_u32 v160, 192, v160
    buffer_load_dwordx4 v163, s[12:15], s51 offen lds
    v_mul_hi_u32 v161, v160, s50
    v_mul_u32_u24 v162, 14, v161
    v_sub_u32 v162, v160, v162
    v_mul_lo_u32 v163, v161, s52
    v_lshl_add_u32 v163, v162, 4, v163
    s_add_u32 m0, s53, 76800
    v_add_u32 v160, 192, v160
    buffer_load_dwordx4 v163, s[12:15], s51 offen lds
    v_mul_hi_u32 v161, v160, s50
    v_mul_u32_u24 v162, 14, v161
    v_sub_u32 v162, v160, v162
    v_mul_lo_u32 v163, v161, s52
    v_lshl_add_u32 v163, v162, 4, v163
    s_add_u32 m0, s53, 79872
    v_add_u32 v160, 192, v160
    buffer_load_dwordx4 v163, s[12:15], s51 offen lds
    v_mul_hi_u32 v161, v160, s50
    v_mul_u32_u24 v162, 14, v161
    v_sub_u32 v162, v160, v162
    v_mul_lo_u32 v163, v161, s52
    v_lshl_add_u32 v163, v162, 4, v163
    s_add_u32 m0, s53, 82944
    v_add_u32 v160, 192, v160
    buffer_load_dwordx4 v163, s[12:15], s51 offen lds
    v_mul_hi_u32 v161, v160, s50
    v_mul_u32_u24 v162, 14, v161
    v_sub_u32 v162, v160, v162
    v_mul_lo_u32 v163, v161, s52
    v_lshl_add_u32 v163, v162, 4, v163
    s_add_u32 m0, s53, 86016
    v_add_u32 v160, 192, v160
    buffer_load_dwordx4 v163, s[12:15], s51 offen lds
    v_mul_hi_u32 v161, v160, s50
    v_mul_u32_u24 v162, 14, v161
    v_sub_u32 v162, v160, v162
    v_mul_lo_u32 v163, v161, s52
    v_lshl_add_u32 v163, v162, 4, v163
    s_add_u32 m0, s53, 89088
    v_add_u32 v160, 192, v160
    buffer_load_dwordx4 v163, s[12:15], s51 offen lds
    v_mul_hi_u32 v161, v160, s50
    v_mul_u32_u24 v162, 14, v161
    v_sub_u32 v162, v160, v162
    v_mul_lo_u32 v163, v161, s52
    v_lshl_add_u32 v163, v162, 4, v163
    s_add_u32 m0, s53, 92160
    v_add_u32 v160, 192, v160
    buffer_load_dwordx4 v163, s[12:15], s51 offen lds
    v_mul_hi_u32 v161, v160, s50
    v_mul_u32_u24 v162, 14, v161
    v_sub_u32 v162, v160, v162
    v_mul_lo_u32 v163, v161, s52
    v_lshl_add_u32 v163, v162, 4, v163
    s_add_u32 m0, s53, 95232
    v_add_u32 v160, 192, v160
    buffer_load_dwordx4 v163, s[12:15], s51 offen lds
    v_mul_hi_u32 v161, v160, s50
    v_mul_u32_u24 v162, 14, v161
    v_sub_u32 v162, v160, v162
    v_mul_lo_u32 v163, v161, s52
    v_lshl_add_u32 v163, v162, 4, v163
    s_add_u32 m0, s53, 98304
    v_add_u32 v160, 192, v160
    buffer_load_dwordx4 v163, s[12:15], s51 offen lds
    v_mul_hi_u32 v161, v160, s50
    v_mul_u32_u24 v162, 14, v161
    v_sub_u32 v162, v160, v162
    v_mul_lo_u32 v163, v161, s52
    v_lshl_add_u32 v163, v162, 4, v163
    s_add_u32 m0, s53, 101376
    v_add_u32 v160, 192, v160
    buffer_load_dwordx4 v163, s[12:15], s51 offen lds
    v_mul_hi_u32 v161, v160, s50
    v_mul_u32_u24 v162, 14, v161
    v_sub_u32 v162, v160, v162
    v_mul_lo_u32 v163, v161, s52
    v_lshl_add_u32 v163, v162, 4, v163
    s_add_u32 m0, s53, 104448
    v_add_u32 v160, 192, v160
    buffer_load_dwordx4 v163, s[12:15], s51 offen lds
    v_mul_hi_u32 v161, v160, s50
    v_mul_u32_u24 v162, 14, v161
    v_sub_u32 v162, v160, v162
    v_mul_lo_u32 v163, v161, s52
    v_lshl_add_u32 v163, v162, 4, v163
    s_add_u32 m0, s53, 107520
    v_add_u32 v160, 192, v160
    buffer_load_dwordx4 v163, s[12:15], s51 offen lds
    v_mul_hi_u32 v161, v160, s50
    v_mul_u32_u24 v162, 14, v161
    v_sub_u32 v162, v160, v162
    v_mul_lo_u32 v163, v161, s52
    v_lshl_add_u32 v163, v162, 4, v163
    s_add_u32 m0, s53, 110592
    v_add_u32 v160, 192, v160
    buffer_load_dwordx4 v163, s[12:15], s51 offen lds
    v_mul_hi_u32 v161, v160, s50
    v_mul_u32_u24 v162, 14, v161
    v_sub_u32 v162, v160, v162
    v_mul_lo_u32 v163, v161, s52
    v_lshl_add_u32 v163, v162, 4, v163
    s_add_u32 m0, s53, 113664
    v_add_u32 v160, 192, v160
    buffer_load_dwordx4 v163, s[12:15], s51 offen lds
    v_mul_hi_u32 v161, v160, s50
    v_mul_u32_u24 v162, 14, v161
    v_sub_u32 v162, v160, v162
    v_mul_lo_u32 v163, v161, s52
    v_lshl_add_u32 v163, v162, 4, v163
    s_add_u32 m0, s53, 116736
    v_add_u32 v160, 192, v160
    buffer_load_dwordx4 v163, s[12:15], s51 offen lds
    v_mul_hi_u32 v161, v160, s50
    v_mul_u32_u24 v162, 14, v161
    v_sub_u32 v162, v160, v162
    v_mul_lo_u32 v163, v161, s52
    v_lshl_add_u32 v163, v162, 4, v163
    s_add_u32 m0, s53, 119808
    v_add_u32 v160, 192, v160
    buffer_load_dwordx4 v163, s[12:15], s51 offen lds
    v_mul_hi_u32 v161, v160, s50
    v_mul_u32_u24 v162, 14, v161
    v_sub_u32 v162, v160, v162
    v_mul_lo_u32 v163, v161, s52
    v_lshl_add_u32 v163, v162, 4, v163
    s_add_u32 m0, s53, 122880
    v_add_u32 v160, 192, v160
    buffer_load_dwordx4 v163, s[12:15], s51 offen lds
    v_mul_hi_u32 v161, v160, s50
    v_mul_u32_u24 v162, 14, v161
    v_sub_u32 v162, v160, v162
    v_mul_lo_u32 v163, v161, s52
    v_lshl_add_u32 v163, v162, 4, v163
    s_add_u32 m0, s53, 125952
    v_add_u32 v160, 192, v160
    buffer_load_dwordx4 v163, s[12:15], s51 offen lds
    v_mul_hi_u32 v161, v160, s50
    v_mul_u32_u24 v162, 14, v161
    v_sub_u32 v162, v160, v162
    v_mul_lo_u32 v163, v161, s52
    v_lshl_add_u32 v163, v162, 4, v163
    s_add_u32 m0, s53, 129024
    v_add_u32 v160, 192, v160
    buffer_load_dwordx4 v163, s[12:15], s51 offen lds
    v_mul_hi_u32 v161, v160, s50
    v_mul_u32_u24 v162, 14, v161
    v_sub_u32 v162, v160, v162
    v_mul_lo_u32 v163, v161, s52
    v_lshl_add_u32 v163, v162, 4, v163
    s_add_u32 m0, s53, 132096
    v_add_u32 v160, 192, v160
    buffer_load_dwordx4 v163, s[12:15], s51 offen lds
    v_mul_hi_u32 v161, v160, s50
    v_mul_u32_u24 v162, 14, v161
    v_sub_u32 v162, v160, v162
    v_mul_lo_u32 v163, v161, s52
    v_lshl_add_u32 v163, v162, 4, v163
    s_add_u32 m0, s53, 135168
    v_add_u32 v160, 192, v160
    buffer_load_dwordx4 v163, s[12:15], s51 offen lds
    v_mul_hi_u32 v161, v160, s50
    v_mul_u32_u24 v162, 14, v161
    v_sub_u32 v162, v160, v162
    v_mul_lo_u32 v163, v161, s52
    v_lshl_add_u32 v163, v162, 4, v163
    s_add_u32 m0, s53, 138240
    v_add_u32 v160, 192, v160
    buffer_load_dwordx4 v163, s[12:15], s51 offen lds
    s_cmp_eq_u32 s6, 2
    s_cbranch_scc1 L_w1l_42
    v_mul_hi_u32 v161, v160, s50
    v_mul_u32_u24 v162, 14, v161
    v_sub_u32 v162, v160, v162
    v_mul_lo_u32 v163, v161, s52
    v_lshl_add_u32 v163, v162, 4, v163
    s_add_u32 m0, s53, 141312
    v_add_u32 v160, 192, v160
    buffer_load_dwordx4 v163, s[12:15], s51 offen lds
    s_nop 0
L_w1l_42:
    s_waitcnt vmcnt(47)
    s_branch L_pcd_39
L_pc3_38:
    v_and_b32 v180, 31, v1
    v_lshlrev_b32 v180, 3, v180
    s_add_u32 s55, s28, 2
    s_mov_b32 s71, 400000
L_poll_43:
    global_load_dwordx2 v[176:177], v180, s[64:65] sc1
    s_sub_u32 s71, s71, 1
    s_cmp_eq_u32 s71, 0
    s_cbranch_scc1 L_abort
    s_waitcnt vmcnt(0)
    v_subrev_u32 v178, s55, v176
    v_cmp_lt_u32 vcc, 5, v178
    v_xor_b32 v178, v176, v177
    v_cmp_ne_u32 s[88:89], s29, v178
    s_or_b64 s[88:89], vcc, s[88:89]
    s_nop 3
    s_cbranch_scc1 L_poll_43
    s_cmp_lg_u32 s5, 0
    s_cbranch_scc1 L_ylead_44
    s_lshl_b32 s50, s4, 8
    s_add_u32 s50, s50, 8192
    s_add_u32 s3, s28, 1
    v_mov_b32 v176, s3
    s_xor_b32 s3, s3, s29
    v_mov_b32 v177, s3
    v_mov_b32 v178, s50
    s_mov_b64 s[92:93], exec
    s_mov_b64 exec, 1
    global_store_dwordx2 v178, v[176:177], s[38:39] sc0 sc1
    s_mov_b64 exec, s[92:93]
L_ylead_44:
L_pcd_39:
    s_add_u32 s55, s28, 0
    s_mov_b32 s71, 400000
L_rsr_45:
    v_subrev_u32 v69, s55, v62
    v_cmp_lt_u32 vcc, 0, v69
    v_xor_b32 v69, v62, v63
    v_cmp_ne_u32 s[88:89], s29, v69
    s_or_b64 s[88:89], vcc, s[88:89]
    s_mov_b64 s[68:69], s[88:89]
    v_subrev_u32 v69, s55, v66
    v_cmp_lt_u32 vcc, 0, v69
    v_xor_b32 v69, v66, v67
    v_cmp_ne_u32 s[88:89], s29, v69
    s_or_b64 s[88:89], vcc, s[88:89]
    s_or_b64 s[88:89], s[88:89], s[68:69]
    s_nop 2
    s_cbranch_scc0 L_rso_46
    s_sub_u32 s71, s71, 1
    s_cmp_eq_u32 s71, 0
    s_cbranch_scc1 L_abort
    global_load_dwordx4 v[60:63], v68, s[38:39] offset:0 sc1
    global_load_dwordx4 v[64:67], v68, s[38:39] offset:16 sc1
    s_waitcnt vmcnt(0)
    s_branch L_rsr_45
L_rso_46:
    v_mov_b32 v62, v64
    v_mov_b32 v63, v65
    v_add_f32 v64, v60, v62
    v_mov_b32 v65, v64
    s_nop 1
    v_permlane16_swap_b32 v64, v65
    v_add_f32 v64, v64, v65
    v_mov_b32 v65, v64
    s_nop 1
    v_permlane32_swap_b32 v64, v65
    v_add_f32 v64, v64, v65
    v_mul_f32 v64, 0x3e000000, v64
    v_sub_f32 v60, v60, v64
    v_sub_f32 v62, v62, v64
    v_mul_f32 v60, v60, v60
    v_fmac_f32 v60, v62, v62
    v_add_f32 v61, v61, v63
    v_mov_b32 v65, 0x42a00000
    v_fmac_f32 v61, v60, v65
    v_mov_b32 v65, v61
    s_nop 1
    v_permlane16_swap_b32 v61, v65
    v_add_f32 v61, v61, v65
    v_mov_b32 v65, v61
    s_nop 1
    v_permlane32_swap_b32 v61, v65
    v_add_f32 v61, v61, v65
    v_mul_f32 v61, 0x3acccccd, v61
    v_cvt_pk_bf16_f32 v65, v61, v61
    v_lshlrev_b32 v61, 16, v65
    v_add_f32 v61, 0x3727c5ac, v61
    v_cvt_pk_bf16_f32 v65, v61, v61
    v_lshlrev_b32 v61, 16, v65
    v_sqrt_f32 v61, v61
    s_nop 0
    v_cvt_pk_bf16_f32 v65, v61, v61
    v_lshlrev_b32 v61, 16, v65
    v_rcp_f32 v26, v61
    v_cvt_pk_bf16_f32 v65, v64, v64
    v_lshlrev_b32 v64, 16, v65
    v_mov_b32 v24, v64
    v_lshlrev_b32 v4, 16, v222
    v_and_b32 v5, s45, v222
    v_lshlrev_b32 v6, 16, v223
    v_and_b32 v7, s45, v223
    v_lshlrev_b32 v8, 16, v224
    v_and_b32 v9, s45, v224
    v_lshlrev_b32 v10, 16, v225
    v_and_b32 v11, s45, v225
    v_lshlrev_b32 v12, 16, v226
    v_and_b32 v13, s45, v226
    v_lshlrev_b32 v14, 16, v227
    v_and_b32 v15, s45, v227
    v_lshlrev_b32 v16, 16, v228
    v_and_b32 v17, s45, v228
    v_lshlrev_b32 v18, 16, v229
    v_and_b32 v19, s45, v229
    v_lshlrev_b32 v20, 16, v230
    v_and_b32 v21, s45, v230
    v_lshlrev_b32 v22, 16, v231
    v_and_b32 v23, s45, v231
    v_pk_add_f32 v[28:29], v[4:5], v[24:25] op_sel_hi:[1,0] neg_lo:[0,1] neg_hi:[0,1]
    v_cvt_pk_bf16_f32 v30, v28, v29
    v_lshlrev_b32 v28, 16, v30
    v_and_b32 v29, s45, v30
    v_pk_mul_f32 v[28:29], v[28:29], v[26:27] op_sel_hi:[1,0]
    v_cvt_pk_bf16_f32 v184, v28, v29
    v_pk_add_f32 v[28:29], v[6:7], v[24:25] op_sel_hi:[1,0] neg_lo:[0,1] neg_hi:[0,1]
    v_cvt_pk_bf16_f32 v30, v28, v29
    v_lshlrev_b32 v28, 16, v30
    v_and_b32 v29, s45, v30
    v_pk_mul_f32 v[28:29], v[28:29], v[26:27] op_sel_hi:[1,0]
    v_cvt_pk_bf16_f32 v185, v28, v29
    v_pk_add_f32 v[28:29], v[8:9], v[24:25] op_sel_hi:[1,0] neg_lo:[0,1] neg_hi:[0,1]
    v_cvt_pk_bf16_f32 v30, v28, v29
    v_lshlrev_b32 v28, 16, v30
    v_and_b32 v29, s45, v30
    v_pk_mul_f32 v[28:29], v[28:29], v[26:27] op_sel_hi:[1,0]
    v_cvt_pk_bf16_f32 v186, v28, v29
    v_pk_add_f32 v[28:29], v[10:11], v[24:25] op_sel_hi:[1,0] neg_lo:[0,1] neg_hi:[0,1]
    v_cvt_pk_bf16_f32 v30, v28, v29
    v_lshlrev_b32 v28, 16, v30
    v_and_b32 v29, s45, v30
    v_pk_mul_f32 v[28:29], v[28:29], v[26:27] op_sel_hi:[1,0]
    v_cvt_pk_bf16_f32 v187, v28, v29
    v_pk_add_f32 v[28:29], v[12:13], v[24:25] op_sel_hi:[1,0] neg_lo:[0,1] neg_hi:[0,1]
    v_cvt_pk_bf16_f32 v30, v28, v29
    v_lshlrev_b32 v28, 16, v30
    v_and_b32 v29, s45, v30
    v_pk_mul_f32 v[28:29], v[28:29], v[26:27] op_sel_hi:[1,0]
    v_cvt_pk_bf16_f32 v188, v28, v29
    v_pk_add_f32 v[28:29], v[14:15], v[24:25] op_sel_hi:[1,0] neg_lo:[0,1] neg_hi:[0,1]
    v_cvt_pk_bf16_f32 v30, v28, v29
    v_lshlrev_b32 v28, 16, v30
    v_and_b32 v29, s45, v30
    v_pk_mul_f32 v[28:29], v[28:29], v[26:27] op_sel_hi:[1,0]
    v_cvt_pk_bf16_f32 v189, v28, v29
    v_pk_add_f32 v[28:29], v[16:17], v[24:25] op_sel_hi:[1,0] neg_lo:[0,1] neg_hi:[0,1]
    v_cvt_pk_bf16_f32 v30, v28, v29
    v_lshlrev_b32 v28, 16, v30
    v_and_b32 v29, s45, v30
    v_pk_mul_f32 v[28:29], v[28:29], v[26:27] op_sel_hi:[1,0]
    v_cvt_pk_bf16_f32 v190, v28, v29
    v_pk_add_f32 v[28:29], v[18:19], v[24:25] op_sel_hi:[1,0] neg_lo:[0,1] neg_hi:[0,1]
    v_cvt_pk_bf16_f32 v30, v28, v29
    v_lshlrev_b32 v28, 16, v30
    v_and_b32 v29, s45, v30
    v_pk_mul_f32 v[28:29], v[28:29], v[26:27] op_sel_hi:[1,0]
    v_cvt_pk_bf16_f32 v191, v28, v29
    v_pk_add_f32 v[28:29], v[20:21], v[24:25] op_sel_hi:[1,0] neg_lo:[0,1] neg_hi:[0,1]
    v_cvt_pk_bf16_f32 v30, v28, v29
    v_lshlrev_b32 v28, 16, v30
    v_and_b32 v29, s45, v30
    v_pk_mul_f32 v[28:29], v[28:29], v[26:27] op_sel_hi:[1,0]
    v_cvt_pk_bf16_f32 v192, v28, v29
    v_pk_add_f32 v[28:29], v[22:23], v[24:25] op_sel_hi:[1,0] neg_lo:[0,1] neg_hi:[0,1]
    v_cvt_pk_bf16_f32 v30, v28, v29
    v_lshlrev_b32 v28, 16, v30
    v_and_b32 v29, s45, v30
    v_pk_mul_f32 v[28:29], v[28:29], v[26:27] op_sel_hi:[1,0]
    v_cvt_pk_bf16_f32 v193, v28, v29
    s_cmp_lg_u32 s6, 3
    s_nop 0
    s_cbranch_scc1 L_iw_47
    s_lshl_b32 s3, s41, 8
    s_add_u32 s66, s38, 8192
    s_addc_u32 s67, s39, 0
    s_add_u32 s66, s66, s3
    s_addc_u32 s67, s67, 0
    v_mov_b32 v180, 0
    s_add_u32 s55, s28, 1
    s_mov_b32 s71, 400000
L_poll_48:
    global_load_dwordx2 v[176:177], v180, s[66:67] sc1
    s_sub_u32 s71, s71, 1
    s_cmp_eq_u32 s71, 0
    s_cbranch_scc1 L_abort
    s_waitcnt vmcnt(0)
    v_subrev_u32 v178, s55, v176
    v_cmp_lt_u32 vcc, 0, v178
    v_xor_b32 v178, v176, v177
    v_cmp_ne_u32 s[88:89], s29, v178
    s_or_b64 s[88:89], vcc, s[88:89]
    s_nop 3
    s_cbranch_scc1 L_poll_48
    s_mul_i32 s3, s41, 327680
    s_lshl_b32 s50, s4, 9
    s_add_u32 s3, s3, s50
    s_lshl_b32 s50, s40, 7
    s_add_u32 s3, s3, s50
    s_add_u32 s66, s38, 5242880
    s_addc_u32 s67, s39, 0
    s_add_u32 s66, s66, s3
    s_addc_u32 s67, s67, 0
    v_lshrrev_b32 v164, 3, v1
    v_lshlrev_b32 v164, 12, v164
    v_and_b32 v165, 7, v1
    v_lshl_add_u32 v164, v165, 4, v164
    s_mov_b32 m0, 143360
    v_add_u32 v165, 0, v164
    global_load_lds_dwordx4 v165, s[66:67]
    s_mov_b32 m0, 144384
    v_add_u32 v165, 32768, v164
    global_load_lds_dwordx4 v165, s[66:67]
    s_mov_b32 m0, 145408
    v_add_u32 v165, 65536, v164
    global_load_lds_dwordx4 v165, s[66:67]
    s_mov_b32 m0, 146432
    v_add_u32 v165, 98304, v164
    global_load_lds_dwordx4 v165, s[66:67]
    s_mov_b32 m0, 147456
    v_add_u32 v165, 131072, v164
    global_load_lds_dwordx4 v165, s[66:67]
    s_mov_b32 m0, 148480
    v_add_u32 v165, 163840, v164
    global_load_lds_dwordx4 v165, s[66:67]
    s_mov_b32 m0, 149504
    v_add_u32 v165, 196608, v164
    global_load_lds_dwordx4 v165, s[66:67]
    s_mov_b32 m0, 150528
    v_add_u32 v165, 229376, v164
    global_load_lds_dwordx4 v165, s[66:67]
    s_mov_b32 m0, 151552
    v_add_u32 v165, 262144, v164
    global_load_lds_dwordx4 v165, s[66:67]
    s_mov_b32 m0, 152576
    v_add_u32 v165, 294912, v164
    global_load_lds_dwordx4 v165, s[66:67]
    s_waitcnt vmcnt(0)
L_iw_47:
    s_barrier
    v_lshlrev_b32 v163, 4, v1
    s_add_u32 s61, s60, 0
    buffer_load_dwordx4 a[0:3], v163, s[56:59], s61 offen offset:0
    buffer_load_dwordx4 a[4:7], v163, s[56:59], s61 offen offset:1024
    buffer_load_dwordx4 a[8:11], v163, s[56:59], s61 offen offset:2048
    buffer_load_dwordx4 a[12:15], v163, s[56:59], s61 offen offset:3072
    s_add_u32 s61, s60, 4096
    buffer_load_dwordx4 a[16:19], v163, s[56:59], s61 offen offset:0
    s_add_u32 s61, s60, 40960
    buffer_load_dwordx4 a[20:23], v163, s[56:59], s61 offen offset:0
    buffer_load_dwordx4 a[24:27], v163, s[56:59], s61 offen offset:1024
    buffer_load_dwordx4 a[28:31], v163, s[56:59], s61 offen offset:2048
    buffer_load_dwordx4 a[32:35], v163, s[56:59], s61 offen offset:3072
    s_add_u32 s61, s60, 45056
    buffer_load_dwordx4 a[36:39], v163, s[56:59], s61 offen offset:0
    s_add_u32 s61, s60, 81920
    buffer_load_dwordx4 a[40:43], v163, s[56:59], s61 offen offset:0
    buffer_load_dwordx4 a[44:47], v163, s[56:59], s61 offen offset:1024
    buffer_load_dwordx4 a[48:51], v163, s[56:59], s61 offen offset:2048
    buffer_load_dwordx4 a[52:55], v163, s[56:59], s61 offen offset:3072
    s_add_u32 s61, s60, 86016
    buffer_load_dwordx4 a[56:59], v163, s[56:59], s61 offen offset:0
    s_add_u32 s61, s60, 122880
    buffer_load_dwordx4 a[60:63], v163, s[56:59], s61 offen offset:0
    buffer_load_dwordx4 a[64:67], v163, s[56:59], s61 offen offset:1024
    buffer_load_dwordx4 a[68:71], v163, s[56:59], s61 offen offset:2048
    buffer_load_dwordx4 a[72:75], v163, s[56:59], s61 offen offset:3072
    s_add_u32 s61, s60, 126976
    buffer_load_dwordx4 a[76:79], v163, s[56:59], s61 offen offset:0
    s_add_u32 s61, s60, 163840
    buffer_load_dwordx4 a[80:83], v163, s[56:59], s61 offen offset:0
    buffer_load_dwordx4 a[84:87], v163, s[56:59], s61 offen offset:1024
    v_bfe_u32 v164, v1, 2, 2
    v_lshl_add_u32 v164, v3, 2, v164
    v_lshlrev_b32 v164, 7, v164
    v_and_b32 v165, 3, v1
    v_lshl_add_u32 v164, v165, 3, v164
    s_lshl_b32 s3, s6, 5
    s_add_u32 s3, s3, 143360
    v_add_u32 v164, s3, v164
    ds_read_b64_tr_b16 v[212:213], v164 offset:0
    ds_read_b64_tr_b16 v[214:215], v164 offset:2048
    ds_read_b64_tr_b16 v[216:217], v164 offset:4096
    ds_read_b64_tr_b16 v[218:219], v164 offset:6144
    ds_read_b64_tr_b16 v[220:221], v164 offset:8192
    s_lshl_b32 s97, s4, 4
    s_lshl_b32 s100, s40, 2
    s_add_u32 s97, s97, s100
    s_add_u32 s97, s97, s6
    s_mul_i32 s97, s97, 20480
    s_add_u32 s97, s97, s90
    v_lshlrev_b32 v170, 4, v1
    v_add_u32 v170, s97, v170
    s_mul_i32 s97, s41, 5
    s_add_u32 s100, s97, 0
    s_lshr_b32 s101, s100, 1
    s_lshl_b32 s101, s101, 10
    s_and_b32 s100, s100, 1
    s_lshl_b32 s100, s100, 3
    s_add_u32 s100, s100, s101
    v_add_u32 v165, s100, v170
    s_add_u32 s100, s97, 1
    s_lshr_b32 s101, s100, 1
    s_lshl_b32 s101, s101, 10
    s_and_b32 s100, s100, 1
    s_lshl_b32 s100, s100, 3
    s_add_u32 s100, s100, s101
    v_add_u32 v166, s100, v170
    s_add_u32 s100, s97, 2
    s_lshr_b32 s101, s100, 1
    s_lshl_b32 s101, s101, 10
    s_and_b32 s100, s100, 1
    s_lshl_b32 s100, s100, 3
    s_add_u32 s100, s100, s101
    v_add_u32 v167, s100, v170
    s_add_u32 s100, s97, 3
    s_lshr_b32 s101, s100, 1
    s_lshl_b32 s101, s101, 10
    s_and_b32 s100, s100, 1
    s_lshl_b32 s100, s100, 3
    s_add_u32 s100, s100, s101
    v_add_u32 v168, s100, v170
    s_add_u32 s100, s97, 4
    s_lshr_b32 s101, s100, 1
    s_lshl_b32 s101, s101, 10
    s_and_b32 s100, s100, 1
    s_lshl_b32 s100, s100, 3
    s_add_u32 s100, s100, s101
    v_add_u32 v169, s100, v170
    s_waitcnt lgkmcnt(0)
    v_lshlrev_b32 v32, 16, v212
    v_and_b32 v33, s45, v212
    v_lshlrev_b32 v34, 16, v184
    v_and_b32 v35, s45, v184
    v_pk_mul_f32 v[28:29], v[32:33], v[34:35]
    v_cvt_pk_bf16_f32 v30, v28, v29
    v_lshlrev_b32 v28, 16, v30
    v_and_b32 v29, s45, v30
    v_pk_add_f32 v[4:5], v[4:5], v[28:29]
    v_cvt_pk_bf16_f32 v222, v4, v5
    v_lshlrev_b32 v4, 16, v222
    v_and_b32 v5, s45, v222
    v_lshlrev_b32 v32, 16, v213
    v_and_b32 v33, s45, v213
    v_lshlrev_b32 v34, 16, v185
    v_and_b32 v35, s45, v185
    v_pk_mul_f32 v[28:29], v[32:33], v[34:35]
    v_cvt_pk_bf16_f32 v30, v28, v29
    v_lshlrev_b32 v28, 16, v30
    v_and_b32 v29, s45, v30
    v_pk_add_f32 v[6:7], v[6:7], v[28:29]
    v_cvt_pk_bf16_f32 v223, v6, v7
    v_lshlrev_b32 v6, 16, v223
    v_and_b32 v7, s45, v223
    v_lshlrev_b32 v32, 16, v214
    v_and_b32 v33, s45, v214
    v_lshlrev_b32 v34, 16, v186
    v_and_b32 v35, s45, v186
    v_pk_mul_f32 v[28:29], v[32:33], v[34:35]
    v_cvt_pk_bf16_f32 v30, v28, v29
    v_lshlrev_b32 v28, 16, v30
    v_and_b32 v29, s45, v30
    v_pk_add_f32 v[8:9], v[8:9], v[28:29]
    v_cvt_pk_bf16_f32 v224, v8, v9
    v_lshlrev_b32 v8, 16, v224
    v_and_b32 v9, s45, v224
    v_lshlrev_b32 v32, 16, v215
    v_and_b32 v33, s45, v215
    v_lshlrev_b32 v34, 16, v187
    v_and_b32 v35, s45, v187
    v_pk_mul_f32 v[28:29], v[32:33], v[34:35]
    v_cvt_pk_bf16_f32 v30, v28, v29
    v_lshlrev_b32 v28, 16, v30
    v_and_b32 v29, s45, v30
    v_pk_add_f32 v[10:11], v[10:11], v[28:29]
    v_cvt_pk_bf16_f32 v225, v10, v11
    v_lshlrev_b32 v10, 16, v225
    v_and_b32 v11, s45, v225
    v_lshlrev_b32 v32, 16, v216
    v_and_b32 v33, s45, v216
    v_lshlrev_b32 v34, 16, v188
    v_and_b32 v35, s45, v188
    v_pk_mul_f32 v[28:29], v[32:33], v[34:35]
    v_cvt_pk_bf16_f32 v30, v28, v29
    v_lshlrev_b32 v28, 16, v30
    v_and_b32 v29, s45, v30
    v_pk_add_f32 v[12:13], v[12:13], v[28:29]
    v_cvt_pk_bf16_f32 v226, v12, v13
    v_lshlrev_b32 v12, 16, v226
    v_and_b32 v13, s45, v226
    v_lshlrev_b32 v32, 16, v217
    v_and_b32 v33, s45, v217
    v_lshlrev_b32 v34, 16, v189
    v_and_b32 v35, s45, v189
    v_pk_mul_f32 v[28:29], v[32:33], v[34:35]
    v_cvt_pk_bf16_f32 v30, v28, v29
    v_lshlrev_b32 v28, 16, v30
    v_and_b32 v29, s45, v30
    v_pk_add_f32 v[14:15], v[14:15], v[28:29]
    v_cvt_pk_bf16_f32 v227, v14, v15
    v_lshlrev_b32 v14, 16, v227
    v_and_b32 v15, s45, v227
    v_lshlrev_b32 v32, 16, v218
    v_and_b32 v33, s45, v218
    v_lshlrev_b32 v34, 16, v190
    v_and_b32 v35, s45, v190
    v_pk_mul_f32 v[28:29], v[32:33], v[34:35]
    v_cvt_pk_bf16_f32 v30, v28, v29
    v_lshlrev_b32 v28, 16, v30
    v_and_b32 v29, s45, v30
    v_pk_add_f32 v[16:17], v[16:17], v[28:29]
    v_cvt_pk_bf16_f32 v228, v16, v17
    v_lshlrev_b32 v16, 16, v228
    v_and_b32 v17, s45, v228
    v_lshlrev_b32 v32, 16, v219
    v_and_b32 v33, s45, v219
    v_lshlrev_b32 v34, 16, v191
    v_and_b32 v35, s45, v191
    v_pk_mul_f32 v[28:29], v[32:33], v[34:35]
    v_cvt_pk_bf16_f32 v30, v28, v29
    v_lshlrev_b32 v28, 16, v30
    v_and_b32 v29, s45, v30
    v_pk_add_f32 v[18:19], v[18:19], v[28:29]
    v_cvt_pk_bf16_f32 v229, v18, v19
    v_lshlrev_b32 v18, 16, v229
    v_and_b32 v19, s45, v229
    v_lshlrev_b32 v32, 16, v220
    v_and_b32 v33, s45, v220
    v_lshlrev_b32 v34, 16, v192
    v_and_b32 v35, s45, v192
    v_pk_mul_f32 v[28:29], v[32:33], v[34:35]
    v_cvt_pk_bf16_f32 v30, v28, v29
    v_lshlrev_b32 v28, 16, v30
    v_and_b32 v29, s45, v30
    v_pk_add_f32 v[20:21], v[20:21], v[28:29]
    v_cvt_pk_bf16_f32 v230, v20, v21
    v_lshlrev_b32 v20, 16, v230
    v_and_b32 v21, s45, v230
    v_lshlrev_b32 v32, 16, v221
    v_and_b32 v33, s45, v221
    v_lshlrev_b32 v34, 16, v193
    v_and_b32 v35, s45, v193
    v_pk_mul_f32 v[28:29], v[32:33], v[34:35]
    v_cvt_pk_bf16_f32 v30, v28, v29
    v_lshlrev_b32 v28, 16, v30
    v_and_b32 v29, s45, v30
    v_pk_add_f32 v[22:23], v[22:23], v[28:29]
    v_cvt_pk_bf16_f32 v231, v22, v23
    v_lshlrev_b32 v22, 16, v231
    v_and_b32 v23, s45, v231
    s_bitcmp1_b32 s41, 0
    s_nop 0
    s_cbranch_scc1 L_xo_49
    s_cmp_eq_u32 s7, 0
    s_cbranch_scc0 L_slow_51
    global_store_dwordx4 v165, v[222:225], s[38:39]
    global_store_dwordx4 v167, v[226:229], s[38:39]
    global_store_dwordx2 v169, v[230:231], s[38:39]
    s_nop 0
    s_branch L_sd_52
L_slow_51:
    global_store_dwordx4 v165, v[222:225], s[38:39] sc0 sc1
    global_store_dwordx4 v167, v[226:229], s[38:39] sc0 sc1
    global_store_dwordx2 v169, v[230:231], s[38:39] sc0 sc1
    s_nop 0
L_sd_52:
    s_branch L_xd_50
L_xo_49:
    s_cmp_eq_u32 s7, 0
    s_cbranch_scc0 L_slow_53
    global_store_dwordx2 v165, v[222:223], s[38:39]
    global_store_dwordx4 v166, v[224:227], s[38:39]
    global_store_dwordx4 v168, v[228:231], s[38:39]
    s_nop 1
    s_branch L_sd_54
L_slow_53:
    global_store_dwordx2 v165, v[222:223], s[38:39] sc0 sc1
    global_store_dwordx4 v166, v[224:227], s[38:39] sc0 sc1
    global_store_dwordx4 v168, v[228:231], s[38:39] sc0 sc1
    s_nop 1
L_sd_54:
L_xd_50:
    s_waitcnt vmcnt(0) lgkmcnt(0)
    s_barrier
    s_cmp_lg_u32 s6, 0
    s_cbranch_scc1 L_iw_55
    s_lshl_b32 s50, s5, 3
    s_add_u32 s3, s28, 3
    v_mov_b32 v176, s3
    s_xor_b32 s3, s3, s29
    v_mov_b32 v177, s3
    v_mov_b32 v178, s50
    s_mov_b64 s[92:93], exec
    s_mov_b64 exec, 1
    s_cmp_eq_u32 s7, 0
    s_cbranch_scc0 L_slow_56
    global_store_dwordx2 v178, v[176:177], s[64:65]
    s_branch L_sd_57
L_slow_56:
    global_store_dwordx2 v178, v[176:177], s[64:65] sc0 sc1
L_sd_57:
    s_mov_b64 exec, s[92:93]
L_iw_55:
    v_pk_add_f32 v[28:29], v[4:5], v[6:7]
    v_pk_add_f32 v[30:31], v[8:9], v[10:11]
    v_pk_add_f32 v[28:29], v[28:29], v[12:13]
    v_pk_add_f32 v[30:31], v[30:31], v[14:15]
    v_pk_add_f32 v[28:29], v[28:29], v[16:17]
    v_pk_add_f32 v[30:31], v[30:31], v[18:19]
    v_pk_add_f32 v[28:29], v[28:29], v[20:21]
    v_pk_add_f32 v[30:31], v[30:31], v[22:23]
    v_pk_add_f32 v[28:29], v[28:29], v[30:31]
    v_add_f32 v28, v28, v29
    v_mov_b32 v32, v28
    s_nop 1
    v_permlane16_swap_b32 v28, v32
    v_add_f32 v28, v28, v32
    v_mov_b32 v32, v28
    s_nop 1
    v_permlane32_swap_b32 v28, v32
    v_add_f32 v28, v28, v32
    v_mul_f32 v28, 0x3c4ccccd, v28
    v_pk_add_f32 v[34:35], v[4:5], v[28:29] op_sel_hi:[1,0] neg_lo:[0,1] neg_hi:[0,1]
    v_pk_add_f32 v[36:37], v[6:7], v[28:29] op_sel_hi:[1,0] neg_lo:[0,1] neg_hi:[0,1]
    v_pk_add_f32 v[38:39], v[8:9], v[28:29] op_sel_hi:[1,0] neg_lo:[0,1] neg_hi:[0,1]
    v_pk_add_f32 v[40:41], v[10:11], v[28:29] op_sel_hi:[1,0] neg_lo:[0,1] neg_hi:[0,1]
    v_pk_add_f32 v[42:43], v[12:13], v[28:29] op_sel_hi:[1,0] neg_lo:[0,1] neg_hi:[0,1]
    v_pk_add_f32 v[44:45], v[14:15], v[28:29] op_sel_hi:[1,0] neg_lo:[0,1] neg_hi:[0,1]
    v_pk_add_f32 v[46:47], v[16:17], v[28:29] op_sel_hi:[1,0] neg_lo:[0,1] neg_hi:[0,1]
    v_pk_add_f32 v[48:49], v[18:19], v[28:29] op_sel_hi:[1,0] neg_lo:[0,1] neg_hi:[0,1]
    v_pk_add_f32 v[50:51], v[20:21], v[28:29] op_sel_hi:[1,0] neg_lo:[0,1] neg_hi:[0,1]
    v_pk_add_f32 v[52:53], v[22:23], v[28:29] op_sel_hi:[1,0] neg_lo:[0,1] neg_hi:[0,1]
    v_pk_mul_f32 v[54:55], v[34:35], v[34:35]
    v_pk_mul_f32 v[30:31], v[36:37], v[36:37]
    v_pk_fma_f32 v[54:55], v[38:39], v[38:39], v[54:55]
    v_pk_fma_f32 v[30:31], v[40:41], v[40:41], v[30:31]
    v_pk_fma_f32 v[54:55], v[42:43], v[42:43], v[54:55]
    v_pk_fma_f32 v[30:31], v[44:45], v[44:45], v[30:31]
    v_pk_fma_f32 v[54:55], v[46:47], v[46:47], v[54:55]
    v_pk_fma_f32 v[30:31], v[48:49], v[48:49], v[30:31]
    v_pk_fma_f32 v[54:55], v[50:51], v[50:51], v[54:55]
    v_pk_fma_f32 v[30:31], v[52:53], v[52:53], v[30:31]
    v_pk_add_f32 v[54:55], v[54:55], v[30:31]
    v_add_f32 v29, v54, v55
    s_add_u32 s3, s28, 1
    v_mov_b32 v30, s3
    v_mov_b32 v32, v29
    s_nop 1
    v_permlane16_swap_b32 v29, v32
    v_add_f32 v29, v29, v32
    v_mov_b32 v32, v29
    s_nop 1
    v_permlane32_swap_b32 v29, v32
    v_add_f32 v29, v29, v32
    s_xor_b32 s3, s3, s29
    v_mov_b32 v31, s3
    s_lshl_b32 s97, s4, 8
    s_lshl_b32 s100, s40, 6
    s_add_u32 s97, s97, s100
    s_lshl_b32 s100, s6, 4
    s_add_u32 s97, s97, s100
    v_add_u32 v33, s97, v2
    v_lshlrev_b32 v33, 7, v33
    s_lshl_b32 s100, s41, 4
    v_add_u32 v32, s100, v33
    v_lshl_add_u32 v33, v3, 5, v33
    s_add_u32 s66, s38, 1310720
    s_addc_u32 s67, s39, 0
    s_mov_b64 s[92:93], exec
    s_mov_b64 exec, 0xffff
    s_cmp_eq_u32 s7, 0
    s_cbranch_scc0 L_slow_58
    global_store_dwordx4 v32, v[28:31], s[66:67]
    s_nop 1
    s_branch L_sd_59
L_slow_58:
    global_store_dwordx4 v32, v[28:31], s[66:67] sc0 sc1
    s_nop 1
L_sd_59:
    s_mov_b64 exec, s[92:93]
    v_mov_b32 v100, 0x3f803f80
    v_mov_b32 v101, 0x3f803f80
    v_mov_b32 v102, 0x3f803f80
    v_mov_b32 v103, 0x3f803f80
    v_bfe_u32 v164, v1, 2, 2
    v_lshl_add_u32 v164, v3, 2, v164
    v_mul_u32_u24 v164, 224, v164
    v_and_b32 v165, 3, v1
    v_lshl_add_u32 v164, v165, 3, v164
    s_lshl_b32 s3, s6, 6
    v_add_u32 v164, s3, v164
    v_add_u32 v165, 57344, v164
    v_add_u32 v166, 114688, v164
    ds_read_b64_tr_b16 v[112:113], v164 offset:0
    ds_read_b64_tr_b16 v[114:115], v164 offset:3584
    ds_read_b64_tr_b16 v[116:117], v164 offset:32
    ds_read_b64_tr_b16 v[118:119], v164 offset:3616
    ds_read_b64_tr_b16 v[120:121], v164 offset:7168
    ds_read_b64_tr_b16 v[122:123], v164 offset:10752
    ds_read_b64_tr_b16 v[124:125], v164 offset:7200
    ds_read_b64_tr_b16 v[126:127], v164 offset:10784
    ds_read_b64_tr_b16 v[128:129], v164 offset:14336
    ds_read_b64_tr_b16 v[130:131], v164 offset:17920
    ds_read_b64_tr_b16 v[132:133], v164 offset:14368
    ds_read_b64_tr_b16 v[134:135], v164 offset:17952
    ds_read_b64_tr_b16 v[136:137], v164 offset:21504
    ds_read_b64_tr_b16 v[138:139], v164 offset:25088
    ds_read_b64_tr_b16 v[140:141], v164 offset:21536
    ds_read_b64_tr_b16 v[142:143], v164 offset:25120
    s_waitcnt lgkmcnt(12)
    v_mfma_f32_16x16x32_bf16 v[104:107], v[112:115], v[100:103], 0
    v_mfma_f32_16x16x32_bf16 v[108:111], v[116:119], v[100:103], 0
    ds_read_b64_tr_b16 v[112:113], v164 offset:28672
    ds_read_b64_tr_b16 v[114:115], v164 offset:32256
    ds_read_b64_tr_b16 v[116:117], v164 offset:28704
    ds_read_b64_tr_b16 v[118:119], v164 offset:32288
    s_waitcnt lgkmcnt(12)
    v_mfma_f32_16x16x32_bf16 v[104:107], v[120:123], v[100:103], v[104:107]
    v_mfma_f32_16x16x32_bf16 v[108:111], v[124:127], v[100:103], v[108:111]
    ds_read_b64_tr_b16 v[120:121], v164 offset:35840
    ds_read_b64_tr_b16 v[122:123], v164 offset:39424
    ds_read_b64_tr_b16 v[124:125], v164 offset:35872
    ds_read_b64_tr_b16 v[126:127], v164 offset:39456
    s_waitcnt lgkmcnt(12)
    v_mfma_f32_16x16x32_bf16 v[104:107], v[128:131], v[100:103], v[104:107]
    v_mfma_f32_16x16x32_bf16 v[108:111], v[132:135], v[100:103], v[108:111]
    ds_read_b64_tr_b16 v[128:129], v164 offset:43008
    ds_read_b64_tr_b16 v[130:131], v164 offset:46592
    ds_read_b64_tr_b16 v[132:133], v164 offset:43040
    ds_read_b64_tr_b16 v[134:135], v164 offset:46624
    s_waitcnt lgkmcnt(12)
    v_mfma_f32_16x16x32_bf16 v[104:107], v[136:139], v[100:103], v[104:107]
    v_mfma_f32_16x16x32_bf16 v[108:111], v[140:143], v[100:103], v[108:111]
    ds_read_b64_tr_b16 v[136:137], v164 offset:50176
    ds_read_b64_tr_b16 v[138:139], v164 offset:53760
    ds_read_b64_tr_b16 v[140:141], v164 offset:50208
    ds_read_b64_tr_b16 v[142:143], v164 offset:53792
    s_waitcnt lgkmcnt(12)
    v_mfma_f32_16x16x32_bf16 v[104:107], v[112:115], v[100:103], v[104:107]
    v_mfma_f32_16x16x32_bf16 v[108:111], v[116:119], v[100:103], v[108:111]
    ds_read_b64_tr_b16 v[112:113], v165 offset:0
    ds_read_b64_tr_b16 v[114:115], v165 offset:3584
    ds_read_b64_tr_b16 v[116:117], v165 offset:32
    ds_read_b64_tr_b16 v[118:119], v165 offset:3616
    s_waitcnt lgkmcnt(12)
    v_mfma_f32_16x16x32_bf16 v[104:107], v[120:123], v[100:103], v[104:107]
    v_mfma_f32_16x16x32_bf16 v[108:111], v[124:127], v[100:103], v[108:111]
    ds_read_b64_tr_b16 v[120:121], v165 offset:7168
    ds_read_b64_tr_b16 v[122:123], v165 offset:10752
    ds_read_b64_tr_b16 v[124:125], v165 offset:7200
    ds_read_b64_tr_b16 v[126:127], v165 offset:10784
    s_waitcnt lgkmcnt(12)
    v_mfma_f32_16x16x32_bf16 v[104:107], v[128:131], v[100:103], v[104:107]
    v_mfma_f32_16x16x32_bf16 v[108:111], v[132:135], v[100:103], v[108:111]
    ds_read_b64_tr_b16 v[128:129], v165 offset:14336
    ds_read_b64_tr_b16 v[130:131], v165 offset:17920
    ds_read_b64_tr_b16 v[132:133], v165 offset:14368
    ds_read_b64_tr_b16 v[134:135], v165 offset:17952
    s_waitcnt lgkmcnt(12)
    v_mfma_f32_16x16x32_bf16 v[104:107], v[136:139], v[100:103], v[104:107]
    v_mfma_f32_16x16x32_bf16 v[108:111], v[140:143], v[100:103], v[108:111]
    ds_read_b64_tr_b16 v[136:137], v165 offset:21504
    ds_read_b64_tr_b16 v[138:139], v165 offset:25088
    ds_read_b64_tr_b16 v[140:141], v165 offset:21536
    ds_read_b64_tr_b16 v[142:143], v165 offset:25120
    s_waitcnt lgkmcnt(12)
    v_mfma_f32_16x16x32_bf16 v[104:107], v[112:115], v[100:103], v[104:107]
    v_mfma_f32_16x16x32_bf16 v[108:111], v[116:119], v[100:103], v[108:111]
    ds_read_b64_tr_b16 v[112:113], v165 offset:28672
    ds_read_b64_tr_b16 v[114:115], v165 offset:32256
    ds_read_b64_tr_b16 v[116:117], v165 offset:28704
    ds_read_b64_tr_b16 v[118:119], v165 offset:32288
    s_waitcnt lgkmcnt(12)
    v_mfma_f32_16x16x32_bf16 v[104:107], v[120:123], v[100:103], v[104:107]
    v_mfma_f32_16x16x32_bf16 v[108:111], v[124:127], v[100:103], v[108:111]
    ds_read_b64_tr_b16 v[120:121], v165 offset:35840
    ds_read_b64_tr_b16 v[122:123], v165 offset:39424
    ds_read_b64_tr_b16 v[124:125], v165 offset:35872
    ds_read_b64_tr_b16 v[126:127], v165 offset:39456
    s_waitcnt lgkmcnt(12)
    v_mfma_f32_16x16x32_bf16 v[104:107], v[128:131], v[100:103], v[104:107]
    v_mfma_f32_16x16x32_bf16 v[108:111], v[132:135], v[100:103], v[108:111]
    ds_read_b64_tr_b16 v[128:129], v165 offset:43008
    ds_read_b64_tr_b16 v[130:131], v165 offset:46592
    ds_read_b64_tr_b16 v[132:133], v165 offset:43040
    ds_read_b64_tr_b16 v[134:135], v165 offset:46624
    s_waitcnt lgkmcnt(12)
    v_mfma_f32_16x16x32_bf16 v[104:107], v[136:139], v[100:103], v[104:107]
    v_mfma_f32_16x16x32_bf16 v[108:111], v[140:143], v[100:103], v[108:111]
    ds_read_b64_tr_b16 v[136:137], v165 offset:50176
    ds_read_b64_tr_b16 v[138:139], v165 offset:53760
    ds_read_b64_tr_b16 v[140:141], v165 offset:50208
    ds_read_b64_tr_b16 v[142:143], v165 offset:53792
    s_waitcnt lgkmcnt(12)
    v_mfma_f32_16x16x32_bf16 v[104:107], v[112:115], v[100:103], v[104:107]
    v_mfma_f32_16x16x32_bf16 v[108:111], v[116:119], v[100:103], v[108:111]
    ds_read_b64_tr_b16 v[112:113], v166 offset:0
    ds_read_b64_tr_b16 v[114:115], v166 offset:3584
    ds_read_b64_tr_b16 v[116:117], v166 offset:32
    ds_read_b64_tr_b16 v[118:119], v166 offset:3616
    s_waitcnt lgkmcnt(12)
    v_mfma_f32_16x16x32_bf16 v[104:107], v[120:123], v[100:103], v[104:107]
    v_mfma_f32_16x16x32_bf16 v[108:111], v[124:127], v[100:103], v[108:111]
    ds_read_b64_tr_b16 v[120:121], v166 offset:7168
    ds_read_b64_tr_b16 v[122:123], v166 offset:10752
    ds_read_b64_tr_b16 v[124:125], v166 offset:7200
    ds_read_b64_tr_b16 v[126:127], v166 offset:10784
    s_waitcnt lgkmcnt(12)
    v_mfma_f32_16x16x32_bf16 v[104:107], v[128:131], v[100:103], v[104:107]
    v_mfma_f32_16x16x32_bf16 v[108:111], v[132:135], v[100:103], v[108:111]
    ds_read_b64_tr_b16 v[128:129], v166 offset:14336
    ds_read_b64_tr_b16 v[130:131], v166 offset:17920
    ds_read_b64_tr_b16 v[132:133], v166 offset:14368
    ds_read_b64_tr_b16 v[134:135], v166 offset:17952
    s_waitcnt lgkmcnt(12)
    v_mfma_f32_16x16x32_bf16 v[104:107], v[136:139], v[100:103], v[104:107]
    v_mfma_f32_16x16x32_bf16 v[108:111], v[140:143], v[100:103], v[108:111]
    ds_read_b64_tr_b16 v[136:137], v166 offset:21504
    ds_read_b64_tr_b16 v[138:139], v166 offset:25088
    ds_read_b64_tr_b16 v[140:141], v166 offset:21536
    ds_read_b64_tr_b16 v[142:143], v166 offset:25120
    s_waitcnt lgkmcnt(12)
    v_mfma_f32_16x16x32_bf16 v[104:107], v[112:115], v[100:103], v[104:107]
    v_mfma_f32_16x16x32_bf16 v[108:111], v[116:119], v[100:103], v[108:111]
    s_waitcnt lgkmcnt(8)
    v_mfma_f32_16x16x32_bf16 v[104:107], v[120:123], v[100:103], v[104:107]
    v_mfma_f32_16x16x32_bf16 v[108:111], v[124:127], v[100:103], v[108:111]
    s_waitcnt lgkmcnt(4)
    v_mfma_f32_16x16x32_bf16 v[104:107], v[128:131], v[100:103], v[104:107]
    v_mfma_f32_16x16x32_bf16 v[108:111], v[132:135], v[100:103], v[108:111]
    s_waitcnt lgkmcnt(0)
    v_mfma_f32_16x16x32_bf16 v[104:107], v[136:139], v[100:103], v[104:107]
    v_mfma_f32_16x16x32_bf16 v[108:111], v[140:143], v[100:103], v[108:111]
    v_lshlrev_b32 v144, 4, v3
    s_lshl_b32 s3, s6, 7
    s_add_u32 s3, s3, 159744
    v_add_u32 v144, s3, v144
    v_cmp_eq_u32 vcc, 0, v2
    s_and_saveexec_b64 s[92:93], vcc
    s_nop 0
    ds_write_b128 v144, v[104:107]
    ds_write_b128 v144, v[108:111] offset:64
    s_mov_b64 exec, s[92:93]
    s_waitcnt lgkmcnt(0)
    s_barrier
    v_lshlrev_b32 v144, 4, v3
    v_add_u32 v144, 159744, v144
    ds_read_b128 v[184:187], v144 offset:0
    ds_read_b128 v[188:191], v144 offset:64
    ds_read_b128 v[192:195], v144 offset:128
    ds_read_b128 v[196:199], v144 offset:192
    ds_read_b128 v[200:203], v144 offset:256
    ds_read_b128 v[204:207], v144 offset:320
    ds_read_b128 v[208:211], v144 offset:384
    s_lshl_b32 s3, s4, 4
    s_lshl_b32 s50, s42, 3
    s_add_u32 s3, s3, s50
    s_lshl_b32 s50, s6, 1
    s_add_u32 s63, s3, s50
    s_mul_i32 s3, s63, 20480
    s_add_u32 s3, s3, s90
    s_add_u32 s86, s38, 0
    s_addc_u32 s87, s39, 0
    s_add_u32 s86, s86, s3
    s_addc_u32 s87, s87, 0
    s_add_u32 s68, s86, 20480
    s_addc_u32 s69, s87, 0
    v_lshlrev_b32 v183, 4, v1
    v_lshlrev_b32 v182, 4, v1
    s_mul_i32 s53, s63, 55296
    s_add_u32 s53, s53, 20971520
    s_add_u32 s51, s44, 0
    s_lshr_b32 s52, s51, 1
    s_lshl_b32 s52, s52, 10
    s_and_b32 s51, s51, 1
    s_lshl_b32 s51, s51, 3
    s_add_u32 s51, s51, s52
    s_add_u32 s51, s51, s53
    s_add_u32 s72, s38, s51
    s_addc_u32 s73, s39, 0
    s_add_u32 s51, s44, 1
    s_lshr_b32 s52, s51, 1
    s_lshl_b32 s52, s52, 10
    s_and_b32 s51, s51, 1
    s_lshl_b32 s51, s51, 3
    s_add_u32 s51, s51, s52
    s_add_u32 s51, s51, s53
    s_add_u32 s74, s38, s51
    s_addc_u32 s75, s39, 0
    s_add_u32 s51, s44, 2
    s_lshr_b32 s52, s51, 1
    s_lshl_b32 s52, s52, 10
    s_and_b32 s51, s51, 1
    s_lshl_b32 s51, s51, 3
    s_add_u32 s51, s51, s52
    s_add_u32 s51, s51, s53
    s_add_u32 s76, s38, s51
    s_addc_u32 s77, s39, 0
    s_add_u32 s51, s44, 3
    s_lshr_b32 s52, s51, 1
    s_lshl_b32 s52, s52, 10
    s_and_b32 s51, s51, 1
    s_lshl_b32 s51, s51, 3
    s_add_u32 s51, s51, s52
    s_add_u32 s51, s51, s53
    s_add_u32 s78, s38, s51
    s_addc_u32 s79, s39, 0
    s_add_u32 s51, s44, 4
    s_lshr_b32 s52, s51, 1
    s_lshl_b32 s52, s52, 10
    s_and_b32 s51, s51, 1
    s_lshl_b32 s51, s51, 3
    s_add_u32 s51, s51, s52
    s_add_u32 s51, s51, s53
    s_add_u32 s80, s38, s51
    s_addc_u32 s81, s39, 0
    s_add_u32 s51, s44, 5
    s_lshr_b32 s52, s51, 1
    s_lshl_b32 s52, s52, 10
    s_and_b32 s51, s51, 1
    s_lshl_b32 s51, s51, 3
    s_add_u32 s51, s51, s52
    s_add_u32 s51, s51, s53
    s_add_u32 s82, s38, s51
    s_addc_u32 s83, s39, 0
    s_add_u32 s51, s44, 6
    s_lshr_b32 s52, s51, 1
    s_lshl_b32 s52, s52, 10
    s_and_b32 s51, s51, 1
    s_lshl_b32 s51, s51, 3
    s_add_u32 s51, s51, s52
    s_add_u32 s51, s51, s53
    s_add_u32 s84, s38, s51
    s_addc_u32 s85, s39, 0
    v_bfe_u32 v172, v1, 2, 2
    v_lshl_add_u32 v172, v3, 2, v172
    v_mul_u32_u24 v172, 224, v172
    v_and_b32 v59, 3, v1
    v_lshl_add_u32 v172, v59, 3, v172
    ds_read_b64_tr_b16 v[60:61], v172 offset:0
    ds_read_b64_tr_b16 v[62:63], v172 offset:3584
    ds_read_b64_tr_b16 v[64:65], v172 offset:32
    ds_read_b64_tr_b16 v[66:67], v172 offset:3616
    ds_read_b64_tr_b16 v[68:69], v172 offset:64
    ds_read_b64_tr_b16 v[70:71], v172 offset:3648
    ds_read_b64_tr_b16 v[72:73], v172 offset:96
    ds_read_b64_tr_b16 v[74:75], v172 offset:3680
    ds_read_b64_tr_b16 v[76:77], v172 offset:128
    ds_read_b64_tr_b16 v[78:79], v172 offset:3712
    ds_read_b64_tr_b16 v[80:81], v172 offset:160
    ds_read_b64_tr_b16 v[82:83], v172 offset:3744
    ds_read_b64_tr_b16 v[84:85], v172 offset:192
    ds_read_b64_tr_b16 v[86:87], v172 offset:3776
    v_add_u32 v172, 7168, v172
    s_waitcnt lgkmcnt(0)
    s_cmp_eq_u32 s6, 3
    s_cbranch_scc1 L_iw_60
    s_add_u32 s61, s60, 163840
    buffer_load_dwordx4 a[88:91], v182, s[56:59], s61 offen offset:2048
    buffer_load_dwordx4 a[92:95], v182, s[56:59], s61 offen offset:3072
    s_add_u32 s61, s60, 167936
    buffer_load_dwordx4 a[96:99], v182, s[56:59], s61 offen offset:0
    s_add_u32 s61, s60, 204800
    buffer_load_dwordx4 a[100:103], v182, s[56:59], s61 offen offset:0
    buffer_load_dwordx4 a[104:107], v182, s[56:59], s61 offen offset:1024
    buffer_load_dwordx4 a[108:111], v182, s[56:59], s61 offen offset:2048
    buffer_load_dwordx4 a[112:115], v182, s[56:59], s61 offen offset:3072
    s_add_u32 s61, s60, 208896
    buffer_load_dwordx4 a[116:119], v182, s[56:59], s61 offen offset:0
    s_add_u32 s61, s60, 245760
    buffer_load_dwordx4 a[120:123], v182, s[56:59], s61 offen offset:0
    buffer_load_dwordx4 a[124:127], v182, s[56:59], s61 offen offset:1024
    buffer_load_dwordx4 a[128:131], v182, s[56:59], s61 offen offset:2048
    buffer_load_dwordx4 a[132:135], v182, s[56:59], s61 offen offset:3072
    s_add_u32 s61, s60, 249856
    buffer_load_dwordx4 a[136:139], v182, s[56:59], s61 offen offset:0
    s_add_u32 s61, s60, 286720
    buffer_load_dwordx4 a[140:143], v182, s[56:59], s61 offen offset:0
L_iw_60:
    s_cmp_lg_u32 s6, 3
    s_cbranch_scc1 L_iw_61
    v_and_b32 v180, 31, v1
    v_lshlrev_b32 v180, 3, v180
    s_add_u32 s55, s28, 3
    s_mov_b32 s71, 400000
L_poll_62:
    global_load_dwordx2 v[176:177], v180, s[64:65] sc1
    s_sub_u32 s71, s71, 1
    s_cmp_eq_u32 s71, 0
    s_cbranch_scc1 L_abort
    s_waitcnt vmcnt(0)
    v_subrev_u32 v178, s55, v176
    v_cmp_lt_u32 vcc, 4, v178
    v_xor_b32 v178, v176, v177
    v_cmp_ne_u32 s[88:89], s29, v178
    s_or_b64 s[88:89], vcc, s[88:89]
    s_nop 3
    s_cbranch_scc1 L_poll_62
L_iw_61:
    s_barrier
    s_cmp_lg_u32 s6, 3
    s_cbranch_scc1 L_iw_63
    s_add_u32 s61, s60, 163840
    buffer_load_dwordx4 a[88:91], v182, s[56:59], s61 offen offset:2048
    buffer_load_dwordx4 a[92:95], v182, s[56:59], s61 offen offset:3072
    s_add_u32 s61, s60, 167936
    buffer_load_dwordx4 a[96:99], v182, s[56:59], s61 offen offset:0
    s_add_u32 s61, s60, 204800
    buffer_load_dwordx4 a[100:103], v182, s[56:59], s61 offen offset:0
    buffer_load_dwordx4 a[104:107], v182, s[56:59], s61 offen offset:1024
    buffer_load_dwordx4 a[108:111], v182, s[56:59], s61 offen offset:2048
    buffer_load_dwordx4 a[112:115], v182, s[56:59], s61 offen offset:3072
    s_add_u32 s61, s60, 208896
    buffer_load_dwordx4 a[116:119], v182, s[56:59], s61 offen offset:0
    s_add_u32 s61, s60, 245760
    buffer_load_dwordx4 a[120:123], v182, s[56:59], s61 offen offset:0
    buffer_load_dwordx4 a[124:127], v182, s[56:59], s61 offen offset:1024
    buffer_load_dwordx4 a[128:131], v182, s[56:59], s61 offen offset:2048
    buffer_load_dwordx4 a[132:135], v182, s[56:59], s61 offen offset:3072
    s_add_u32 s61, s60, 249856
    buffer_load_dwordx4 a[136:139], v182, s[56:59], s61 offen offset:0
    s_add_u32 s61, s60, 286720
    buffer_load_dwordx4 a[140:143], v182, s[56:59], s61 offen offset:0
L_iw_63:
    global_load_dwordx4 v[116:119], v183, s[86:87] offset:0 sc1
    global_load_dwordx4 v[120:123], v183, s[68:69] offset:0 sc1
    global_load_dwordx4 v[124:127], v183, s[86:87] offset:1024 sc1
    global_load_dwordx4 v[128:131], v183, s[68:69] offset:1024 sc1
    global_load_dwordx4 v[132:135], v183, s[86:87] offset:2048 sc1
    global_load_dwordx4 v[136:139], v183, s[68:69] offset:2048 sc1
    s_lshl_b32 s3, s63, 11
    s_add_u32 s3, s3, 1310720
    v_lshlrev_b32 v169, 7, v2
    v_lshl_add_u32 v169, v3, 5, v169
    v_add_u32 v169, s3, v169
    s_add_u32 s101, s28, 1
    global_load_dwordx4 v[140:143], v183, s[86:87] offset:3072 sc1
    global_load_dwordx4 v[144:147], v183, s[68:69] offset:3072 sc1
    v_add_u32 v183, 4096, v183
    global_load_dwordx4 v[148:151], v183, s[86:87] offset:0 sc1
    global_load_dwordx4 v[152:155], v183, s[68:69] offset:0 sc1
    global_load_dwordx4 v[156:159], v183, s[86:87] offset:1024 sc1
    global_load_dwordx4 v[160:163], v183, s[68:69] offset:1024 sc1
    s_waitcnt lgkmcnt(0)
    s_waitcnt vmcnt(10)
    v_mfma_f32_16x16x32_bf16 v[4:7], v[60:63], v[116:119], 0
    ds_read_b64_tr_b16 v[88:89], v172 offset:0
    ds_read_b64_tr_b16 v[90:91], v172 offset:3584
    v_mfma_f32_16x16x32_bf16 v[32:35], v[60:63], v[120:123], 0
    ds_read_b64_tr_b16 v[92:93], v172 offset:32
    v_mfma_f32_16x16x32_bf16 v[8:11], v[64:67], v[116:119], 0
    ds_read_b64_tr_b16 v[94:95], v172 offset:3616
    v_mfma_f32_16x16x32_bf16 v[36:39], v[64:67], v[120:123], 0
    ds_read_b64_tr_b16 v[96:97], v172 offset:64
    v_mfma_f32_16x16x32_bf16 v[12:15], v[68:71], v[116:119], 0
    ds_read_b64_tr_b16 v[98:99], v172 offset:3648
    v_mfma_f32_16x16x32_bf16 v[40:43], v[68:71], v[120:123], 0
    ds_read_b64_tr_b16 v[100:101], v172 offset:96
    v_mfma_f32_16x16x32_bf16 v[16:19], v[72:75], v[116:119], 0
    ds_read_b64_tr_b16 v[102:103], v172 offset:3680
    v_mfma_f32_16x16x32_bf16 v[44:47], v[72:75], v[120:123], 0
    ds_read_b64_tr_b16 v[104:105], v172 offset:128
    v_mfma_f32_16x16x32_bf16 v[20:23], v[76:79], v[116:119], 0
    ds_read_b64_tr_b16 v[106:107], v172 offset:3712
    v_mfma_f32_16x16x32_bf16 v[48:51], v[76:79], v[120:123], 0
    ds_read_b64_tr_b16 v[108:109], v172 offset:160
    v_mfma_f32_16x16x32_bf16 v[24:27], v[80:83], v[116:119], 0
    ds_read_b64_tr_b16 v[110:111], v172 offset:3744
    v_mfma_f32_16x16x32_bf16 v[52:55], v[80:83], v[120:123], 0
    ds_read_b64_tr_b16 v[112:113], v172 offset:192
    v_mfma_f32_16x16x32_bf16 v[28:31], v[84:87], v[116:119], 0
    ds_read_b64_tr_b16 v[114:115], v172 offset:3776
    v_mfma_f32_16x16x32_bf16 v[56:59], v[84:87], v[120:123], 0
    v_add_u32 v172, 7168, v172
    global_load_dwordx4 v[116:119], v183, s[86:87] offset:2048 sc1
    global_load_dwordx4 v[120:123], v183, s[68:69] offset:2048 sc1
    s_waitcnt lgkmcnt(0)
    s_waitcnt vmcnt(10)
    v_mfma_f32_16x16x32_bf16 v[4:7], v[88:91], v[124:127], v[4:7]
    ds_read_b64_tr_b16 v[60:61], v172 offset:0
    ds_read_b64_tr_b16 v[62:63], v172 offset:3584
    v_mfma_f32_16x16x32_bf16 v[32:35], v[88:91], v[128:131], v[32:35]
    ds_read_b64_tr_b16 v[64:65], v172 offset:32
    v_mfma_f32_16x16x32_bf16 v[8:11], v[92:95], v[124:127], v[8:11]
    ds_read_b64_tr_b16 v[66:67], v172 offset:3616
    v_mfma_f32_16x16x32_bf16 v[36:39], v[92:95], v[128:131], v[36:39]
    ds_read_b64_tr_b16 v[68:69], v172 offset:64
    v_mfma_f32_16x16x32_bf16 v[12:15], v[96:99], v[124:127], v[12:15]
    ds_read_b64_tr_b16 v[70:71], v172 offset:3648
    ds_read_b64_tr_b16 v[72:73], v172 offset:96
    v_mfma_f32_16x16x32_bf16 v[40:43], v[96:99], v[128:131], v[40:43]
    ds_read_b64_tr_b16 v[74:75], v172 offset:3680
    v_mfma_f32_16x16x32_bf16 v[16:19], v[100:103], v[124:127], v[16:19]
    ds_read_b64_tr_b16 v[76:77], v172 offset:128
    v_mfma_f32_16x16x32_bf16 v[44:47], v[100:103], v[128:131], v[44:47]
    ds_read_b64_tr_b16 v[78:79], v172 offset:3712
    v_mfma_f32_16x16x32_bf16 v[20:23], v[104:107], v[124:127], v[20:23]
    ds_read_b64_tr_b16 v[80:81], v172 offset:160
    ds_read_b64_tr_b16 v[82:83], v172 offset:3744
    v_mfma_f32_16x16x32_bf16 v[48:51], v[104:107], v[128:131], v[48:51]
    ds_read_b64_tr_b16 v[84:85], v172 offset:192
    v_mfma_f32_16x16x32_bf16 v[24:27], v[108:111], v[124:127], v[24:27]
    ds_read_b64_tr_b16 v[86:87], v172 offset:3776
    v_mfma_f32_16x16x32_bf16 v[52:55], v[108:111], v[128:131], v[52:55]
    s_add_u32 s61, s60, 286720
    v_mfma_f32_16x16x32_bf16 v[28:31], v[112:115], v[124:127], v[28:31]
    buffer_load_dwordx4 a[144:147], v182, s[56:59], s61 offen offset:1024
    v_mfma_f32_16x16x32_bf16 v[56:59], v[112:115], v[128:131], v[56:59]
    v_add_u32 v172, 7168, v172
    global_load_dwordx4 v[124:127], v183, s[86:87] offset:3072 sc1
    global_load_dwordx4 v[128:131], v183, s[68:69] offset:3072 sc1
    v_add_u32 v183, 4096, v183
    s_waitcnt lgkmcnt(0)
    s_waitcnt vmcnt(11)
    v_mfma_f32_16x16x32_bf16 v[4:7], v[60:63], v[132:135], v[4:7]
    ds_read_b64_tr_b16 v[88:89], v172 offset:0
    ds_read_b64_tr_b16 v[90:91], v172 offset:3584
    v_mfma_f32_16x16x32_bf16 v[32:35], v[60:63], v[136:139], v[32:35]
    ds_read_b64_tr_b16 v[92:93], v172 offset:32
    v_mfma_f32_16x16x32_bf16 v[8:11], v[64:67], v[132:135], v[8:11]
    ds_read_b64_tr_b16 v[94:95], v172 offset:3616
    ds_read_b64_tr_b16 v[96:97], v172 offset:64
    v_mfma_f32_16x16x32_bf16 v[36:39], v[64:67], v[136:139], v[36:39]
    ds_read_b64_tr_b16 v[98:99], v172 offset:3648
    v_mfma_f32_16x16x32_bf16 v[12:15], v[68:71], v[132:135], v[12:15]
    ds_read_b64_tr_b16 v[100:101], v172 offset:96
    v_mfma_f32_16x16x32_bf16 v[40:43], v[68:71], v[136:139], v[40:43]
    ds_read_b64_tr_b16 v[102:103], v172 offset:3680
    ds_read_b64_tr_b16 v[104:105], v172 offset:128
    v_mfma_f32_16x16x32_bf16 v[16:19], v[72:75], v[132:135], v[16:19]
    ds_read_b64_tr_b16 v[106:107], v172 offset:3712
    v_mfma_f32_16x16x32_bf16 v[44:47], v[72:75], v[136:139], v[44:47]
    ds_read_b64_tr_b16 v[108:109], v172 offset:160
    ds_read_b64_tr_b16 v[110:111], v172 offset:3744
    v_mfma_f32_16x16x32_bf16 v[20:23], v[76:79], v[132:135], v[20:23]
    ds_read_b64_tr_b16 v[112:113], v172 offset:192
    v_mfma_f32_16x16x32_bf16 v[48:51], v[76:79], v[136:139], v[48:51]
    ds_read_b64_tr_b16 v[114:115], v172 offset:3776
    v_mfma_f32_16x16x32_bf16 v[24:27], v[80:83], v[132:135], v[24:27]
    global_load_dwordx4 v[174:177], v169, s[38:39] offset:0 sc1
    global_load_dwordx4 v[178:181], v169, s[38:39] offset:16 sc1
    v_mfma_f32_16x16x32_bf16 v[52:55], v[80:83], v[136:139], v[52:55]
    buffer_load_dwordx4 a[148:151], v182, s[56:59], s61 offen offset:2048
    v_mfma_f32_16x16x32_bf16 v[28:31], v[84:87], v[132:135], v[28:31]
    buffer_load_dwordx4 a[152:155], v182, s[56:59], s61 offen offset:3072
    v_mfma_f32_16x16x32_bf16 v[56:59], v[84:87], v[136:139], v[56:59]
    v_add_u32 v172, 7168, v172
    global_load_dwordx4 v[132:135], v183, s[86:87] offset:0 sc1
    global_load_dwordx4 v[136:139], v183, s[68:69] offset:0 sc1
    s_waitcnt lgkmcnt(0)
    s_waitcnt vmcnt(15)
    v_mfma_f32_16x16x32_bf16 v[4:7], v[88:91], v[140:143], v[4:7]
    ds_read_b64_tr_b16 v[60:61], v172 offset:0
    ds_read_b64_tr_b16 v[62:63], v172 offset:3584
    v_mfma_f32_16x16x32_bf16 v[32:35], v[88:91], v[144:147], v[32:35]
    ds_read_b64_tr_b16 v[64:65], v172 offset:32
    v_mfma_f32_16x16x32_bf16 v[8:11], v[92:95], v[140:143], v[8:11]
    ds_read_b64_tr_b16 v[66:67], v172 offset:3616
    v_mfma_f32_16x16x32_bf16 v[36:39], v[92:95], v[144:147], v[36:39]
    ds_read_b64_tr_b16 v[68:69], v172 offset:64
    v_mfma_f32_16x16x32_bf16 v[12:15], v[96:99], v[140:143], v[12:15]
    ds_read_b64_tr_b16 v[70:71], v172 offset:3648
    ds_read_b64_tr_b16 v[72:73], v172 offset:96
    v_mfma_f32_16x16x32_bf16 v[40:43], v[96:99], v[144:147], v[40:43]
    ds_read_b64_tr_b16 v[74:75], v172 offset:3680
    v_mfma_f32_16x16x32_bf16 v[16:19], v[100:103], v[140:143], v[16:19]
    ds_read_b64_tr_b16 v[76:77], v172 offset:128
    v_mfma_f32_16x16x32_bf16 v[44:47], v[100:103], v[144:147], v[44:47]
    ds_read_b64_tr_b16 v[78:79], v172 offset:3712
    v_mfma_f32_16x16x32_bf16 v[20:23], v[104:107], v[140:143], v[20:23]
    ds_read_b64_tr_b16 v[80:81], v172 offset:160
    ds_read_b64_tr_b16 v[82:83], v172 offset:3744
    v_mfma_f32_16x16x32_bf16 v[48:51], v[104:107], v[144:147], v[48:51]
    ds_read_b64_tr_b16 v[84:85], v172 offset:192
    v_mfma_f32_16x16x32_bf16 v[24:27], v[108:111], v[140:143], v[24:27]
    ds_read_b64_tr_b16 v[86:87], v172 offset:3776
    v_mfma_f32_16x16x32_bf16 v[52:55], v[108:111], v[144:147], v[52:55]
    s_add_u32 s61, s60, 290816
    v_mfma_f32_16x16x32_bf16 v[28:31], v[112:115], v[140:143], v[28:31]
    buffer_load_dwordx4 a[156:159], v182, s[56:59], s61 offen offset:0
    v_mfma_f32_16x16x32_bf16 v[56:59], v[112:115], v[144:147], v[56:59]
    v_add_u32 v172, 7168, v172
    global_load_dwordx4 v[140:143], v183, s[86:87] offset:1024 sc1
    global_load_dwordx4 v[144:147], v183, s[68:69] offset:1024 sc1
    s_waitcnt lgkmcnt(0)
    s_waitcnt vmcnt(16)
    v_mfma_f32_16x16x32_bf16 v[4:7], v[60:63], v[148:151], v[4:7]
    ds_read_b64_tr_b16 v[88:89], v172 offset:0
    ds_read_b64_tr_b16 v[90:91], v172 offset:3584
    v_mfma_f32_16x16x32_bf16 v[32:35], v[60:63], v[152:155], v[32:35]
    ds_read_b64_tr_b16 v[92:93], v172 offset:32
    v_mfma_f32_16x16x32_bf16 v[8:11], v[64:67], v[148:151], v[8:11]
    ds_read_b64_tr_b16 v[94:95], v172 offset:3616
    v_mfma_f32_16x16x32_bf16 v[36:39], v[64:67], v[152:155], v[36:39]
    ds_read_b64_tr_b16 v[96:97], v172 offset:64
    v_mfma_f32_16x16x32_bf16 v[12:15], v[68:71], v[148:151], v[12:15]
    ds_read_b64_tr_b16 v[98:99], v172 offset:3648
    ds_read_b64_tr_b16 v[100:101], v172 offset:96
    v_mfma_f32_16x16x32_bf16 v[40:43], v[68:71], v[152:155], v[40:43]
    ds_read_b64_tr_b16 v[102:103], v172 offset:3680
    v_mfma_f32_16x16x32_bf16 v[16:19], v[72:75], v[148:151], v[16:19]
    ds_read_b64_tr_b16 v[104:105], v172 offset:128
    v_mfma_f32_16x16x32_bf16 v[44:47], v[72:75], v[152:155], v[44:47]
    ds_read_b64_tr_b16 v[106:107], v172 offset:3712
    v_mfma_f32_16x16x32_bf16 v[20:23], v[76:79], v[148:151], v[20:23]
    ds_read_b64_tr_b16 v[108:109], v172 offset:160
    ds_read_b64_tr_b16 v[110:111], v172 offset:3744
    v_mfma_f32_16x16x32_bf16 v[48:51], v[76:79], v[152:155], v[48:51]
    ds_read_b64_tr_b16 v[112:113], v172 offset:192
    v_mfma_f32_16x16x32_bf16 v[24:27], v[80:83], v[148:151], v[24:27]
    ds_read_b64_tr_b16 v[114:115], v172 offset:3776
    v_mfma_f32_16x16x32_bf16 v[52:55], v[80:83], v[152:155], v[52:55]
    s_add_u32 s61, s60, 327680
    v_mfma_f32_16x16x32_bf16 v[28:31], v[84:87], v[148:151], v[28:31]
    buffer_load_dwordx4 a[160:163], v182, s[56:59], s61 offen offset:0
    v_mfma_f32_16x16x32_bf16 v[56:59], v[84:87], v[152:155], v[56:59]
    v_add_u32 v172, 7168, v172
    global_load_dwordx4 v[148:151], v183, s[86:87] offset:2048 sc1
    global_load_dwordx4 v[152:155], v183, s[68:69] offset:2048 sc1
    s_waitcnt lgkmcnt(0)
    s_waitcnt vmcnt(17)
    v_mfma_f32_16x16x32_bf16 v[4:7], v[88:91], v[156:159], v[4:7]
    ds_read_b64_tr_b16 v[60:61], v172 offset:0
    ds_read_b64_tr_b16 v[62:63], v172 offset:3584
    v_mfma_f32_16x16x32_bf16 v[32:35], v[88:91], v[160:163], v[32:35]
    ds_read_b64_tr_b16 v[64:65], v172 offset:32
    v_mfma_f32_16x16x32_bf16 v[8:11], v[92:95], v[156:159], v[8:11]
    ds_read_b64_tr_b16 v[66:67], v172 offset:3616
    ds_read_b64_tr_b16 v[68:69], v172 offset:64
    v_mfma_f32_16x16x32_bf16 v[36:39], v[92:95], v[160:163], v[36:39]
    ds_read_b64_tr_b16 v[70:71], v172 offset:3648
    v_mfma_f32_16x16x32_bf16 v[12:15], v[96:99], v[156:159], v[12:15]
    ds_read_b64_tr_b16 v[72:73], v172 offset:96
    ds_read_b64_tr_b16 v[74:75], v172 offset:3680
    v_mfma_f32_16x16x32_bf16 v[40:43], v[96:99], v[160:163], v[40:43]
    ds_read_b64_tr_b16 v[76:77], v172 offset:128
    v_mfma_f32_16x16x32_bf16 v[16:19], v[100:103], v[156:159], v[16:19]
    ds_read_b64_tr_b16 v[78:79], v172 offset:3712
    ds_read_b64_tr_b16 v[80:81], v172 offset:160
    v_mfma_f32_16x16x32_bf16 v[44:47], v[100:103], v[160:163], v[44:47]
    ds_read_b64_tr_b16 v[82:83], v172 offset:3744
    v_mfma_f32_16x16x32_bf16 v[20:23], v[104:107], v[156:159], v[20:23]
    ds_read_b64_tr_b16 v[84:85], v172 offset:192
    ds_read_b64_tr_b16 v[86:87], v172 offset:3776
    v_mfma_f32_16x16x32_bf16 v[48:51], v[104:107], v[160:163], v[48:51]
    s_waitcnt vmcnt(10)
    v_xor_b32 v170, s101, v176
    v_xor_b32 v171, s101, v180
    v_or_b32 v170, v170, v171
    v_xor_b32 v171, v176, v177
    v_xor_b32 v171, s29, v171
    v_or_b32 v170, v170, v171
    v_xor_b32 v171, v180, v181
    v_xor_b32 v171, s29, v171
    v_or_b32 v170, v170, v171
    v_cmp_ne_u32 vcc, 0, v170
    s_cbranch_vccnz L_str_64
L_stb_65:
    v_mfma_f32_16x16x32_bf16 v[24:27], v[108:111], v[156:159], v[24:27]
    v_mov_b32 v176, v178
    v_mov_b32 v177, v179
    v_mfma_f32_16x16x32_bf16 v[52:55], v[108:111], v[160:163], v[52:55]
    buffer_load_dwordx4 a[164:167], v182, s[56:59], s61 offen offset:1024
    v_mfma_f32_16x16x32_bf16 v[28:31], v[112:115], v[156:159], v[28:31]
    buffer_load_dwordx4 a[168:171], v182, s[56:59], s61 offen offset:2048
    v_mfma_f32_16x16x32_bf16 v[56:59], v[112:115], v[160:163], v[56:59]
    v_add_u32 v172, 7168, v172
    global_load_dwordx4 v[156:159], v183, s[86:87] offset:3072 sc1
    global_load_dwordx4 v[160:163], v183, s[68:69] offset:3072 sc1
    v_add_u32 v183, 4096, v183
    s_waitcnt lgkmcnt(0)
    v_mfma_f32_16x16x32_bf16 v[4:7], v[60:63], v[116:119], v[4:7]
    ds_read_b64_tr_b16 v[88:89], v172 offset:0
    ds_read_b64_tr_b16 v[90:91], v172 offset:3584
    v_mfma_f32_16x16x32_bf16 v[32:35], v[60:63], v[120:123], v[32:35]
    ds_read_b64_tr_b16 v[92:93], v172 offset:32
    ds_read_b64_tr_b16 v[94:95], v172 offset:3616
    v_mfma_f32_16x16x32_bf16 v[8:11], v[64:67], v[116:119], v[8:11]
    ds_read_b64_tr_b16 v[96:97], v172 offset:64
    ds_read_b64_tr_b16 v[98:99], v172 offset:3648
    v_mfma_f32_16x16x32_bf16 v[36:39], v[64:67], v[120:123], v[36:39]
    ds_read_b64_tr_b16 v[100:101], v172 offset:96
    ds_read_b64_tr_b16 v[102:103], v172 offset:3680
    v_mfma_f32_16x16x32_bf16 v[12:15], v[68:71], v[116:119], v[12:15]
    ds_read_b64_tr_b16 v[104:105], v172 offset:128
    ds_read_b64_tr_b16 v[106:107], v172 offset:3712
    v_mfma_f32_16x16x32_bf16 v[40:43], v[68:71], v[120:123], v[40:43]
    ds_read_b64_tr_b16 v[108:109], v172 offset:160
    ds_read_b64_tr_b16 v[110:111], v172 offset:3744
    v_mfma_f32_16x16x32_bf16 v[16:19], v[72:75], v[116:119], v[16:19]
    ds_read_b64_tr_b16 v[112:113], v172 offset:192
    ds_read_b64_tr_b16 v[114:115], v172 offset:3776
    v_mfma_f32_16x16x32_bf16 v[44:47], v[72:75], v[120:123], v[44:47]
    v_add_f32 v178, v174, v176
    v_mov_b32 v179, v178
    v_mfma_f32_16x16x32_bf16 v[20:23], v[76:79], v[116:119], v[20:23]
    s_nop 0
    v_permlane16_swap_b32 v178, v179
    v_add_f32 v178, v178, v179
    v_mfma_f32_16x16x32_bf16 v[48:51], v[76:79], v[120:123], v[48:51]
    v_mov_b32 v179, v178
    s_nop 1
    v_permlane32_swap_b32 v178, v179
    v_mfma_f32_16x16x32_bf16 v[24:27], v[80:83], v[116:119], v[24:27]
    v_add_f32 v178, v178, v179
    v_mul_f32 v178, 0x3e000000, v178
    v_mfma_f32_16x16x32_bf16 v[52:55], v[80:83], v[120:123], v[52:55]
    v_sub_f32 v174, v174, v178
    buffer_load_dwordx4 a[172:175], v182, s[56:59], s61 offen offset:3072
    v_mfma_f32_16x16x32_bf16 v[28:31], v[84:87], v[116:119], v[28:31]
    s_add_u32 s61, s60, 331776
    v_mfma_f32_16x16x32_bf16 v[56:59], v[84:87], v[120:123], v[56:59]
    v_add_u32 v172, 7168, v172
    global_load_dwordx4 v[116:119], v183, s[86:87] offset:0 sc1
    global_load_dwordx4 v[120:123], v183, s[68:69] offset:0 sc1
    s_waitcnt lgkmcnt(0)
    v_mfma_f32_16x16x32_bf16 v[4:7], v[88:91], v[124:127], v[4:7]
    ds_read_b64_tr_b16 v[60:61], v172 offset:0
    ds_read_b64_tr_b16 v[62:63], v172 offset:3584
    v_mfma_f32_16x16x32_bf16 v[32:35], v[88:91], v[128:131], v[32:35]
    ds_read_b64_tr_b16 v[64:65], v172 offset:32
    ds_read_b64_tr_b16 v[66:67], v172 offset:3616
    v_mfma_f32_16x16x32_bf16 v[8:11], v[92:95], v[124:127], v[8:11]
    ds_read_b64_tr_b16 v[68:69], v172 offset:64
    ds_read_b64_tr_b16 v[70:71], v172 offset:3648
    v_mfma_f32_16x16x32_bf16 v[36:39], v[92:95], v[128:131], v[36:39]
    ds_read_b64_tr_b16 v[72:73], v172 offset:96
    ds_read_b64_tr_b16 v[74:75], v172 offset:3680
    v_mfma_f32_16x16x32_bf16 v[12:15], v[96:99], v[124:127], v[12:15]
    ds_read_b64_tr_b16 v[76:77], v172 offset:128
    ds_read_b64_tr_b16 v[78:79], v172 offset:3712
    v_mfma_f32_16x16x32_bf16 v[40:43], v[96:99], v[128:131], v[40:43]
    ds_read_b64_tr_b16 v[80:81], v172 offset:160
    ds_read_b64_tr_b16 v[82:83], v172 offset:3744
    v_mfma_f32_16x16x32_bf16 v[16:19], v[100:103], v[124:127], v[16:19]
    ds_read_b64_tr_b16 v[84:85], v172 offset:192
    ds_read_b64_tr_b16 v[86:87], v172 offset:3776
    v_mfma_f32_16x16x32_bf16 v[44:47], v[100:103], v[128:131], v[44:47]
    v_sub_f32 v176, v176, v178
    v_mul_f32 v174, v174, v174
    v_mfma_f32_16x16x32_bf16 v[20:23], v[104:107], v[124:127], v[20:23]
    v_fmac_f32 v174, v176, v176
    v_add_f32 v175, v175, v177
    v_mfma_f32_16x16x32_bf16 v[48:51], v[104:107], v[128:131], v[48:51]
    v_mov_b32 v179, 0x42a00000
    v_fmac_f32 v175, v174, v179
    v_mfma_f32_16x16x32_bf16 v[24:27], v[108:111], v[124:127], v[24:27]
    v_mov_b32 v179, v175
    s_nop 1
    v_permlane16_swap_b32 v175, v179
    v_mfma_f32_16x16x32_bf16 v[52:55], v[108:111], v[128:131], v[52:55]
    v_add_f32 v175, v175, v179
    buffer_load_dwordx4 a[176:179], v182, s[56:59], s61 offen offset:0
    v_mfma_f32_16x16x32_bf16 v[28:31], v[112:115], v[124:127], v[28:31]
    s_add_u32 s61, s60, 368640
    v_mfma_f32_16x16x32_bf16 v[56:59], v[112:115], v[128:131], v[56:59]
    v_add_u32 v172, 7168, v172
    global_load_dwordx4 v[124:127], v183, s[86:87] offset:1024 sc1
    global_load_dwordx4 v[128:131], v183, s[68:69] offset:1024 sc1
    s_waitcnt lgkmcnt(0)
    s_waitcnt vmcnt(16)
    v_mfma_f32_16x16x32_bf16 v[4:7], v[60:63], v[132:135], v[4:7]
    ds_read_b64_tr_b16 v[88:89], v172 offset:0
    ds_read_b64_tr_b16 v[90:91], v172 offset:3584
    v_mfma_f32_16x16x32_bf16 v[32:35], v[60:63], v[136:139], v[32:35]
    ds_read_b64_tr_b16 v[92:93], v172 offset:32
    ds_read_b64_tr_b16 v[94:95], v172 offset:3616
    v_mfma_f32_16x16x32_bf16 v[8:11], v[64:67], v[132:135], v[8:11]
    ds_read_b64_tr_b16 v[96:97], v172 offset:64
    ds_read_b64_tr_b16 v[98:99], v172 offset:3648
    v_mfma_f32_16x16x32_bf16 v[36:39], v[64:67], v[136:139], v[36:39]
    ds_read_b64_tr_b16 v[100:101], v172 offset:96
    ds_read_b64_tr_b16 v[102:103], v172 offset:3680
    v_mfma_f32_16x16x32_bf16 v[12:15], v[68:71], v[132:135], v[12:15]
    ds_read_b64_tr_b16 v[104:105], v172 offset:128
    ds_read_b64_tr_b16 v[106:107], v172 offset:3712
    v_mfma_f32_16x16x32_bf16 v[40:43], v[68:71], v[136:139], v[40:43]
    ds_read_b64_tr_b16 v[108:109], v172 offset:160
    ds_read_b64_tr_b16 v[110:111], v172 offset:3744
    v_mfma_f32_16x16x32_bf16 v[16:19], v[72:75], v[132:135], v[16:19]
    ds_read_b64_tr_b16 v[112:113], v172 offset:192
    ds_read_b64_tr_b16 v[114:115], v172 offset:3776
    v_mfma_f32_16x16x32_bf16 v[44:47], v[72:75], v[136:139], v[44:47]
    v_mov_b32 v179, v175
    s_nop 1
    v_permlane32_swap_b32 v175, v179
    v_mfma_f32_16x16x32_bf16 v[20:23], v[76:79], v[132:135], v[20:23]
    v_add_f32 v175, v175, v179
    v_mul_f32 v175, 0x3acccccd, v175
    v_mfma_f32_16x16x32_bf16 v[48:51], v[76:79], v[136:139], v[48:51]
    v_cvt_pk_bf16_f32 v179, v175, v175
    v_lshlrev_b32 v175, 16, v179
    v_mfma_f32_16x16x32_bf16 v[24:27], v[80:83], v[132:135], v[24:27]
    v_add_f32 v175, 0x3727c5ac, v175
    v_cvt_pk_bf16_f32 v179, v175, v175
    v_mfma_f32_16x16x32_bf16 v[52:55], v[80:83], v[136:139], v[52:55]
    v_lshlrev_b32 v175, 16, v179
    buffer_load_dwordx4 a[180:183], v182, s[56:59], s61 offen offset:0
    v_mfma_f32_16x16x32_bf16 v[28:31], v[84:87], v[132:135], v[28:31]
    buffer_load_dwordx4 a[184:187], v182, s[56:59], s61 offen offset:1024
    v_mfma_f32_16x16x32_bf16 v[56:59], v[84:87], v[136:139], v[56:59]
    v_add_u32 v172, 7168, v172
    global_load_dwordx4 v[132:135], v183, s[86:87] offset:2048 sc1
    global_load_dwordx4 v[136:139], v183, s[68:69] offset:2048 sc1
    s_waitcnt lgkmcnt(0)
    s_waitcnt vmcnt(17)
    v_mfma_f32_16x16x32_bf16 v[4:7], v[88:91], v[140:143], v[4:7]
    ds_read_b64_tr_b16 v[60:61], v172 offset:0
    ds_read_b64_tr_b16 v[62:63], v172 offset:3584
    v_mfma_f32_16x16x32_bf16 v[32:35], v[88:91], v[144:147], v[32:35]
    ds_read_b64_tr_b16 v[64:65], v172 offset:32
    ds_read_b64_tr_b16 v[66:67], v172 offset:3616
    v_mfma_f32_16x16x32_bf16 v[8:11], v[92:95], v[140:143], v[8:11]
    ds_read_b64_tr_b16 v[68:69], v172 offset:64
    ds_read_b64_tr_b16 v[70:71], v172 offset:3648
    v_mfma_f32_16x16x32_bf16 v[36:39], v[92:95], v[144:147], v[36:39]
    ds_read_b64_tr_b16 v[72:73], v172 offset:96
    ds_read_b64_tr_b16 v[74:75], v172 offset:3680
    v_mfma_f32_16x16x32_bf16 v[12:15], v[96:99], v[140:143], v[12:15]
    ds_read_b64_tr_b16 v[76:77], v172 offset:128
    ds_read_b64_tr_b16 v[78:79], v172 offset:3712
    v_mfma_f32_16x16x32_bf16 v[40:43], v[96:99], v[144:147], v[40:43]
    ds_read_b64_tr_b16 v[80:81], v172 offset:160
    ds_read_b64_tr_b16 v[82:83], v172 offset:3744
    v_mfma_f32_16x16x32_bf16 v[16:19], v[100:103], v[140:143], v[16:19]
    ds_read_b64_tr_b16 v[84:85], v172 offset:192
    v_mfma_f32_16x16x32_bf16 v[44:47], v[100:103], v[144:147], v[44:47]
    ds_read_b64_tr_b16 v[86:87], v172 offset:3776
    v_sqrt_f32 v175, v175
    v_mfma_f32_16x16x32_bf16 v[20:23], v[104:107], v[140:143], v[20:23]
    s_nop 0
    v_cvt_pk_bf16_f32 v179, v175, v175
    v_mfma_f32_16x16x32_bf16 v[48:51], v[104:107], v[144:147], v[48:51]
    v_lshlrev_b32 v175, 16, v179
    v_rcp_f32 v165, v175
    v_mfma_f32_16x16x32_bf16 v[24:27], v[108:111], v[140:143], v[24:27]
    v_cvt_pk_bf16_f32 v179, v178, v178
    v_lshlrev_b32 v178, 16, v179
    v_mfma_f32_16x16x32_bf16 v[52:55], v[108:111], v[144:147], v[52:55]
    v_mov_b32 v164, v178
    buffer_load_dwordx4 a[188:191], v182, s[56:59], s61 offen offset:2048
    v_mfma_f32_16x16x32_bf16 v[28:31], v[112:115], v[140:143], v[28:31]
    buffer_load_dwordx4 a[192:195], v182, s[56:59], s61 offen offset:3072
    v_mfma_f32_16x16x32_bf16 v[56:59], v[112:115], v[144:147], v[56:59]
    v_add_u32 v172, 7168, v172
    global_load_dwordx4 v[140:143], v183, s[86:87] offset:3072 sc1
    global_load_dwordx4 v[144:147], v183, s[68:69] offset:3072 sc1
    v_add_u32 v183, 4096, v183
    s_waitcnt lgkmcnt(0)
    s_waitcnt vmcnt(18)
    v_mfma_f32_16x16x32_bf16 v[4:7], v[60:63], v[148:151], v[4:7]
    ds_read_b64_tr_b16 v[88:89], v172 offset:0
    ds_read_b64_tr_b16 v[90:91], v172 offset:3584
    v_mfma_f32_16x16x32_bf16 v[32:35], v[60:63], v[152:155], v[32:35]
    ds_read_b64_tr_b16 v[92:93], v172 offset:32
    v_mfma_f32_16x16x32_bf16 v[8:11], v[64:67], v[148:151], v[8:11]
    ds_read_b64_tr_b16 v[94:95], v172 offset:3616
    ds_read_b64_tr_b16 v[96:97], v172 offset:64
    v_mfma_f32_16x16x32_bf16 v[36:39], v[64:67], v[152:155], v[36:39]
    ds_read_b64_tr_b16 v[98:99], v172 offset:3648
    v_mfma_f32_16x16x32_bf16 v[12:15], v[68:71], v[148:151], v[12:15]
    ds_read_b64_tr_b16 v[100:101], v172 offset:96
    v_mfma_f32_16x16x32_bf16 v[40:43], v[68:71], v[152:155], v[40:43]
    ds_read_b64_tr_b16 v[102:103], v172 offset:3680
    ds_read_b64_tr_b16 v[104:105], v172 offset:128
    v_mfma_f32_16x16x32_bf16 v[16:19], v[72:75], v[148:151], v[16:19]
    ds_read_b64_tr_b16 v[106:107], v172 offset:3712
    v_mfma_f32_16x16x32_bf16 v[44:47], v[72:75], v[152:155], v[44:47]
    ds_read_b64_tr_b16 v[108:109], v172 offset:160
    ds_read_b64_tr_b16 v[110:111], v172 offset:3744
    v_mfma_f32_16x16x32_bf16 v[20:23], v[76:79], v[148:151], v[20:23]
    ds_read_b64_tr_b16 v[112:113], v172 offset:192
    v_mfma_f32_16x16x32_bf16 v[48:51], v[76:79], v[152:155], v[48:51]
    ds_read_b64_tr_b16 v[114:115], v172 offset:3776
    v_mfma_f32_16x16x32_bf16 v[24:27], v[80:83], v[148:151], v[24:27]
    global_load_dwordx4 v[174:177], v169, s[38:39] offset:2048 sc1
    global_load_dwordx4 v[178:181], v169, s[38:39] offset:2064 sc1
    v_mfma_f32_16x16x32_bf16 v[52:55], v[80:83], v[152:155], v[52:55]
    s_add_u32 s61, s60, 372736
    v_mfma_f32_16x16x32_bf16 v[28:31], v[84:87], v[148:151], v[28:31]
    buffer_load_dwordx4 a[196:199], v182, s[56:59], s61 offen offset:0
    v_mfma_f32_16x16x32_bf16 v[56:59], v[84:87], v[152:155], v[56:59]
    v_add_u32 v172, 7168, v172
    global_load_dwordx4 v[148:151], v183, s[86:87] offset:0 sc1
    global_load_dwordx4 v[152:155], v183, s[68:69] offset:0 sc1
    s_waitcnt lgkmcnt(0)
    s_waitcnt vmcnt(19)
    v_mfma_f32_16x16x32_bf16 v[4:7], v[88:91], v[156:159], v[4:7]
    ds_read_b64_tr_b16 v[60:61], v172 offset:0
    ds_read_b64_tr_b16 v[62:63], v172 offset:3584
    v_mfma_f32_16x16x32_bf16 v[32:35], v[88:91], v[160:163], v[32:35]
    ds_read_b64_tr_b16 v[64:65], v172 offset:32
    v_mfma_f32_16x16x32_bf16 v[8:11], v[92:95], v[156:159], v[8:11]
    ds_read_b64_tr_b16 v[66:67], v172 offset:3616
    v_mfma_f32_16x16x32_bf16 v[36:39], v[92:95], v[160:163], v[36:39]
    ds_read_b64_tr_b16 v[68:69], v172 offset:64
    v_mfma_f32_16x16x32_bf16 v[12:15], v[96:99], v[156:159], v[12:15]
    ds_read_b64_tr_b16 v[70:71], v172 offset:3648
    ds_read_b64_tr_b16 v[72:73], v172 offset:96
    v_mfma_f32_16x16x32_bf16 v[40:43], v[96:99], v[160:163], v[40:43]
    ds_read_b64_tr_b16 v[74:75], v172 offset:3680
    v_mfma_f32_16x16x32_bf16 v[16:19], v[100:103], v[156:159], v[16:19]
    ds_read_b64_tr_b16 v[76:77], v172 offset:128
    v_mfma_f32_16x16x32_bf16 v[44:47], v[100:103], v[160:163], v[44:47]
    ds_read_b64_tr_b16 v[78:79], v172 offset:3712
    v_mfma_f32_16x16x32_bf16 v[20:23], v[104:107], v[156:159], v[20:23]
    ds_read_b64_tr_b16 v[80:81], v172 offset:160
    ds_read_b64_tr_b16 v[82:83], v172 offset:3744
    v_mfma_f32_16x16x32_bf16 v[48:51], v[104:107], v[160:163], v[48:51]
    ds_read_b64_tr_b16 v[84:85], v172 offset:192
    v_mfma_f32_16x16x32_bf16 v[24:27], v[108:111], v[156:159], v[24:27]
    ds_read_b64_tr_b16 v[86:87], v172 offset:3776
    v_mfma_f32_16x16x32_bf16 v[52:55], v[108:111], v[160:163], v[52:55]
    s_add_u32 s61, s60, 409600
    v_mfma_f32_16x16x32_bf16 v[28:31], v[112:115], v[156:159], v[28:31]
    buffer_load_dwordx4 a[200:203], v182, s[56:59], s61 offen offset:0
    v_mfma_f32_16x16x32_bf16 v[56:59], v[112:115], v[160:163], v[56:59]
    v_add_u32 v172, 7168, v172
    global_load_dwordx4 v[156:159], v183, s[86:87] offset:1024 sc1
    global_load_dwordx4 v[160:163], v183, s[68:69] offset:1024 sc1
    s_waitcnt lgkmcnt(0)
    s_waitcnt vmcnt(19)
    v_mfma_f32_16x16x32_bf16 v[4:7], v[60:63], v[116:119], v[4:7]
    ds_read_b64_tr_b16 v[88:89], v172 offset:0
    ds_read_b64_tr_b16 v[90:91], v172 offset:3584
    v_mfma_f32_16x16x32_bf16 v[32:35], v[60:63], v[120:123], v[32:35]
    ds_read_b64_tr_b16 v[92:93], v172 offset:32
    v_mfma_f32_16x16x32_bf16 v[8:11], v[64:67], v[116:119], v[8:11]
    ds_read_b64_tr_b16 v[94:95], v172 offset:3616
    v_mfma_f32_16x16x32_bf16 v[36:39], v[64:67], v[120:123], v[36:39]
    ds_read_b64_tr_b16 v[96:97], v172 offset:64
    v_mfma_f32_16x16x32_bf16 v[12:15], v[68:71], v[116:119], v[12:15]
    ds_read_b64_tr_b16 v[98:99], v172 offset:3648
    ds_read_b64_tr_b16 v[100:101], v172 offset:96
    v_mfma_f32_16x16x32_bf16 v[40:43], v[68:71], v[120:123], v[40:43]
    ds_read_b64_tr_b16 v[102:103], v172 offset:3680
    v_mfma_f32_16x16x32_bf16 v[16:19], v[72:75], v[116:119], v[16:19]
    ds_read_b64_tr_b16 v[104:105], v172 offset:128
    v_mfma_f32_16x16x32_bf16 v[44:47], v[72:75], v[120:123], v[44:47]
    ds_read_b64_tr_b16 v[106:107], v172 offset:3712
    v_mfma_f32_16x16x32_bf16 v[20:23], v[76:79], v[116:119], v[20:23]
    ds_read_b64_tr_b16 v[108:109], v172 offset:160
    ds_read_b64_tr_b16 v[110:111], v172 offset:3744
    v_mfma_f32_16x16x32_bf16 v[48:51], v[76:79], v[120:123], v[48:51]
    ds_read_b64_tr_b16 v[112:113], v172 offset:192
    v_mfma_f32_16x16x32_bf16 v[24:27], v[80:83], v[116:119], v[24:27]
    ds_read_b64_tr_b16 v[114:115], v172 offset:3776
    v_mfma_f32_16x16x32_bf16 v[52:55], v[80:83], v[120:123], v[52:55]
    buffer_load_dwordx4 a[204:207], v182, s[56:59], s61 offen offset:1024
    v_mfma_f32_16x16x32_bf16 v[28:31], v[84:87], v[116:119], v[28:31]
    buffer_load_dwordx4 a[208:211], v182, s[56:59], s61 offen offset:2048
    v_mfma_f32_16x16x32_bf16 v[56:59], v[84:87], v[120:123], v[56:59]
    v_add_u32 v172, 7168, v172
    global_load_dwordx4 v[116:119], v183, s[86:87] offset:2048 sc1
    global_load_dwordx4 v[120:123], v183, s[68:69] offset:2048 sc1
    s_waitcnt lgkmcnt(0)
    s_waitcnt vmcnt(20)
    v_mfma_f32_16x16x32_bf16 v[4:7], v[88:91], v[124:127], v[4:7]
    ds_read_b64_tr_b16 v[60:61], v172 offset:0
    ds_read_b64_tr_b16 v[62:63], v172 offset:3584
    v_mfma_f32_16x16x32_bf16 v[32:35], v[88:91], v[128:131], v[32:35]
    ds_read_b64_tr_b16 v[64:65], v172 offset:32
    v_mfma_f32_16x16x32_bf16 v[8:11], v[92:95], v[124:127], v[8:11]
    ds_read_b64_tr_b16 v[66:67], v172 offset:3616
    ds_read_b64_tr_b16 v[68:69], v172 offset:64
    v_mfma_f32_16x16x32_bf16 v[36:39], v[92:95], v[128:131], v[36:39]
    ds_read_b64_tr_b16 v[70:71], v172 offset:3648
    v_mfma_f32_16x16x32_bf16 v[12:15], v[96:99], v[124:127], v[12:15]
    ds_read_b64_tr_b16 v[72:73], v172 offset:96
    v_mfma_f32_16x16x32_bf16 v[40:43], v[96:99], v[128:131], v[40:43]
    ds_read_b64_tr_b16 v[74:75], v172 offset:3680
    ds_read_b64_tr_b16 v[76:77], v172 offset:128
    v_mfma_f32_16x16x32_bf16 v[16:19], v[100:103], v[124:127], v[16:19]
    ds_read_b64_tr_b16 v[78:79], v172 offset:3712
    v_mfma_f32_16x16x32_bf16 v[44:47], v[100:103], v[128:131], v[44:47]
    ds_read_b64_tr_b16 v[80:81], v172 offset:160
    ds_read_b64_tr_b16 v[82:83], v172 offset:3744
    v_mfma_f32_16x16x32_bf16 v[20:23], v[104:107], v[124:127], v[20:23]
    ds_read_b64_tr_b16 v[84:85], v172 offset:192
    v_mfma_f32_16x16x32_bf16 v[48:51], v[104:107], v[128:131], v[48:51]
    ds_read_b64_tr_b16 v[86:87], v172 offset:3776
    v_mfma_f32_16x16x32_bf16 v[24:27], v[108:111], v[124:127], v[24:27]
    s_waitcnt vmcnt(10)
    v_xor_b32 v170, s101, v176
    v_xor_b32 v171, s101, v180
    v_or_b32 v170, v170, v171
    v_xor_b32 v171, v176, v177
    v_xor_b32 v171, s29, v171
    v_or_b32 v170, v170, v171
    v_xor_b32 v171, v180, v181
    v_xor_b32 v171, s29, v171
    v_or_b32 v170, v170, v171
    v_cmp_ne_u32 vcc, 0, v170
    s_cbranch_vccnz L_str_66
L_stb_67:
    v_mov_b32 v176, v178
    v_mfma_f32_16x16x32_bf16 v[52:55], v[108:111], v[128:131], v[52:55]
    v_mov_b32 v177, v179
    v_mfma_f32_16x16x32_bf16 v[28:31], v[112:115], v[124:127], v[28:31]
    buffer_load_dwordx4 a[212:215], v182, s[56:59], s61 offen offset:3072
    v_mfma_f32_16x16x32_bf16 v[56:59], v[112:115], v[128:131], v[56:59]
    v_add_u32 v172, 7168, v172
    global_load_dwordx4 v[124:127], v183, s[86:87] offset:3072 sc1
    global_load_dwordx4 v[128:131], v183, s[68:69] offset:3072 sc1
    v_add_u32 v183, 4096, v183
    s_waitcnt lgkmcnt(0)
    v_mfma_f32_16x16x32_bf16 v[4:7], v[60:63], v[132:135], v[4:7]
    ds_read_b64_tr_b16 v[88:89], v172 offset:0
    ds_read_b64_tr_b16 v[90:91], v172 offset:3584
    v_mfma_f32_16x16x32_bf16 v[32:35], v[60:63], v[136:139], v[32:35]
    ds_read_b64_tr_b16 v[92:93], v172 offset:32
    ds_read_b64_tr_b16 v[94:95], v172 offset:3616
    v_mfma_f32_16x16x32_bf16 v[8:11], v[64:67], v[132:135], v[8:11]
    ds_read_b64_tr_b16 v[96:97], v172 offset:64
    ds_read_b64_tr_b16 v[98:99], v172 offset:3648
    v_mfma_f32_16x16x32_bf16 v[36:39], v[64:67], v[136:139], v[36:39]
    ds_read_b64_tr_b16 v[100:101], v172 offset:96
    ds_read_b64_tr_b16 v[102:103], v172 offset:3680
    v_mfma_f32_16x16x32_bf16 v[12:15], v[68:71], v[132:135], v[12:15]
    ds_read_b64_tr_b16 v[104:105], v172 offset:128
    v_mfma_f32_16x16x32_bf16 v[40:43], v[68:71], v[136:139], v[40:43]
    ds_read_b64_tr_b16 v[106:107], v172 offset:3712
    ds_read_b64_tr_b16 v[108:109], v172 offset:160
    v_mfma_f32_16x16x32_bf16 v[16:19], v[72:75], v[132:135], v[16:19]
    ds_read_b64_tr_b16 v[110:111], v172 offset:3744
    ds_read_b64_tr_b16 v[112:113], v172 offset:192
    v_mfma_f32_16x16x32_bf16 v[44:47], v[72:75], v[136:139], v[44:47]
    ds_read_b64_tr_b16 v[114:115], v172 offset:3776
    v_add_f32 v178, v174, v176
    v_mfma_f32_16x16x32_bf16 v[20:23], v[76:79], v[132:135], v[20:23]
    v_mov_b32 v179, v178
    v_mfma_f32_16x16x32_bf16 v[48:51], v[76:79], v[136:139], v[48:51]
    s_nop 0
    v_permlane16_swap_b32 v178, v179
    v_add_f32 v178, v178, v179
    v_mfma_f32_16x16x32_bf16 v[24:27], v[80:83], v[132:135], v[24:27]
    v_mov_b32 v179, v178
    s_nop 1
    v_permlane32_swap_b32 v178, v179
    v_mfma_f32_16x16x32_bf16 v[52:55], v[80:83], v[136:139], v[52:55]
    v_add_f32 v178, v178, v179
    v_mul_f32 v178, 0x3e000000, v178
    v_mfma_f32_16x16x32_bf16 v[28:31], v[84:87], v[132:135], v[28:31]
    v_sub_f32 v174, v174, v178
    v_mfma_f32_16x16x32_bf16 v[56:59], v[84:87], v[136:139], v[56:59]
    v_add_u32 v172, 7168, v172
    s_waitcnt lgkmcnt(0)
    v_mfma_f32_16x16x32_bf16 v[4:7], v[88:91], v[140:143], v[4:7]
    ds_read_b64_tr_b16 v[60:61], v172 offset:0
    ds_read_b64_tr_b16 v[62:63], v172 offset:3584
    v_mfma_f32_16x16x32_bf16 v[32:35], v[88:91], v[144:147], v[32:35]
    ds_read_b64_tr_b16 v[64:65], v172 offset:32
    ds_read_b64_tr_b16 v[66:67], v172 offset:3616
    v_mfma_f32_16x16x32_bf16 v[8:11], v[92:95], v[140:143], v[8:11]
    ds_read_b64_tr_b16 v[68:69], v172 offset:64
    ds_read_b64_tr_b16 v[70:71], v172 offset:3648
    v_mfma_f32_16x16x32_bf16 v[36:39], v[92:95], v[144:147], v[36:39]
    ds_read_b64_tr_b16 v[72:73], v172 offset:96
    ds_read_b64_tr_b16 v[74:75], v172 offset:3680
    v_mfma_f32_16x16x32_bf16 v[12:15], v[96:99], v[140:143], v[12:15]
    ds_read_b64_tr_b16 v[76:77], v172 offset:128
    v_mfma_f32_16x16x32_bf16 v[40:43], v[96:99], v[144:147], v[40:43]
    ds_read_b64_tr_b16 v[78:79], v172 offset:3712
    ds_read_b64_tr_b16 v[80:81], v172 offset:160
    v_mfma_f32_16x16x32_bf16 v[16:19], v[100:103], v[140:143], v[16:19]
    ds_read_b64_tr_b16 v[82:83], v172 offset:3744
    ds_read_b64_tr_b16 v[84:85], v172 offset:192
    v_mfma_f32_16x16x32_bf16 v[44:47], v[100:103], v[144:147], v[44:47]
    ds_read_b64_tr_b16 v[86:87], v172 offset:3776
    v_sub_f32 v176, v176, v178
    v_mfma_f32_16x16x32_bf16 v[20:23], v[104:107], v[140:143], v[20:23]
    v_mul_f32 v174, v174, v174
    v_mfma_f32_16x16x32_bf16 v[48:51], v[104:107], v[144:147], v[48:51]
    v_fmac_f32 v174, v176, v176
    v_add_f32 v175, v175, v177
    v_mfma_f32_16x16x32_bf16 v[24:27], v[108:111], v[140:143], v[24:27]
    v_mov_b32 v179, 0x42a00000
    v_fmac_f32 v175, v174, v179
    v_mfma_f32_16x16x32_bf16 v[52:55], v[108:111], v[144:147], v[52:55]
    v_mov_b32 v179, v175
    s_nop 1
    v_permlane16_swap_b32 v175, v179
    v_mfma_f32_16x16x32_bf16 v[28:31], v[112:115], v[140:143], v[28:31]
    v_add_f32 v175, v175, v179
    v_mfma_f32_16x16x32_bf16 v[56:59], v[112:115], v[144:147], v[56:59]
    v_add_u32 v172, 7168, v172
    s_waitcnt lgkmcnt(0)
    s_waitcnt vmcnt(10)
    v_mfma_f32_16x16x32_bf16 v[4:7], v[60:63], v[148:151], v[4:7]
    ds_read_b64_tr_b16 v[88:89], v172 offset:0
    ds_read_b64_tr_b16 v[90:91], v172 offset:3584
    v_mfma_f32_16x16x32_bf16 v[32:35], v[60:63], v[152:155], v[32:35]
    ds_read_b64_tr_b16 v[92:93], v172 offset:32
    ds_read_b64_tr_b16 v[94:95], v172 offset:3616
    v_mfma_f32_16x16x32_bf16 v[8:11], v[64:67], v[148:151], v[8:11]
    ds_read_b64_tr_b16 v[96:97], v172 offset:64
    ds_read_b64_tr_b16 v[98:99], v172 offset:3648
    v_mfma_f32_16x16x32_bf16 v[36:39], v[64:67], v[152:155], v[36:39]
    ds_read_b64_tr_b16 v[100:101], v172 offset:96
    ds_read_b64_tr_b16 v[102:103], v172 offset:3680
    v_mfma_f32_16x16x32_bf16 v[12:15], v[68:71], v[148:151], v[12:15]
    ds_read_b64_tr_b16 v[104:105], v172 offset:128
    v_mfma_f32_16x16x32_bf16 v[40:43], v[68:71], v[152:155], v[40:43]
    ds_read_b64_tr_b16 v[106:107], v172 offset:3712
    ds_read_b64_tr_b16 v[108:109], v172 offset:160
    v_mfma_f32_16x16x32_bf16 v[16:19], v[72:75], v[148:151], v[16:19]
    ds_read_b64_tr_b16 v[110:111], v172 offset:3744
    ds_read_b64_tr_b16 v[112:113], v172 offset:192
    v_mfma_f32_16x16x32_bf16 v[44:47], v[72:75], v[152:155], v[44:47]
    ds_read_b64_tr_b16 v[114:115], v172 offset:3776
    v_mov_b32 v179, v175
    v_mfma_f32_16x16x32_bf16 v[20:23], v[76:79], v[148:151], v[20:23]
    s_nop 0
    v_permlane32_swap_b32 v175, v179
    v_mfma_f32_16x16x32_bf16 v[48:51], v[76:79], v[152:155], v[48:51]
    v_add_f32 v175, v175, v179
    v_mul_f32 v175, 0x3acccccd, v175
    v_mfma_f32_16x16x32_bf16 v[24:27], v[80:83], v[148:151], v[24:27]
    v_cvt_pk_bf16_f32 v179, v175, v175
    v_lshlrev_b32 v175, 16, v179
    v_mfma_f32_16x16x32_bf16 v[52:55], v[80:83], v[152:155], v[52:55]
    v_add_f32 v175, 0x3727c5ac, v175
    v_cvt_pk_bf16_f32 v179, v175, v175
    v_mfma_f32_16x16x32_bf16 v[28:31], v[84:87], v[148:151], v[28:31]
    v_lshlrev_b32 v175, 16, v179
    v_mfma_f32_16x16x32_bf16 v[56:59], v[84:87], v[152:155], v[56:59]
    v_add_u32 v172, 7168, v172
    s_waitcnt lgkmcnt(0)
    s_waitcnt vmcnt(7)
    v_mfma_f32_16x16x32_bf16 v[4:7], v[88:91], v[156:159], v[4:7]
    ds_read_b64_tr_b16 v[60:61], v172 offset:0
    ds_read_b64_tr_b16 v[62:63], v172 offset:3584
    v_mfma_f32_16x16x32_bf16 v[32:35], v[88:91], v[160:163], v[32:35]
    ds_read_b64_tr_b16 v[64:65], v172 offset:32
    ds_read_b64_tr_b16 v[66:67], v172 offset:3616
    v_mfma_f32_16x16x32_bf16 v[8:11], v[92:95], v[156:159], v[8:11]
    ds_read_b64_tr_b16 v[68:69], v172 offset:64
    ds_read_b64_tr_b16 v[70:71], v172 offset:3648
    v_mfma_f32_16x16x32_bf16 v[36:39], v[92:95], v[160:163], v[36:39]
    ds_read_b64_tr_b16 v[72:73], v172 offset:96
    v_mfma_f32_16x16x32_bf16 v[12:15], v[96:99], v[156:159], v[12:15]
    ds_read_b64_tr_b16 v[74:75], v172 offset:3680
    ds_read_b64_tr_b16 v[76:77], v172 offset:128
    v_mfma_f32_16x16x32_bf16 v[40:43], v[96:99], v[160:163], v[40:43]
    ds_read_b64_tr_b16 v[78:79], v172 offset:3712
    ds_read_b64_tr_b16 v[80:81], v172 offset:160
    v_mfma_f32_16x16x32_bf16 v[16:19], v[100:103], v[156:159], v[16:19]
    ds_read_b64_tr_b16 v[82:83], v172 offset:3744
    v_mfma_f32_16x16x32_bf16 v[44:47], v[100:103], v[160:163], v[44:47]
    ds_read_b64_tr_b16 v[84:85], v172 offset:192
    ds_read_b64_tr_b16 v[86:87], v172 offset:3776
    v_mfma_f32_16x16x32_bf16 v[20:23], v[104:107], v[156:159], v[20:23]
    v_sqrt_f32 v175, v175
    s_nop 0
    v_mfma_f32_16x16x32_bf16 v[48:51], v[104:107], v[160:163], v[48:51]
    v_cvt_pk_bf16_f32 v179, v175, v175
    v_mfma_f32_16x16x32_bf16 v[24:27], v[108:111], v[156:159], v[24:27]
    v_lshlrev_b32 v175, 16, v179
    v_rcp_f32 v167, v175
    v_mfma_f32_16x16x32_bf16 v[52:55], v[108:111], v[160:163], v[52:55]
    v_cvt_pk_bf16_f32 v179, v178, v178
    v_lshlrev_b32 v178, 16, v179
    v_mfma_f32_16x16x32_bf16 v[28:31], v[112:115], v[156:159], v[28:31]
    v_mov_b32 v166, v178
    v_mfma_f32_16x16x32_bf16 v[56:59], v[112:115], v[160:163], v[56:59]
    v_add_u32 v172, 7168, v172
    s_waitcnt lgkmcnt(0)
    s_waitcnt vmcnt(3)
    v_mfma_f32_16x16x32_bf16 v[4:7], v[60:63], v[116:119], v[4:7]
    ds_read_b64_tr_b16 v[88:89], v172 offset:0
    ds_read_b64_tr_b16 v[90:91], v172 offset:3584
    v_mfma_f32_16x16x32_bf16 v[32:35], v[60:63], v[120:123], v[32:35]
    ds_read_b64_tr_b16 v[92:93], v172 offset:32
    v_mfma_f32_16x16x32_bf16 v[8:11], v[64:67], v[116:119], v[8:11]
    ds_read_b64_tr_b16 v[94:95], v172 offset:3616
    v_mfma_f32_16x16x32_bf16 v[36:39], v[64:67], v[120:123], v[36:39]
    ds_read_b64_tr_b16 v[96:97], v172 offset:64
    v_mfma_f32_16x16x32_bf16 v[12:15], v[68:71], v[116:119], v[12:15]
    ds_read_b64_tr_b16 v[98:99], v172 offset:3648
    v_mfma_f32_16x16x32_bf16 v[40:43], v[68:71], v[120:123], v[40:43]
    ds_read_b64_tr_b16 v[100:101], v172 offset:96
    v_mfma_f32_16x16x32_bf16 v[16:19], v[72:75], v[116:119], v[16:19]
    ds_read_b64_tr_b16 v[102:103], v172 offset:3680
    v_mfma_f32_16x16x32_bf16 v[44:47], v[72:75], v[120:123], v[44:47]
    ds_read_b64_tr_b16 v[104:105], v172 offset:128
    v_mfma_f32_16x16x32_bf16 v[20:23], v[76:79], v[116:119], v[20:23]
    ds_read_b64_tr_b16 v[106:107], v172 offset:3712
    v_mfma_f32_16x16x32_bf16 v[48:51], v[76:79], v[120:123], v[48:51]
    ds_read_b64_tr_b16 v[108:109], v172 offset:160
    v_mfma_f32_16x16x32_bf16 v[24:27], v[80:83], v[116:119], v[24:27]
    ds_read_b64_tr_b16 v[110:111], v172 offset:3744
    v_mfma_f32_16x16x32_bf16 v[52:55], v[80:83], v[120:123], v[52:55]
    ds_read_b64_tr_b16 v[112:113], v172 offset:192
    v_mfma_f32_16x16x32_bf16 v[28:31], v[84:87], v[116:119], v[28:31]
    ds_read_b64_tr_b16 v[114:115], v172 offset:3776
    v_mfma_f32_16x16x32_bf16 v[56:59], v[84:87], v[120:123], v[56:59]
    v_add_u32 v172, 7168, v172
    s_waitcnt lgkmcnt(0)
    s_waitcnt vmcnt(0)
    v_mfma_f32_16x16x32_bf16 v[4:7], v[88:91], v[124:127], v[4:7]
    v_mfma_f32_16x16x32_bf16 v[32:35], v[88:91], v[128:131], v[32:35]
    v_mfma_f32_16x16x32_bf16 v[8:11], v[92:95], v[124:127], v[8:11]
    v_mfma_f32_16x16x32_bf16 v[36:39], v[92:95], v[128:131], v[36:39]
    v_mfma_f32_16x16x32_bf16 v[12:15], v[96:99], v[124:127], v[12:15]
    v_mfma_f32_16x16x32_bf16 v[40:43], v[96:99], v[128:131], v[40:43]
    v_mfma_f32_16x16x32_bf16 v[16:19], v[100:103], v[124:127], v[16:19]
    v_mfma_f32_16x16x32_bf16 v[44:47], v[100:103], v[128:131], v[44:47]
    v_mfma_f32_16x16x32_bf16 v[20:23], v[104:107], v[124:127], v[20:23]
    v_mfma_f32_16x16x32_bf16 v[48:51], v[104:107], v[128:131], v[48:51]
    v_mfma_f32_16x16x32_bf16 v[24:27], v[108:111], v[124:127], v[24:27]
    v_mfma_f32_16x16x32_bf16 v[52:55], v[108:111], v[128:131], v[52:55]
    v_mfma_f32_16x16x32_bf16 v[28:31], v[112:115], v[124:127], v[28:31]
    v_mfma_f32_16x16x32_bf16 v[56:59], v[112:115], v[128:131], v[56:59]
    s_add_u32 s61, s60, 413696
    buffer_load_dwordx4 a[216:219], v182, s[56:59], s61 offen offset:0
    s_add_u32 s61, s60, 450560
    buffer_load_dwordx4 a[220:223], v182, s[56:59], s61 offen offset:0
    buffer_load_dwordx4 a[224:227], v182, s[56:59], s61 offen offset:1024
    buffer_load_dwordx4 a[228:231], v182, s[56:59], s61 offen offset:2048
    buffer_load_dwordx4 a[232:235], v182, s[56:59], s61 offen offset:3072
    s_add_u32 s61, s60, 454656
    buffer_load_dwordx4 a[236:239], v182, s[56:59], s61 offen offset:0
    s_add_u32 s61, s60, 491520
    buffer_load_dwordx4 a[240:243], v182, s[56:59], s61 offen offset:0
    buffer_load_dwordx4 a[244:247], v182, s[56:59], s61 offen offset:1024
    buffer_load_dwordx4 a[248:251], v182, s[56:59], s61 offen offset:2048
    buffer_load_dwordx4 a[252:255], v182, s[56:59], s61 offen offset:3072
    s_add_u32 s61, s60, 495616
    buffer_load_dwordx4 v[232:235], v182, s[56:59], s61 offen offset:0
    s_add_u32 s61, s60, 532480
    buffer_load_dwordx4 v[236:239], v182, s[56:59], s61 offen offset:0
    s_mov_b32 s27, 0
    s_call_b64 s[30:31], L_g1epi
    s_branch L_stx_68
L_str_64:
    s_mov_b32 s71, 400000
L_sti_69:
    global_load_dwordx4 v[174:177], v169, s[38:39] offset:0 sc1
    global_load_dwordx4 v[178:181], v169, s[38:39] offset:16 sc1
    s_sub_u32 s71, s71, 1
    s_cmp_eq_u32 s71, 0
    s_cbranch_scc1 L_abort
    s_waitcnt vmcnt(0)
    v_xor_b32 v170, s101, v176
    v_xor_b32 v171, s101, v180
    v_or_b32 v170, v170, v171
    v_xor_b32 v171, v176, v177
    v_xor_b32 v171, s29, v171
    v_or_b32 v170, v170, v171
    v_xor_b32 v171, v180, v181
    v_xor_b32 v171, s29, v171
    v_or_b32 v170, v170, v171
    v_cmp_ne_u32 vcc, 0, v170
    s_nop 4
    s_cbranch_vccnz L_sti_69
    s_branch L_stb_65
L_str_66:
    s_mov_b32 s71, 400000
L_sti_70:
    global_load_dwordx4 v[174:177], v169, s[38:39] offset:2048 sc1
    global_load_dwordx4 v[178:181], v169, s[38:39] offset:2064 sc1
    s_sub_u32 s71, s71, 1
    s_cmp_eq_u32 s71, 0
    s_cbranch_scc1 L_abort
    s_waitcnt vmcnt(0)
    v_xor_b32 v170, s101, v176
    v_xor_b32 v171, s101, v180
    v_or_b32 v170, v170, v171
    v_xor_b32 v171, v176, v177
    v_xor_b32 v171, s29, v171
    v_or_b32 v170, v170, v171
    v_xor_b32 v171, v180, v181
    v_xor_b32 v171, s29, v171
    v_or_b32 v170, v170, v171
    v_cmp_ne_u32 vcc, 0, v170
    s_nop 4
    s_cbranch_vccnz L_sti_70
    s_branch L_stb_67
L_stx_68:
    v_lshlrev_b32 v163, 4, v1
    s_waitcnt vmcnt(0) lgkmcnt(0)
    s_barrier
    s_cmp_lg_u32 s6, 0
    s_cbranch_scc1 L_iw_71
    s_lshl_b32 s50, s5, 3
    s_add_u32 s3, s28, 4
    v_mov_b32 v176, s3
    s_xor_b32 s3, s3, s29
    v_mov_b32 v177, s3
    v_mov_b32 v178, s50
    s_mov_b64 s[92:93], exec
    s_mov_b64 exec, 1
    s_cmp_eq_u32 s7, 0
    s_cbranch_scc0 L_slow_72
    global_store_dwordx2 v178, v[176:177], s[64:65]
    s_branch L_sd_73
L_slow_72:
    global_store_dwordx2 v178, v[176:177], s[64:65] sc0 sc1
L_sd_73:
    s_mov_b64 exec, s[92:93]
L_iw_71:
    s_add_u32 s61, s60, 532480
    buffer_load_dwordx4 v[240:243], v163, s[56:59], s61 offen offset:1024
    buffer_load_dwordx4 v[244:247], v163, s[56:59], s61 offen offset:2048
    buffer_load_dwordx4 v[248:251], v163, s[56:59], s61 offen offset:3072
    s_add_u32 s61, s60, 536576
    buffer_load_dwordx4 v[252:255], v163, s[56:59], s61 offen offset:0
    s_mul_i32 s3, s6, 14
    s_add_u32 s3, s3, 0
    s_min_u32 s3, s3, 53
    s_lshl_b32 s72, s3, 10
    s_mul_i32 s3, s6, 14
    s_add_u32 s3, s3, 1
    s_min_u32 s3, s3, 53
    s_lshl_b32 s73, s3, 10
    s_mul_i32 s3, s6, 14
    s_add_u32 s3, s3, 2
    s_min_u32 s3, s3, 53
    s_lshl_b32 s74, s3, 10
    s_mul_i32 s3, s6, 14
    s_add_u32 s3, s3, 3
    s_min_u32 s3, s3, 53
    s_lshl_b32 s75, s3, 10
    s_mul_i32 s3, s6, 14
    s_add_u32 s3, s3, 4
    s_min_u32 s3, s3, 53
    s_lshl_b32 s76, s3, 10
    s_mul_i32 s3, s6, 14
    s_add_u32 s3, s3, 5
    s_min_u32 s3, s3, 53
    s_lshl_b32 s77, s3, 10
    s_mul_i32 s3, s6, 14
    s_add_u32 s3, s3, 6
    s_min_u32 s3, s3, 53
    s_lshl_b32 s78, s3, 10
    s_mul_i32 s3, s6, 14
    s_add_u32 s3, s3, 7
    s_min_u32 s3, s3, 53
    s_lshl_b32 s79, s3, 10
    s_mul_i32 s3, s6, 14
    s_add_u32 s3, s3, 8
    s_min_u32 s3, s3, 53
    s_lshl_b32 s80, s3, 10
    s_mul_i32 s3, s6, 14
    s_add_u32 s3, s3, 9
    s_min_u32 s3, s3, 53
    s_lshl_b32 s81, s3, 10
    s_mul_i32 s3, s6, 14
    s_add_u32 s3, s3, 10
    s_min_u32 s3, s3, 53
    s_lshl_b32 s82, s3, 10
    s_mul_i32 s3, s6, 14
    s_add_u32 s3, s3, 11
    s_min_u32 s3, s3, 53
    s_lshl_b32 s83, s3, 10
    s_mul_i32 s3, s6, 14
    s_add_u32 s3, s3, 12
    s_min_u32 s3, s3, 53
    s_lshl_b32 s84, s3, 10
    s_mul_i32 s3, s6, 14
    s_add_u32 s3, s3, 13
    s_min_u32 s3, s3, 53
    s_lshl_b32 s85, s3, 10
    s_add_u32 s8, s38, 0
    s_addc_u32 s9, s39, 0
    s_and_b32 s9, s9, 0xffff
    s_mov_b32 s10, 268435456
    s_mov_b32 s11, 0x20000
    s_add_u32 s3, s6, 1
    s_and_b32 s3, s3, 3
    s_mul_i32 s51, s3, 5120
    s_lshl_b32 s50, s4, 4
    s_add_u32 s3, s3, s50
    s_lshl_b32 s50, s40, 2
    s_add_u32 s3, s3, s50
    s_mul_i32 s3, s3, 55296
    s_add_u32 s3, s3, 20971520
    v_lshlrev_b32 v100, 4, v1
    v_add_u32 v100, s3, v100
    v_lshlrev_b32 v104, 4, v1
    s_add_u32 s3, s51, 143360
    v_add_u32 v104, s3, v104
    s_add_u32 s3, s6, 2
    s_and_b32 s3, s3, 3
    s_mul_i32 s51, s3, 5120
    s_lshl_b32 s50, s4, 4
    s_add_u32 s3, s3, s50
    s_lshl_b32 s50, s40, 2
    s_add_u32 s3, s3, s50
    s_mul_i32 s3, s3, 55296
    s_add_u32 s3, s3, 20971520
    v_lshlrev_b32 v101, 4, v1
    v_add_u32 v101, s3, v101
    v_lshlrev_b32 v105, 4, v1
    s_add_u32 s3, s51, 143360
    v_add_u32 v105, s3, v105
    s_add_u32 s3, s6, 3
    s_and_b32 s3, s3, 3
    s_mul_i32 s51, s3, 5120
    s_lshl_b32 s50, s4, 4
    s_add_u32 s3, s3, s50
    s_lshl_b32 s50, s40, 2
    s_add_u32 s3, s3, s50
    s_mul_i32 s3, s3, 55296
    s_add_u32 s3, s3, 20971520
    v_lshlrev_b32 v102, 4, v1
    v_add_u32 v102, s3, v102
    v_lshlrev_b32 v106, 4, v1
    s_add_u32 s3, s51, 143360
    v_add_u32 v106, s3, v106
    s_add_u32 s3, s6, 4
    s_and_b32 s3, s3, 3
    s_mul_i32 s51, s3, 5120
    s_lshl_b32 s50, s4, 4
    s_add_u32 s3, s3, s50
    s_lshl_b32 s50, s40, 2
    s_add_u32 s3, s3, s50
    s_mul_i32 s3, s3, 55296
    s_add_u32 s3, s3, 20971520
    v_lshlrev_b32 v103, 4, v1
    v_add_u32 v103, s3, v103
    v_lshlrev_b32 v107, 4, v1
    s_add_u32 s3, s51, 143360
    v_add_u32 v107, s3, v107
    s_cmp_lg_u32 s6, 0
    s_nop 0
    s_cbranch_scc1 L_iw_74
    v_and_b32 v180, 31, v1
    v_lshlrev_b32 v180, 3, v180
    s_add_u32 s55, s28, 4
    s_mov_b32 s71, 400000
L_poll_75:
    global_load_dwordx2 v[176:177], v180, s[64:65] sc1
    s_sub_u32 s71, s71, 1
    s_cmp_eq_u32 s71, 0
    s_cbranch_scc1 L_abort
    s_waitcnt vmcnt(0)
    v_subrev_u32 v178, s55, v176
    v_cmp_lt_u32 vcc, 3, v178
    v_xor_b32 v178, v176, v177
    v_cmp_ne_u32 s[88:89], s29, v178
    s_or_b64 s[88:89], vcc, s[88:89]
    s_nop 3
    s_cbranch_scc1 L_poll_75
L_iw_74:
    s_barrier
    buffer_load_dwordx4 v[44:47], v100, s[8:11], s72 offen
    buffer_load_dwordx4 v[48:51], v100, s[8:11], s73 offen
    buffer_load_dwordx4 v[52:55], v100, s[8:11], s74 offen
    buffer_load_dwordx4 v[56:59], v100, s[8:11], s75 offen
    buffer_load_dwordx4 v[60:63], v100, s[8:11], s76 offen
    buffer_load_dwordx4 v[64:67], v100, s[8:11], s77 offen
    buffer_load_dwordx4 v[68:71], v100, s[8:11], s78 offen
    buffer_load_dwordx4 v[72:75], v100, s[8:11], s79 offen
    buffer_load_dwordx4 v[76:79], v100, s[8:11], s80 offen
    buffer_load_dwordx4 v[80:83], v100, s[8:11], s81 offen
    buffer_load_dwordx4 v[84:87], v100, s[8:11], s82 offen
    buffer_load_dwordx4 v[88:91], v100, s[8:11], s83 offen
    buffer_load_dwordx4 v[92:95], v100, s[8:11], s84 offen
    buffer_load_dwordx4 v[96:99], v100, s[8:11], s85 offen
    s_waitcnt vmcnt(13)
    v_mfma_f32_16x16x32_bf16 v[4:7], a[0:3], v[44:47], 0
    v_lshlrev_b32 v150, 16, v222
    v_mfma_f32_16x16x32_bf16 v[8:11], a[4:7], v[44:47], 0
    v_and_b32 v151, s45, v222
    v_mfma_f32_16x16x32_bf16 v[12:15], a[8:11], v[44:47], 0
    v_lshlrev_b32 v152, 16, v223
    v_mfma_f32_16x16x32_bf16 v[16:19], a[12:15], v[44:47], 0
    v_and_b32 v153, s45, v223
    v_mfma_f32_16x16x32_bf16 v[20:23], a[16:19], v[44:47], 0
    v_lshlrev_b32 v154, 16, v224
    buffer_load_dwordx4 v[44:47], v101, s[8:11], s72 offen
    s_waitcnt vmcnt(13)
    v_mfma_f32_16x16x32_bf16 v[4:7], a[20:23], v[48:51], v[4:7]
    v_and_b32 v155, s45, v224
    v_mfma_f32_16x16x32_bf16 v[8:11], a[24:27], v[48:51], v[8:11]
    v_lshlrev_b32 v156, 16, v225
    v_mfma_f32_16x16x32_bf16 v[12:15], a[28:31], v[48:51], v[12:15]
    v_and_b32 v157, s45, v225
    v_mfma_f32_16x16x32_bf16 v[16:19], a[32:35], v[48:51], v[16:19]
    v_lshlrev_b32 v158, 16, v226
    v_mfma_f32_16x16x32_bf16 v[20:23], a[36:39], v[48:51], v[20:23]
    v_and_b32 v159, s45, v226
    buffer_load_dwordx4 v[48:51], v101, s[8:11], s73 offen
    s_waitcnt vmcnt(13)
    v_mfma_f32_16x16x32_bf16 v[4:7], a[40:43], v[52:55], v[4:7]
    v_lshlrev_b32 v160, 16, v227
    v_mfma_f32_16x16x32_bf16 v[8:11], a[44:47], v[52:55], v[8:11]
    v_and_b32 v161, s45, v227
    v_mfma_f32_16x16x32_bf16 v[12:15], a[48:51], v[52:55], v[12:15]
    v_lshlrev_b32 v162, 16, v228
    v_mfma_f32_16x16x32_bf16 v[16:19], a[52:55], v[52:55], v[16:19]
    v_and_b32 v163, s45, v228
    v_mfma_f32_16x16x32_bf16 v[20:23], a[56:59], v[52:55], v[20:23]
    v_lshlrev_b32 v164, 16, v229
    buffer_load_dwordx4 v[52:55], v101, s[8:11], s74 offen
    s_waitcnt vmcnt(13)
    v_mfma_f32_16x16x32_bf16 v[4:7], a[60:63], v[56:59], v[4:7]
    v_and_b32 v165, s45, v229
    v_mfma_f32_16x16x32_bf16 v[8:11], a[64:67], v[56:59], v[8:11]
    v_lshlrev_b32 v166, 16, v230
    v_mfma_f32_16x16x32_bf16 v[12:15], a[68:71], v[56:59], v[12:15]
    v_and_b32 v167, s45, v230
    v_mfma_f32_16x16x32_bf16 v[16:19], a[72:75], v[56:59], v[16:19]
    v_lshlrev_b32 v168, 16, v231
    v_mfma_f32_16x16x32_bf16 v[20:23], a[76:79], v[56:59], v[20:23]
    v_and_b32 v169, s45, v231
    buffer_load_dwordx4 v[56:59], v101, s[8:11], s75 offen
    s_waitcnt vmcnt(13)
    v_mfma_f32_16x16x32_bf16 v[4:7], a[80:83], v[60:63], v[4:7]
    s_lshl_b32 s97, s4, 8
    v_mfma_f32_16x16x32_bf16 v[8:11], a[84:87], v[60:63], v[8:11]
    s_lshl_b32 s100, s40, 6
    v_mfma_f32_16x16x32_bf16 v[12:15], a[88:91], v[60:63], v[12:15]
    s_add_u32 s97, s97, s100
    v_mfma_f32_16x16x32_bf16 v[16:19], a[92:95], v[60:63], v[16:19]
    s_lshl_b32 s100, s6, 4
    v_mfma_f32_16x16x32_bf16 v[20:23], a[96:99], v[60:63], v[20:23]
    s_add_u32 s97, s97, s100
    buffer_load_dwordx4 v[60:63], v101, s[8:11], s76 offen
    s_waitcnt vmcnt(13)
    v_mfma_f32_16x16x32_bf16 v[4:7], a[100:103], v[64:67], v[4:7]
    v_add_u32 v171, s97, v2
    v_mfma_f32_16x16x32_bf16 v[8:11], a[104:107], v[64:67], v[8:11]
    v_lshlrev_b32 v171, 7, v171
    v_mfma_f32_16x16x32_bf16 v[12:15], a[108:111], v[64:67], v[12:15]
    s_lshl_b32 s100, s41, 4
    v_mfma_f32_16x16x32_bf16 v[16:19], a[112:115], v[64:67], v[16:19]
    v_add_u32 v170, s100, v171
    v_mfma_f32_16x16x32_bf16 v[20:23], a[116:119], v[64:67], v[20:23]
    v_lshl_add_u32 v171, v3, 5, v171
    buffer_load_dwordx4 v[64:67], v101, s[8:11], s77 offen
    s_waitcnt vmcnt(13)
    v_mfma_f32_16x16x32_bf16 v[4:7], a[120:123], v[68:71], v[4:7]
    s_lshl_b32 s97, s4, 4
    v_mfma_f32_16x16x32_bf16 v[8:11], a[124:127], v[68:71], v[8:11]
    s_lshl_b32 s100, s40, 2
    v_mfma_f32_16x16x32_bf16 v[12:15], a[128:131], v[68:71], v[12:15]
    s_add_u32 s97, s97, s100
    v_mfma_f32_16x16x32_bf16 v[16:19], a[132:135], v[68:71], v[16:19]
    s_add_u32 s97, s97, s6
    v_mfma_f32_16x16x32_bf16 v[20:23], a[136:139], v[68:71], v[20:23]
    s_mul_i32 s97, s97, 20480
    buffer_load_dwordx4 v[68:71], v101, s[8:11], s78 offen
    s_waitcnt vmcnt(13)
    v_mfma_f32_16x16x32_bf16 v[4:7], a[140:143], v[72:75], v[4:7]
    s_add_u32 s97, s97, s91
    v_mfma_f32_16x16x32_bf16 v[8:11], a[144:147], v[72:75], v[8:11]
    v_lshlrev_b32 v179, 4, v1
    v_mfma_f32_16x16x32_bf16 v[12:15], a[148:151], v[72:75], v[12:15]
    v_add_u32 v179, s97, v179
    v_mfma_f32_16x16x32_bf16 v[16:19], a[152:155], v[72:75], v[16:19]
    s_mul_i32 s97, s41, 5
    v_mfma_f32_16x16x32_bf16 v[20:23], a[156:159], v[72:75], v[20:23]
    s_add_u32 s100, s97, 0
    buffer_load_dwordx4 v[72:75], v101, s[8:11], s79 offen
    s_waitcnt vmcnt(13)
    v_mfma_f32_16x16x32_bf16 v[4:7], a[160:163], v[76:79], v[4:7]
    s_lshr_b32 s101, s100, 1
    v_mfma_f32_16x16x32_bf16 v[8:11], a[164:167], v[76:79], v[8:11]
    s_lshl_b32 s101, s101, 10
    v_mfma_f32_16x16x32_bf16 v[12:15], a[168:171], v[76:79], v[12:15]
    s_and_b32 s100, s100, 1
    v_mfma_f32_16x16x32_bf16 v[16:19], a[172:175], v[76:79], v[16:19]
    s_lshl_b32 s100, s100, 3
    v_mfma_f32_16x16x32_bf16 v[20:23], a[176:179], v[76:79], v[20:23]
    s_add_u32 s100, s100, s101
    buffer_load_dwordx4 v[76:79], v101, s[8:11], s80 offen
    s_waitcnt vmcnt(13)
    v_mfma_f32_16x16x32_bf16 v[4:7], a[180:183], v[80:83], v[4:7]
    v_add_u32 v174, s100, v179
    v_mfma_f32_16x16x32_bf16 v[8:11], a[184:187], v[80:83], v[8:11]
    s_add_u32 s100, s97, 1
    v_mfma_f32_16x16x32_bf16 v[12:15], a[188:191], v[80:83], v[12:15]
    s_lshr_b32 s101, s100, 1
    v_mfma_f32_16x16x32_bf16 v[16:19], a[192:195], v[80:83], v[16:19]
    s_lshl_b32 s101, s101, 10
    v_mfma_f32_16x16x32_bf16 v[20:23], a[196:199], v[80:83], v[20:23]
    s_and_b32 s100, s100, 1
    buffer_load_dwordx4 v[80:83], v101, s[8:11], s81 offen
    s_waitcnt vmcnt(13)
    v_mfma_f32_16x16x32_bf16 v[4:7], a[200:203], v[84:87], v[4:7]
    s_lshl_b32 s100, s100, 3
    v_mfma_f32_16x16x32_bf16 v[8:11], a[204:207], v[84:87], v[8:11]
    s_add_u32 s100, s100, s101
    v_mfma_f32_16x16x32_bf16 v[12:15], a[208:211], v[84:87], v[12:15]
    v_add_u32 v175, s100, v179
    v_mfma_f32_16x16x32_bf16 v[16:19], a[212:215], v[84:87], v[16:19]
    s_add_u32 s100, s97, 2
    v_mfma_f32_16x16x32_bf16 v[20:23], a[216:219], v[84:87], v[20:23]
    s_lshr_b32 s101, s100, 1
    buffer_load_dwordx4 v[84:87], v101, s[8:11], s82 offen
    s_waitcnt vmcnt(13)
    v_mfma_f32_16x16x32_bf16 v[4:7], a[220:223], v[88:91], v[4:7]
    s_lshl_b32 s101, s101, 10
    v_mfma_f32_16x16x32_bf16 v[8:11], a[224:227], v[88:91], v[8:11]
    s_and_b32 s100, s100, 1
    v_mfma_f32_16x16x32_bf16 v[12:15], a[228:231], v[88:91], v[12:15]
    s_lshl_b32 s100, s100, 3
    v_mfma_f32_16x16x32_bf16 v[16:19], a[232:235], v[88:91], v[16:19]
    s_add_u32 s100, s100, s101
    v_mfma_f32_16x16x32_bf16 v[20:23], a[236:239], v[88:91], v[20:23]
    v_add_u32 v176, s100, v179
    buffer_load_dwordx4 v[88:91], v101, s[8:11], s83 offen
    s_waitcnt vmcnt(13)
    v_mfma_f32_16x16x32_bf16 v[4:7], a[240:243], v[92:95], v[4:7]
    s_add_u32 s100, s97, 3
    v_mfma_f32_16x16x32_bf16 v[8:11], a[244:247], v[92:95], v[8:11]
    s_lshr_b32 s101, s100, 1
    v_mfma_f32_16x16x32_bf16 v[12:15], a[248:251], v[92:95], v[12:15]
    s_lshl_b32 s101, s101, 10
    v_mfma_f32_16x16x32_bf16 v[16:19], a[252:255], v[92:95], v[16:19]
    s_and_b32 s100, s100, 1
    v_mfma_f32_16x16x32_bf16 v[20:23], v[232:235], v[92:95], v[20:23]
    s_lshl_b32 s100, s100, 3
    buffer_load_dwordx4 v[92:95], v101, s[8:11], s84 offen
    s_waitcnt vmcnt(13)
    v_mfma_f32_16x16x32_bf16 v[4:7], v[236:239], v[96:99], v[4:7]
    s_add_u32 s100, s100, s101
    v_mfma_f32_16x16x32_bf16 v[8:11], v[240:243], v[96:99], v[8:11]
    v_add_u32 v177, s100, v179
    v_mfma_f32_16x16x32_bf16 v[12:15], v[244:247], v[96:99], v[12:15]
    s_add_u32 s100, s97, 4
    v_mfma_f32_16x16x32_bf16 v[16:19], v[248:251], v[96:99], v[16:19]
    s_lshr_b32 s101, s100, 1
    v_mfma_f32_16x16x32_bf16 v[20:23], v[252:255], v[96:99], v[20:23]
    s_lshl_b32 s101, s101, 10
    buffer_load_dwordx4 v[96:99], v101, s[8:11], s85 offen
    s_and_b32 s100, s100, 1
    s_lshl_b32 s100, s100, 3
    s_add_u32 s100, s100, s101
    v_add_u32 v178, s100, v179
    s_waitcnt vmcnt(13)
    v_mfma_f32_16x16x32_bf16 v[24:27], a[0:3], v[44:47], 0
    v_mfma_f32_16x16x32_bf16 v[28:31], a[4:7], v[44:47], 0
    v_mfma_f32_16x16x32_bf16 v[32:35], a[8:11], v[44:47], 0
    v_mfma_f32_16x16x32_bf16 v[36:39], a[12:15], v[44:47], 0
    v_mfma_f32_16x16x32_bf16 v[40:43], a[16:19], v[44:47], 0
    buffer_load_dwordx4 v[44:47], v102, s[8:11], s72 offen
    s_waitcnt vmcnt(13)
    v_mfma_f32_16x16x32_bf16 v[24:27], a[20:23], v[48:51], v[24:27]
    v_mfma_f32_16x16x32_bf16 v[28:31], a[24:27], v[48:51], v[28:31]
    v_mfma_f32_16x16x32_bf16 v[32:35], a[28:31], v[48:51], v[32:35]
    ds_write_b128 v104, v[4:7] offset:0
    v_mfma_f32_16x16x32_bf16 v[36:39], a[32:35], v[48:51], v[36:39]
    v_mfma_f32_16x16x32_bf16 v[40:43], a[36:39], v[48:51], v[40:43]
    buffer_load_dwordx4 v[48:51], v102, s[8:11], s73 offen
    s_waitcnt vmcnt(13)
    v_mfma_f32_16x16x32_bf16 v[24:27], a[40:43], v[52:55], v[24:27]
    v_mfma_f32_16x16x32_bf16 v[28:31], a[44:47], v[52:55], v[28:31]
    v_mfma_f32_16x16x32_bf16 v[32:35], a[48:51], v[52:55], v[32:35]
    ds_write_b128 v104, v[8:11] offset:1024
    v_mfma_f32_16x16x32_bf16 v[36:39], a[52:55], v[52:55], v[36:39]
    v_mfma_f32_16x16x32_bf16 v[40:43], a[56:59], v[52:55], v[40:43]
    buffer_load_dwordx4 v[52:55], v102, s[8:11], s74 offen
    s_waitcnt vmcnt(13)
    v_mfma_f32_16x16x32_bf16 v[24:27], a[60:63], v[56:59], v[24:27]
    v_mfma_f32_16x16x32_bf16 v[28:31], a[64:67], v[56:59], v[28:31]
    v_mfma_f32_16x16x32_bf16 v[32:35], a[68:71], v[56:59], v[32:35]
    ds_write_b128 v104, v[12:15] offset:2048
    v_mfma_f32_16x16x32_bf16 v[36:39], a[72:75], v[56:59], v[36:39]
    v_mfma_f32_16x16x32_bf16 v[40:43], a[76:79], v[56:59], v[40:43]
    buffer_load_dwordx4 v[56:59], v102, s[8:11], s75 offen
    s_waitcnt vmcnt(13)
    v_mfma_f32_16x16x32_bf16 v[24:27], a[80:83], v[60:63], v[24:27]
    v_mfma_f32_16x16x32_bf16 v[28:31], a[84:87], v[60:63], v[28:31]
    v_mfma_f32_16x16x32_bf16 v[32:35], a[88:91], v[60:63], v[32:35]
    ds_write_b128 v104, v[16:19] offset:3072
    v_mfma_f32_16x16x32_bf16 v[36:39], a[92:95], v[60:63], v[36:39]
    v_mfma_f32_16x16x32_bf16 v[40:43], a[96:99], v[60:63], v[40:43]
    buffer_load_dwordx4 v[60:63], v102, s[8:11], s76 offen
    s_waitcnt vmcnt(13)
    v_mfma_f32_16x16x32_bf16 v[24:27], a[100:103], v[64:67], v[24:27]
    v_mfma_f32_16x16x32_bf16 v[28:31], a[104:107], v[64:67], v[28:31]
    v_mfma_f32_16x16x32_bf16 v[32:35], a[108:111], v[64:67], v[32:35]
    ds_write_b128 v104, v[20:23] offset:4096
    v_mfma_f32_16x16x32_bf16 v[36:39], a[112:115], v[64:67], v[36:39]
    v_mfma_f32_16x16x32_bf16 v[40:43], a[116:119], v[64:67], v[40:43]
    buffer_load_dwordx4 v[64:67], v102, s[8:11], s77 offen
    s_waitcnt vmcnt(13)
    v_mfma_f32_16x16x32_bf16 v[24:27], a[120:123], v[68:71], v[24:27]
    v_mfma_f32_16x16x32_bf16 v[28:31], a[124:127], v[68:71], v[28:31]
    v_mfma_f32_16x16x32_bf16 v[32:35], a[128:131], v[68:71], v[32:35]
    v_mfma_f32_16x16x32_bf16 v[36:39], a[132:135], v[68:71], v[36:39]
    v_mfma_f32_16x16x32_bf16 v[40:43], a[136:139], v[68:71], v[40:43]
    buffer_load_dwordx4 v[68:71], v102, s[8:11], s78 offen
    s_waitcnt lgkmcnt(0)
    s_barrier
    s_waitcnt vmcnt(13)
    v_mfma_f32_16x16x32_bf16 v[24:27], a[140:143], v[72:75], v[24:27]
    ds_read_b128 v[128:131], v107 offset:0
    v_mfma_f32_16x16x32_bf16 v[28:31], a[144:147], v[72:75], v[28:31]
    ds_read_b128 v[132:135], v107 offset:1024
    v_mfma_f32_16x16x32_bf16 v[32:35], a[148:151], v[72:75], v[32:35]
    ds_read_b128 v[136:139], v107 offset:2048
    v_mfma_f32_16x16x32_bf16 v[36:39], a[152:155], v[72:75], v[36:39]
    ds_read_b128 v[140:143], v107 offset:3072
    v_mfma_f32_16x16x32_bf16 v[40:43], a[156:159], v[72:75], v[40:43]
    ds_read_b128 v[144:147], v107 offset:4096
    buffer_load_dwordx4 v[72:75], v102, s[8:11], s79 offen
    s_waitcnt vmcnt(13)
    v_mfma_f32_16x16x32_bf16 v[24:27], a[160:163], v[76:79], v[24:27]
    v_mfma_f32_16x16x32_bf16 v[28:31], a[164:167], v[76:79], v[28:31]
    v_mfma_f32_16x16x32_bf16 v[32:35], a[168:171], v[76:79], v[32:35]
    v_mfma_f32_16x16x32_bf16 v[36:39], a[172:175], v[76:79], v[36:39]
    v_mfma_f32_16x16x32_bf16 v[40:43], a[176:179], v[76:79], v[40:43]
    buffer_load_dwordx4 v[76:79], v102, s[8:11], s80 offen
    s_waitcnt vmcnt(13)
    v_mfma_f32_16x16x32_bf16 v[24:27], a[180:183], v[80:83], v[24:27]
    v_mfma_f32_16x16x32_bf16 v[28:31], a[184:187], v[80:83], v[28:31]
    v_mfma_f32_16x16x32_bf16 v[32:35], a[188:191], v[80:83], v[32:35]
    v_mfma_f32_16x16x32_bf16 v[36:39], a[192:195], v[80:83], v[36:39]
    v_mfma_f32_16x16x32_bf16 v[40:43], a[196:199], v[80:83], v[40:43]
    buffer_load_dwordx4 v[80:83], v102, s[8:11], s81 offen
    s_waitcnt vmcnt(13)
    v_mfma_f32_16x16x32_bf16 v[24:27], a[200:203], v[84:87], v[24:27]
    v_mfma_f32_16x16x32_bf16 v[28:31], a[204:207], v[84:87], v[28:31]
    v_mfma_f32_16x16x32_bf16 v[32:35], a[208:211], v[84:87], v[32:35]
    v_mfma_f32_16x16x32_bf16 v[36:39], a[212:215], v[84:87], v[36:39]
    v_mfma_f32_16x16x32_bf16 v[40:43], a[216:219], v[84:87], v[40:43]
    buffer_load_dwordx4 v[84:87], v102, s[8:11], s82 offen
    s_waitcnt lgkmcnt(0)
    s_barrier
    s_waitcnt vmcnt(13)
    v_mfma_f32_16x16x32_bf16 v[24:27], a[220:223], v[88:91], v[24:27]
    v_mfma_f32_16x16x32_bf16 v[28:31], a[224:227], v[88:91], v[28:31]
    v_mfma_f32_16x16x32_bf16 v[32:35], a[228:231], v[88:91], v[32:35]
    v_mfma_f32_16x16x32_bf16 v[36:39], a[232:235], v[88:91], v[36:39]
    v_mfma_f32_16x16x32_bf16 v[40:43], a[236:239], v[88:91], v[40:43]
    buffer_load_dwordx4 v[88:91], v102, s[8:11], s83 offen
    s_waitcnt vmcnt(13)
    v_mfma_f32_16x16x32_bf16 v[24:27], a[240:243], v[92:95], v[24:27]
    v_mfma_f32_16x16x32_bf16 v[28:31], a[244:247], v[92:95], v[28:31]
    v_mfma_f32_16x16x32_bf16 v[32:35], a[248:251], v[92:95], v[32:35]
    v_mfma_f32_16x16x32_bf16 v[36:39], a[252:255], v[92:95], v[36:39]
    v_mfma_f32_16x16x32_bf16 v[40:43], v[232:235], v[92:95], v[40:43]
    buffer_load_dwordx4 v[92:95], v102, s[8:11], s84 offen
    s_waitcnt vmcnt(13)
    v_mfma_f32_16x16x32_bf16 v[24:27], v[236:239], v[96:99], v[24:27]
    v_mfma_f32_16x16x32_bf16 v[28:31], v[240:243], v[96:99], v[28:31]
    v_mfma_f32_16x16x32_bf16 v[32:35], v[244:247], v[96:99], v[32:35]
    v_mfma_f32_16x16x32_bf16 v[36:39], v[248:251], v[96:99], v[36:39]
    v_mfma_f32_16x16x32_bf16 v[40:43], v[252:255], v[96:99], v[40:43]
    buffer_load_dwordx4 v[96:99], v102, s[8:11], s85 offen
    s_waitcnt vmcnt(13)
    v_mfma_f32_16x16x32_bf16 v[4:7], a[0:3], v[44:47], 0
    v_mfma_f32_16x16x32_bf16 v[8:11], a[4:7], v[44:47], 0
    v_mfma_f32_16x16x32_bf16 v[12:15], a[8:11], v[44:47], 0
    v_mfma_f32_16x16x32_bf16 v[16:19], a[12:15], v[44:47], 0
    v_mfma_f32_16x16x32_bf16 v[20:23], a[16:19], v[44:47], 0
    buffer_load_dwordx4 v[44:47], v103, s[8:11], s72 offen
    s_waitcnt vmcnt(13)
    v_mfma_f32_16x16x32_bf16 v[4:7], a[20:23], v[48:51], v[4:7]
    v_mfma_f32_16x16x32_bf16 v[8:11], a[24:27], v[48:51], v[8:11]
    v_mfma_f32_16x16x32_bf16 v[12:15], a[28:31], v[48:51], v[12:15]
    ds_write_b128 v105, v[24:27] offset:0
    v_mfma_f32_16x16x32_bf16 v[16:19], a[32:35], v[48:51], v[16:19]
    v_mfma_f32_16x16x32_bf16 v[20:23], a[36:39], v[48:51], v[20:23]
    buffer_load_dwordx4 v[48:51], v103, s[8:11], s73 offen
    s_waitcnt vmcnt(13)
    v_mfma_f32_16x16x32_bf16 v[4:7], a[40:43], v[52:55], v[4:7]
    v_mfma_f32_16x16x32_bf16 v[8:11], a[44:47], v[52:55], v[8:11]
    v_mfma_f32_16x16x32_bf16 v[12:15], a[48:51], v[52:55], v[12:15]
    ds_write_b128 v105, v[28:31] offset:1024
    v_mfma_f32_16x16x32_bf16 v[16:19], a[52:55], v[52:55], v[16:19]
    v_mfma_f32_16x16x32_bf16 v[20:23], a[56:59], v[52:55], v[20:23]
    buffer_load_dwordx4 v[52:55], v103, s[8:11], s74 offen
    s_waitcnt vmcnt(13)
    v_mfma_f32_16x16x32_bf16 v[4:7], a[60:63], v[56:59], v[4:7]
    v_mfma_f32_16x16x32_bf16 v[8:11], a[64:67], v[56:59], v[8:11]
    v_mfma_f32_16x16x32_bf16 v[12:15], a[68:71], v[56:59], v[12:15]
    ds_write_b128 v105, v[32:35] offset:2048
    v_mfma_f32_16x16x32_bf16 v[16:19], a[72:75], v[56:59], v[16:19]
    v_mfma_f32_16x16x32_bf16 v[20:23], a[76:79], v[56:59], v[20:23]
    buffer_load_dwordx4 v[56:59], v103, s[8:11], s75 offen
    s_waitcnt vmcnt(13)
    v_mfma_f32_16x16x32_bf16 v[4:7], a[80:83], v[60:63], v[4:7]
    v_mfma_f32_16x16x32_bf16 v[8:11], a[84:87], v[60:63], v[8:11]
    v_mfma_f32_16x16x32_bf16 v[12:15], a[88:91], v[60:63], v[12:15]
    ds_write_b128 v105, v[36:39] offset:3072
    v_mfma_f32_16x16x32_bf16 v[16:19], a[92:95], v[60:63], v[16:19]
    v_mfma_f32_16x16x32_bf16 v[20:23], a[96:99], v[60:63], v[20:23]
    buffer_load_dwordx4 v[60:63], v103, s[8:11], s76 offen
    s_waitcnt vmcnt(13)
    v_mfma_f32_16x16x32_bf16 v[4:7], a[100:103], v[64:67], v[4:7]
    v_mfma_f32_16x16x32_bf16 v[8:11], a[104:107], v[64:67], v[8:11]
    v_mfma_f32_16x16x32_bf16 v[12:15], a[108:111], v[64:67], v[12:15]
    ds_write_b128 v105, v[40:43] offset:4096
    v_mfma_f32_16x16x32_bf16 v[16:19], a[112:115], v[64:67], v[16:19]
    v_mfma_f32_16x16x32_bf16 v[20:23], a[116:119], v[64:67], v[20:23]
    buffer_load_dwordx4 v[64:67], v103, s[8:11], s77 offen
    s_waitcnt vmcnt(13)
    v_mfma_f32_16x16x32_bf16 v[4:7], a[120:123], v[68:71], v[4:7]
    v_mfma_f32_16x16x32_bf16 v[8:11], a[124:127], v[68:71], v[8:11]
    v_mfma_f32_16x16x32_bf16 v[12:15], a[128:131], v[68:71], v[12:15]
    v_mfma_f32_16x16x32_bf16 v[16:19], a[132:135], v[68:71], v[16:19]
    v_mfma_f32_16x16x32_bf16 v[20:23], a[136:139], v[68:71], v[20:23]
    buffer_load_dwordx4 v[68:71], v103, s[8:11], s78 offen
    s_waitcnt lgkmcnt(0)
    s_barrier
    s_waitcnt vmcnt(13)
    v_mfma_f32_16x16x32_bf16 v[4:7], a[140:143], v[72:75], v[4:7]
    ds_read_b128 v[108:111], v107 offset:0
    v_mfma_f32_16x16x32_bf16 v[8:11], a[144:147], v[72:75], v[8:11]
    ds_read_b128 v[112:115], v107 offset:1024
    v_mfma_f32_16x16x32_bf16 v[12:15], a[148:151], v[72:75], v[12:15]
    ds_read_b128 v[116:119], v107 offset:2048
    v_mfma_f32_16x16x32_bf16 v[16:19], a[152:155], v[72:75], v[16:19]
    ds_read_b128 v[120:123], v107 offset:3072
    v_mfma_f32_16x16x32_bf16 v[20:23], a[156:159], v[72:75], v[20:23]
    ds_read_b128 v[124:127], v107 offset:4096
    buffer_load_dwordx4 v[72:75], v103, s[8:11], s79 offen
    s_waitcnt vmcnt(13)
    v_mfma_f32_16x16x32_bf16 v[4:7], a[160:163], v[76:79], v[4:7]
    v_mfma_f32_16x16x32_bf16 v[8:11], a[164:167], v[76:79], v[8:11]
    v_mfma_f32_16x16x32_bf16 v[12:15], a[168:171], v[76:79], v[12:15]
    v_mfma_f32_16x16x32_bf16 v[16:19], a[172:175], v[76:79], v[16:19]
    v_mfma_f32_16x16x32_bf16 v[20:23], a[176:179], v[76:79], v[20:23]
    buffer_load_dwordx4 v[76:79], v103, s[8:11], s80 offen
    s_waitcnt vmcnt(13)
    v_mfma_f32_16x16x32_bf16 v[4:7], a[180:183], v[80:83], v[4:7]
    v_mfma_f32_16x16x32_bf16 v[8:11], a[184:187], v[80:83], v[8:11]
    v_mfma_f32_16x16x32_bf16 v[12:15], a[188:191], v[80:83], v[12:15]
    v_mfma_f32_16x16x32_bf16 v[16:19], a[192:195], v[80:83], v[16:19]
    v_mfma_f32_16x16x32_bf16 v[20:23], a[196:199], v[80:83], v[20:23]
    buffer_load_dwordx4 v[80:83], v103, s[8:11], s81 offen
    s_waitcnt vmcnt(13)
    v_mfma_f32_16x16x32_bf16 v[4:7], a[200:203], v[84:87], v[4:7]
    v_mfma_f32_16x16x32_bf16 v[8:11], a[204:207], v[84:87], v[8:11]
    v_mfma_f32_16x16x32_bf16 v[12:15], a[208:211], v[84:87], v[12:15]
    v_mfma_f32_16x16x32_bf16 v[16:19], a[212:215], v[84:87], v[16:19]
    v_mfma_f32_16x16x32_bf16 v[20:23], a[216:219], v[84:87], v[20:23]
    buffer_load_dwordx4 v[84:87], v103, s[8:11], s82 offen
    s_waitcnt lgkmcnt(0)
    s_barrier
    s_waitcnt vmcnt(13)
    v_mfma_f32_16x16x32_bf16 v[4:7], a[220:223], v[88:91], v[4:7]
    v_add_f32 v128, v128, v108
    v_add_f32 v129, v129, v109
    v_mfma_f32_16x16x32_bf16 v[8:11], a[224:227], v[88:91], v[8:11]
    v_add_f32 v130, v130, v110
    v_add_f32 v131, v131, v111
    v_mfma_f32_16x16x32_bf16 v[12:15], a[228:231], v[88:91], v[12:15]
    v_add_f32 v132, v132, v112
    v_add_f32 v133, v133, v113
    v_mfma_f32_16x16x32_bf16 v[16:19], a[232:235], v[88:91], v[16:19]
    v_add_f32 v134, v134, v114
    v_add_f32 v135, v135, v115
    v_mfma_f32_16x16x32_bf16 v[20:23], a[236:239], v[88:91], v[20:23]
    v_add_f32 v136, v136, v116
    v_add_f32 v137, v137, v117
    buffer_load_dwordx4 v[88:91], v103, s[8:11], s83 offen
    s_waitcnt vmcnt(13)
    v_mfma_f32_16x16x32_bf16 v[4:7], a[240:243], v[92:95], v[4:7]
    v_add_f32 v138, v138, v118
    v_add_f32 v139, v139, v119
    v_mfma_f32_16x16x32_bf16 v[8:11], a[244:247], v[92:95], v[8:11]
    v_add_f32 v140, v140, v120
    v_add_f32 v141, v141, v121
    v_mfma_f32_16x16x32_bf16 v[12:15], a[248:251], v[92:95], v[12:15]
    v_add_f32 v142, v142, v122
    v_add_f32 v143, v143, v123
    v_mfma_f32_16x16x32_bf16 v[16:19], a[252:255], v[92:95], v[16:19]
    v_add_f32 v144, v144, v124
    v_add_f32 v145, v145, v125
    v_mfma_f32_16x16x32_bf16 v[20:23], v[232:235], v[92:95], v[20:23]
    v_add_f32 v146, v146, v126
    v_add_f32 v147, v147, v127
    buffer_load_dwordx4 v[92:95], v103, s[8:11], s84 offen
    s_waitcnt vmcnt(13)
    v_mfma_f32_16x16x32_bf16 v[4:7], v[236:239], v[96:99], v[4:7]
    v_mfma_f32_16x16x32_bf16 v[8:11], v[240:243], v[96:99], v[8:11]
    v_mfma_f32_16x16x32_bf16 v[12:15], v[244:247], v[96:99], v[12:15]
    v_mfma_f32_16x16x32_bf16 v[16:19], v[248:251], v[96:99], v[16:19]
    v_mfma_f32_16x16x32_bf16 v[20:23], v[252:255], v[96:99], v[20:23]
    buffer_load_dwordx4 v[96:99], v103, s[8:11], s85 offen
    s_waitcnt vmcnt(13)
    v_mfma_f32_16x16x32_bf16 v[24:27], a[0:3], v[44:47], 0
    v_mfma_f32_16x16x32_bf16 v[28:31], a[4:7], v[44:47], 0
    v_mfma_f32_16x16x32_bf16 v[32:35], a[8:11], v[44:47], 0
    v_mfma_f32_16x16x32_bf16 v[36:39], a[12:15], v[44:47], 0
    v_mfma_f32_16x16x32_bf16 v[40:43], a[16:19], v[44:47], 0
    s_waitcnt vmcnt(12)
    v_mfma_f32_16x16x32_bf16 v[24:27], a[20:23], v[48:51], v[24:27]
    v_mfma_f32_16x16x32_bf16 v[28:31], a[24:27], v[48:51], v[28:31]
    v_mfma_f32_16x16x32_bf16 v[32:35], a[28:31], v[48:51], v[32:35]
    ds_write_b128 v106, v[4:7] offset:0
    v_mfma_f32_16x16x32_bf16 v[36:39], a[32:35], v[48:51], v[36:39]
    v_mfma_f32_16x16x32_bf16 v[40:43], a[36:39], v[48:51], v[40:43]
    s_waitcnt vmcnt(11)
    v_mfma_f32_16x16x32_bf16 v[24:27], a[40:43], v[52:55], v[24:27]
    v_mfma_f32_16x16x32_bf16 v[28:31], a[44:47], v[52:55], v[28:31]
    v_mfma_f32_16x16x32_bf16 v[32:35], a[48:51], v[52:55], v[32:35]
    ds_write_b128 v106, v[8:11] offset:1024
    v_mfma_f32_16x16x32_bf16 v[36:39], a[52:55], v[52:55], v[36:39]
    v_mfma_f32_16x16x32_bf16 v[40:43], a[56:59], v[52:55], v[40:43]
    s_waitcnt vmcnt(10)
    v_mfma_f32_16x16x32_bf16 v[24:27], a[60:63], v[56:59], v[24:27]
    v_mfma_f32_16x16x32_bf16 v[28:31], a[64:67], v[56:59], v[28:31]
    v_mfma_f32_16x16x32_bf16 v[32:35], a[68:71], v[56:59], v[32:35]
    ds_write_b128 v106, v[12:15] offset:2048
    v_mfma_f32_16x16x32_bf16 v[36:39], a[72:75], v[56:59], v[36:39]
    v_mfma_f32_16x16x32_bf16 v[40:43], a[76:79], v[56:59], v[40:43]
    s_waitcnt vmcnt(9)
    v_mfma_f32_16x16x32_bf16 v[24:27], a[80:83], v[60:63], v[24:27]
    v_mfma_f32_16x16x32_bf16 v[28:31], a[84:87], v[60:63], v[28:31]
    v_mfma_f32_16x16x32_bf16 v[32:35], a[88:91], v[60:63], v[32:35]
    ds_write_b128 v106, v[16:19] offset:3072
    v_mfma_f32_16x16x32_bf16 v[36:39], a[92:95], v[60:63], v[36:39]
    v_mfma_f32_16x16x32_bf16 v[40:43], a[96:99], v[60:63], v[40:43]
    s_waitcnt vmcnt(8)
    v_mfma_f32_16x16x32_bf16 v[24:27], a[100:103], v[64:67], v[24:27]
    v_mfma_f32_16x16x32_bf16 v[28:31], a[104:107], v[64:67], v[28:31]
    v_mfma_f32_16x16x32_bf16 v[32:35], a[108:111], v[64:67], v[32:35]
    ds_write_b128 v106, v[20:23] offset:4096
    v_mfma_f32_16x16x32_bf16 v[36:39], a[112:115], v[64:67], v[36:39]
    v_mfma_f32_16x16x32_bf16 v[40:43], a[116:119], v[64:67], v[40:43]
    s_waitcnt vmcnt(7)
    v_mfma_f32_16x16x32_bf16 v[24:27], a[120:123], v[68:71], v[24:27]
    v_mfma_f32_16x16x32_bf16 v[28:31], a[124:127], v[68:71], v[28:31]
    v_mfma_f32_16x16x32_bf16 v[32:35], a[128:131], v[68:71], v[32:35]
    v_mfma_f32_16x16x32_bf16 v[36:39], a[132:135], v[68:71], v[36:39]
    v_mfma_f32_16x16x32_bf16 v[40:43], a[136:139], v[68:71], v[40:43]
    s_waitcnt lgkmcnt(0)
    s_barrier
    s_waitcnt vmcnt(6)
    v_mfma_f32_16x16x32_bf16 v[24:27], a[140:143], v[72:75], v[24:27]
    ds_read_b128 v[108:111], v107 offset:0
    v_mfma_f32_16x16x32_bf16 v[28:31], a[144:147], v[72:75], v[28:31]
    ds_read_b128 v[112:115], v107 offset:1024
    v_mfma_f32_16x16x32_bf16 v[32:35], a[148:151], v[72:75], v[32:35]
    ds_read_b128 v[116:119], v107 offset:2048
    v_mfma_f32_16x16x32_bf16 v[36:39], a[152:155], v[72:75], v[36:39]
    ds_read_b128 v[120:123], v107 offset:3072
    v_mfma_f32_16x16x32_bf16 v[40:43], a[156:159], v[72:75], v[40:43]
    ds_read_b128 v[124:127], v107 offset:4096
    s_waitcnt vmcnt(5)
    v_mfma_f32_16x16x32_bf16 v[24:27], a[160:163], v[76:79], v[24:27]
    v_mfma_f32_16x16x32_bf16 v[28:31], a[164:167], v[76:79], v[28:31]
    v_mfma_f32_16x16x32_bf16 v[32:35], a[168:171], v[76:79], v[32:35]
    v_mfma_f32_16x16x32_bf16 v[36:39], a[172:175], v[76:79], v[36:39]
    v_mfma_f32_16x16x32_bf16 v[40:43], a[176:179], v[76:79], v[40:43]
    s_waitcnt vmcnt(4)
    v_mfma_f32_16x16x32_bf16 v[24:27], a[180:183], v[80:83], v[24:27]
    v_mfma_f32_16x16x32_bf16 v[28:31], a[184:187], v[80:83], v[28:31]
    v_mfma_f32_16x16x32_bf16 v[32:35], a[188:191], v[80:83], v[32:35]
    v_mfma_f32_16x16x32_bf16 v[36:39], a[192:195], v[80:83], v[36:39]
    v_mfma_f32_16x16x32_bf16 v[40:43], a[196:199], v[80:83], v[40:43]
    s_waitcnt vmcnt(3)
    v_mfma_f32_16x16x32_bf16 v[24:27], a[200:203], v[84:87], v[24:27]
    v_mfma_f32_16x16x32_bf16 v[28:31], a[204:207], v[84:87], v[28:31]
    v_mfma_f32_16x16x32_bf16 v[32:35], a[208:211], v[84:87], v[32:35]
    v_mfma_f32_16x16x32_bf16 v[36:39], a[212:215], v[84:87], v[36:39]
    v_mfma_f32_16x16x32_bf16 v[40:43], a[216:219], v[84:87], v[40:43]
    s_waitcnt lgkmcnt(0)
    s_barrier
    s_waitcnt vmcnt(2)
    v_mfma_f32_16x16x32_bf16 v[24:27], a[220:223], v[88:91], v[24:27]
    v_add_f32 v128, v128, v108
    v_add_f32 v129, v129, v109
    v_mfma_f32_16x16x32_bf16 v[28:31], a[224:227], v[88:91], v[28:31]
    v_add_f32 v130, v130, v110
    v_add_f32 v131, v131, v111
    v_mfma_f32_16x16x32_bf16 v[32:35], a[228:231], v[88:91], v[32:35]
    v_add_f32 v132, v132, v112
    v_add_f32 v133, v133, v113
    v_mfma_f32_16x16x32_bf16 v[36:39], a[232:235], v[88:91], v[36:39]
    v_add_f32 v134, v134, v114
    v_add_f32 v135, v135, v115
    v_mfma_f32_16x16x32_bf16 v[40:43], a[236:239], v[88:91], v[40:43]
    v_add_f32 v136, v136, v116
    v_add_f32 v137, v137, v117
    s_waitcnt vmcnt(1)
    v_mfma_f32_16x16x32_bf16 v[24:27], a[240:243], v[92:95], v[24:27]
    v_add_f32 v138, v138, v118
    v_add_f32 v139, v139, v119
    v_mfma_f32_16x16x32_bf16 v[28:31], a[244:247], v[92:95], v[28:31]
    v_add_f32 v140, v140, v120
    v_add_f32 v141, v141, v121
    v_mfma_f32_16x16x32_bf16 v[32:35], a[248:251], v[92:95], v[32:35]
    v_add_f32 v142, v142, v122
    v_add_f32 v143, v143, v123
    v_mfma_f32_16x16x32_bf16 v[36:39], a[252:255], v[92:95], v[36:39]
    v_add_f32 v144, v144, v124
    v_add_f32 v145, v145, v125
    v_mfma_f32_16x16x32_bf16 v[40:43], v[232:235], v[92:95], v[40:43]
    v_add_f32 v146, v146, v126
    v_add_f32 v147, v147, v127
    s_waitcnt vmcnt(0)
    v_mfma_f32_16x16x32_bf16 v[24:27], v[236:239], v[96:99], v[24:27]
    v_mfma_f32_16x16x32_bf16 v[28:31], v[240:243], v[96:99], v[28:31]
    v_mfma_f32_16x16x32_bf16 v[32:35], v[244:247], v[96:99], v[32:35]
    v_mfma_f32_16x16x32_bf16 v[36:39], v[248:251], v[96:99], v[36:39]
    v_mfma_f32_16x16x32_bf16 v[40:43], v[252:255], v[96:99], v[40:43]
    s_nop 3
    v_pk_add_f32 v[128:129], v[128:129], v[24:25]
    v_pk_add_f32 v[130:131], v[130:131], v[26:27]
    v_pk_add_f32 v[132:133], v[132:133], v[28:29]
    v_pk_add_f32 v[134:135], v[134:135], v[30:31]
    v_pk_add_f32 v[136:137], v[136:137], v[32:33]
    v_pk_add_f32 v[138:139], v[138:139], v[34:35]
    v_pk_add_f32 v[140:141], v[140:141], v[36:37]
    v_pk_add_f32 v[142:143], v[142:143], v[38:39]
    v_pk_add_f32 v[144:145], v[144:145], v[40:41]
    v_pk_add_f32 v[146:147], v[146:147], v[42:43]
    v_cvt_pk_bf16_f32 v180, v128, v129
    v_lshlrev_b32 v128, 16, v180
    v_and_b32 v129, s45, v180
    v_pk_add_f32 v[150:151], v[150:151], v[128:129]
    v_cvt_pk_bf16_f32 v222, v150, v151
    v_cvt_pk_bf16_f32 v181, v130, v131
    v_lshlrev_b32 v130, 16, v181
    v_and_b32 v131, s45, v181
    v_pk_add_f32 v[152:153], v[152:153], v[130:131]
    v_cvt_pk_bf16_f32 v223, v152, v153
    v_cvt_pk_bf16_f32 v180, v132, v133
    v_lshlrev_b32 v132, 16, v180
    v_and_b32 v133, s45, v180
    v_pk_add_f32 v[154:155], v[154:155], v[132:133]
    v_cvt_pk_bf16_f32 v224, v154, v155
    v_cvt_pk_bf16_f32 v181, v134, v135
    v_lshlrev_b32 v134, 16, v181
    v_and_b32 v135, s45, v181
    v_pk_add_f32 v[156:157], v[156:157], v[134:135]
    v_cvt_pk_bf16_f32 v225, v156, v157
    v_cvt_pk_bf16_f32 v180, v136, v137
    v_lshlrev_b32 v136, 16, v180
    v_and_b32 v137, s45, v180
    v_pk_add_f32 v[158:159], v[158:159], v[136:137]
    v_cvt_pk_bf16_f32 v226, v158, v159
    v_cvt_pk_bf16_f32 v181, v138, v139
    v_lshlrev_b32 v138, 16, v181
    v_and_b32 v139, s45, v181
    v_pk_add_f32 v[160:161], v[160:161], v[138:139]
    v_cvt_pk_bf16_f32 v227, v160, v161
    v_cvt_pk_bf16_f32 v180, v140, v141
    v_lshlrev_b32 v140, 16, v180
    v_and_b32 v141, s45, v180
    v_pk_add_f32 v[162:163], v[162:163], v[140:141]
    v_cvt_pk_bf16_f32 v228, v162, v163
    v_cvt_pk_bf16_f32 v181, v142, v143
    v_lshlrev_b32 v142, 16, v181
    v_and_b32 v143, s45, v181
    v_pk_add_f32 v[164:165], v[164:165], v[142:143]
    v_cvt_pk_bf16_f32 v229, v164, v165
    v_cvt_pk_bf16_f32 v180, v144, v145
    v_lshlrev_b32 v144, 16, v180
    v_and_b32 v145, s45, v180
    v_pk_add_f32 v[166:167], v[166:167], v[144:145]
    v_cvt_pk_bf16_f32 v230, v166, v167
    v_cvt_pk_bf16_f32 v181, v146, v147
    v_lshlrev_b32 v146, 16, v181
    v_and_b32 v147, s45, v181
    v_pk_add_f32 v[168:169], v[168:169], v[146:147]
    v_cvt_pk_bf16_f32 v231, v168, v169
    v_lshlrev_b32 v150, 16, v222
    v_and_b32 v151, s45, v222
    v_lshlrev_b32 v152, 16, v223
    v_and_b32 v153, s45, v223
    v_lshlrev_b32 v154, 16, v224
    v_and_b32 v155, s45, v224
    v_lshlrev_b32 v156, 16, v225
    v_and_b32 v157, s45, v225
    v_lshlrev_b32 v158, 16, v226
    v_and_b32 v159, s45, v226
    v_lshlrev_b32 v160, 16, v227
    v_and_b32 v161, s45, v227
    v_lshlrev_b32 v162, 16, v228
    v_and_b32 v163, s45, v228
    v_lshlrev_b32 v164, 16, v229
    v_and_b32 v165, s45, v229
    v_lshlrev_b32 v166, 16, v230
    v_and_b32 v167, s45, v230
    v_lshlrev_b32 v168, 16, v231
    v_and_b32 v169, s45, v231
    v_pk_add_f32 v[28:29], v[150:151], v[152:153]
    v_pk_add_f32 v[30:31], v[154:155], v[156:157]
    v_pk_add_f32 v[28:29], v[28:29], v[158:159]
    v_pk_add_f32 v[30:31], v[30:31], v[160:161]
    v_pk_add_f32 v[28:29], v[28:29], v[162:163]
    v_pk_add_f32 v[30:31], v[30:31], v[164:165]
    v_pk_add_f32 v[28:29], v[28:29], v[166:167]
    v_pk_add_f32 v[30:31], v[30:31], v[168:169]
    v_pk_add_f32 v[28:29], v[28:29], v[30:31]
    v_add_f32 v28, v28, v29
    v_mov_b32 v32, v28
    s_nop 1
    v_permlane16_swap_b32 v28, v32
    v_add_f32 v28, v28, v32
    v_mov_b32 v32, v28
    s_nop 1
    v_permlane32_swap_b32 v28, v32
    v_add_f32 v28, v28, v32
    v_mul_f32 v28, 0x3c4ccccd, v28
    v_pk_add_f32 v[34:35], v[150:151], v[28:29] op_sel_hi:[1,0] neg_lo:[0,1] neg_hi:[0,1]
    v_pk_add_f32 v[36:37], v[152:153], v[28:29] op_sel_hi:[1,0] neg_lo:[0,1] neg_hi:[0,1]
    v_pk_add_f32 v[38:39], v[154:155], v[28:29] op_sel_hi:[1,0] neg_lo:[0,1] neg_hi:[0,1]
    v_pk_add_f32 v[40:41], v[156:157], v[28:29] op_sel_hi:[1,0] neg_lo:[0,1] neg_hi:[0,1]
    v_pk_add_f32 v[42:43], v[158:159], v[28:29] op_sel_hi:[1,0] neg_lo:[0,1] neg_hi:[0,1]
    v_pk_add_f32 v[44:45], v[160:161], v[28:29] op_sel_hi:[1,0] neg_lo:[0,1] neg_hi:[0,1]
    v_pk_add_f32 v[46:47], v[162:163], v[28:29] op_sel_hi:[1,0] neg_lo:[0,1] neg_hi:[0,1]
    v_pk_add_f32 v[48:49], v[164:165], v[28:29] op_sel_hi:[1,0] neg_lo:[0,1] neg_hi:[0,1]
    v_pk_add_f32 v[50:51], v[166:167], v[28:29] op_sel_hi:[1,0] neg_lo:[0,1] neg_hi:[0,1]
    v_pk_add_f32 v[52:53], v[168:169], v[28:29] op_sel_hi:[1,0] neg_lo:[0,1] neg_hi:[0,1]
    v_pk_mul_f32 v[54:55], v[34:35], v[34:35]
    v_pk_mul_f32 v[30:31], v[36:37], v[36:37]
    v_pk_fma_f32 v[54:55], v[38:39], v[38:39], v[54:55]
    v_pk_fma_f32 v[30:31], v[40:41], v[40:41], v[30:31]
    v_pk_fma_f32 v[54:55], v[42:43], v[42:43], v[54:55]
    v_pk_fma_f32 v[30:31], v[44:45], v[44:45], v[30:31]
    v_pk_fma_f32 v[54:55], v[46:47], v[46:47], v[54:55]
    v_pk_fma_f32 v[30:31], v[48:49], v[48:49], v[30:31]
    v_pk_fma_f32 v[54:55], v[50:51], v[50:51], v[54:55]
    v_pk_fma_f32 v[30:31], v[52:53], v[52:53], v[30:31]
    v_pk_add_f32 v[54:55], v[54:55], v[30:31]
    v_add_f32 v29, v54, v55
    s_add_u32 s3, s28, 2
    v_mov_b32 v30, s3
    v_mov_b32 v32, v29
    s_nop 1
    v_permlane16_swap_b32 v29, v32
    v_add_f32 v29, v29, v32
    v_mov_b32 v32, v29
    s_nop 1
    v_permlane32_swap_b32 v29, v32
    v_add_f32 v29, v29, v32
    s_xor_b32 s3, s3, s29
    v_mov_b32 v31, s3
    s_add_u32 s66, s38, 1572864
    s_addc_u32 s67, s39, 0
    s_mov_b64 s[92:93], exec
    s_mov_b64 exec, 0xffff
    s_cmp_eq_u32 s7, 0
    s_cbranch_scc0 L_slow_76
    global_store_dwordx4 v170, v[28:31], s[66:67]
    s_nop 1
    s_branch L_sd_77
L_slow_76:
    global_store_dwordx4 v170, v[28:31], s[66:67] sc0 sc1
    s_nop 1
L_sd_77:
    s_mov_b64 exec, s[92:93]
    v_add_u32 v68, 1572864, v171
    global_load_dwordx4 v[60:63], v68, s[38:39] offset:0 sc1
    global_load_dwordx4 v[64:67], v68, s[38:39] offset:16 sc1
    s_waitcnt vmcnt(0)
    s_add_u32 s55, s28, 2
    s_mov_b32 s71, 400000
L_rsr_78:
    v_subrev_u32 v69, s55, v62
    v_cmp_lt_u32 vcc, 0, v69
    v_xor_b32 v69, v62, v63
    v_cmp_ne_u32 s[88:89], s29, v69
    s_or_b64 s[88:89], vcc, s[88:89]
    s_mov_b64 s[68:69], s[88:89]
    v_subrev_u32 v69, s55, v66
    v_cmp_lt_u32 vcc, 0, v69
    v_xor_b32 v69, v66, v67
    v_cmp_ne_u32 s[88:89], s29, v69
    s_or_b64 s[88:89], vcc, s[88:89]
    s_or_b64 s[88:89], s[88:89], s[68:69]
    s_nop 2
    s_cbranch_scc0 L_rso_79
    s_sub_u32 s71, s71, 1
    s_cmp_eq_u32 s71, 0
    s_cbranch_scc1 L_abort
    global_load_dwordx4 v[60:63], v68, s[38:39] offset:0 sc1
    global_load_dwordx4 v[64:67], v68, s[38:39] offset:16 sc1
    s_waitcnt vmcnt(0)
    s_branch L_rsr_78
L_rso_79:
    v_mov_b32 v62, v64
    v_mov_b32 v63, v65
    v_add_f32 v64, v60, v62
    v_mov_b32 v65, v64
    s_nop 1
    v_permlane16_swap_b32 v64, v65
    v_add_f32 v64, v64, v65
    v_mov_b32 v65, v64
    s_nop 1
    v_permlane32_swap_b32 v64, v65
    v_add_f32 v64, v64, v65
    v_mul_f32 v64, 0x3e000000, v64
    v_sub_f32 v60, v60, v64
    v_sub_f32 v62, v62, v64
    v_mul_f32 v60, v60, v60
    v_fmac_f32 v60, v62, v62
    v_add_f32 v61, v61, v63
    v_mov_b32 v65, 0x42a00000
    v_fmac_f32 v61, v60, v65
    v_mov_b32 v65, v61
    s_nop 1
    v_permlane16_swap_b32 v61, v65
    v_add_f32 v61, v61, v65
    v_mov_b32 v65, v61
    s_nop 1
    v_permlane32_swap_b32 v61, v65
    v_add_f32 v61, v61, v65
    v_mul_f32 v61, 0x3acccccd, v61
    v_cvt_pk_bf16_f32 v65, v61, v61
    v_lshlrev_b32 v61, 16, v65
    v_add_f32 v61, 0x3727c5ac, v61
    v_cvt_pk_bf16_f32 v65, v61, v61
    v_lshlrev_b32 v61, 16, v65
    v_sqrt_f32 v61, v61
    s_nop 0
    v_cvt_pk_bf16_f32 v65, v61, v61
    v_lshlrev_b32 v61, 16, v65
    v_rcp_f32 v26, v61
    v_cvt_pk_bf16_f32 v65, v64, v64
    v_lshlrev_b32 v64, 16, v65
    v_mov_b32 v24, v64
    v_lshlrev_b32 v28, 16, v212
    v_and_b32 v29, s45, v212
    v_pk_add_f32 v[30:31], v[150:151], v[24:25] op_sel_hi:[1,0] neg_lo:[0,1] neg_hi:[0,1]
    v_pk_mul_f32 v[30:31], v[30:31], v[26:27] op_sel_hi:[1,0]
    v_pk_fma_f32 v[150:151], v[30:31], v[28:29], v[150:151]
    v_cvt_pk_bf16_f32 v222, v150, v151
    v_lshlrev_b32 v150, 16, v222
    v_and_b32 v151, s45, v222
    v_lshlrev_b32 v28, 16, v213
    v_and_b32 v29, s45, v213
    v_pk_add_f32 v[30:31], v[152:153], v[24:25] op_sel_hi:[1,0] neg_lo:[0,1] neg_hi:[0,1]
    v_pk_mul_f32 v[30:31], v[30:31], v[26:27] op_sel_hi:[1,0]
    v_pk_fma_f32 v[152:153], v[30:31], v[28:29], v[152:153]
    v_cvt_pk_bf16_f32 v223, v152, v153
    v_lshlrev_b32 v152, 16, v223
    v_and_b32 v153, s45, v223
    v_lshlrev_b32 v28, 16, v214
    v_and_b32 v29, s45, v214
    v_pk_add_f32 v[30:31], v[154:155], v[24:25] op_sel_hi:[1,0] neg_lo:[0,1] neg_hi:[0,1]
    v_pk_mul_f32 v[30:31], v[30:31], v[26:27] op_sel_hi:[1,0]
    v_pk_fma_f32 v[154:155], v[30:31], v[28:29], v[154:155]
    v_cvt_pk_bf16_f32 v224, v154, v155
    v_lshlrev_b32 v154, 16, v224
    v_and_b32 v155, s45, v224
    v_lshlrev_b32 v28, 16, v215
    v_and_b32 v29, s45, v215
    v_pk_add_f32 v[30:31], v[156:157], v[24:25] op_sel_hi:[1,0] neg_lo:[0,1] neg_hi:[0,1]
    v_pk_mul_f32 v[30:31], v[30:31], v[26:27] op_sel_hi:[1,0]
    v_pk_fma_f32 v[156:157], v[30:31], v[28:29], v[156:157]
    v_cvt_pk_bf16_f32 v225, v156, v157
    v_lshlrev_b32 v156, 16, v225
    v_and_b32 v157, s45, v225
    v_lshlrev_b32 v28, 16, v216
    v_and_b32 v29, s45, v216
    v_pk_add_f32 v[30:31], v[158:159], v[24:25] op_sel_hi:[1,0] neg_lo:[0,1] neg_hi:[0,1]
    v_pk_mul_f32 v[30:31], v[30:31], v[26:27] op_sel_hi:[1,0]
    v_pk_fma_f32 v[158:159], v[30:31], v[28:29], v[158:159]
    v_cvt_pk_bf16_f32 v226, v158, v159
    v_lshlrev_b32 v158, 16, v226
    v_and_b32 v159, s45, v226
    v_lshlrev_b32 v28, 16, v217
    v_and_b32 v29, s45, v217
    v_pk_add_f32 v[30:31], v[160:161], v[24:25] op_sel_hi:[1,0] neg_lo:[0,1] neg_hi:[0,1]
    v_pk_mul_f32 v[30:31], v[30:31], v[26:27] op_sel_hi:[1,0]
    v_pk_fma_f32 v[160:161], v[30:31], v[28:29], v[160:161]
    v_cvt_pk_bf16_f32 v227, v160, v161
    v_lshlrev_b32 v160, 16, v227
    v_and_b32 v161, s45, v227
    v_lshlrev_b32 v28, 16, v218
    v_and_b32 v29, s45, v218
    v_pk_add_f32 v[30:31], v[162:163], v[24:25] op_sel_hi:[1,0] neg_lo:[0,1] neg_hi:[0,1]
    v_pk_mul_f32 v[30:31], v[30:31], v[26:27] op_sel_hi:[1,0]
    v_pk_fma_f32 v[162:163], v[30:31], v[28:29], v[162:163]
    v_cvt_pk_bf16_f32 v228, v162, v163
    v_lshlrev_b32 v162, 16, v228
    v_and_b32 v163, s45, v228
    v_lshlrev_b32 v28, 16, v219
    v_and_b32 v29, s45, v219
    v_pk_add_f32 v[30:31], v[164:165], v[24:25] op_sel_hi:[1,0] neg_lo:[0,1] neg_hi:[0,1]
    v_pk_mul_f32 v[30:31], v[30:31], v[26:27] op_sel_hi:[1,0]
    v_pk_fma_f32 v[164:165], v[30:31], v[28:29], v[164:165]
    v_cvt_pk_bf16_f32 v229, v164, v165
    v_lshlrev_b32 v164, 16, v229
    v_and_b32 v165, s45, v229
    v_lshlrev_b32 v28, 16, v220
    v_and_b32 v29, s45, v220
    v_pk_add_f32 v[30:31], v[166:167], v[24:25] op_sel_hi:[1,0] neg_lo:[0,1] neg_hi:[0,1]
    v_pk_mul_f32 v[30:31], v[30:31], v[26:27] op_sel_hi:[1,0]
    v_pk_fma_f32 v[166:167], v[30:31], v[28:29], v[166:167]
    v_cvt_pk_bf16_f32 v230, v166, v167
    v_lshlrev_b32 v166, 16, v230
    v_and_b32 v167, s45, v230
    v_lshlrev_b32 v28, 16, v221
    v_and_b32 v29, s45, v221
    v_pk_add_f32 v[30:31], v[168:169], v[24:25] op_sel_hi:[1,0] neg_lo:[0,1] neg_hi:[0,1]
    v_pk_mul_f32 v[30:31], v[30:31], v[26:27] op_sel_hi:[1,0]
    v_pk_fma_f32 v[168:169], v[30:31], v[28:29], v[168:169]
    v_cvt_pk_bf16_f32 v231, v168, v169
    v_lshlrev_b32 v168, 16, v231
    v_and_b32 v169, s45, v231
    s_bitcmp1_b32 s41, 0
    s_nop 0
    s_cbranch_scc1 L_xo_80
    s_cmp_eq_u32 s7, 0
    s_cbranch_scc0 L_slow_82
    global_store_dwordx4 v174, v[222:225], s[38:39]
    global_store_dwordx4 v176, v[226:229], s[38:39]
    global_store_dwordx2 v178, v[230:231], s[38:39]
    s_nop 0
    s_branch L_sd_83
L_slow_82:
    global_store_dwordx4 v174, v[222:225], s[38:39] sc0 sc1
    global_store_dwordx4 v176, v[226:229], s[38:39] sc0 sc1
    global_store_dwordx2 v178, v[230:231], s[38:39] sc0 sc1
    s_nop 0
L_sd_83:
    s_branch L_xd_81
L_xo_80:
    s_cmp_eq_u32 s7, 0
    s_cbranch_scc0 L_slow_84
    global_store_dwordx2 v174, v[222:223], s[38:39]
    global_store_dwordx4 v175, v[224:227], s[38:39]
    global_store_dwordx4 v177, v[228:231], s[38:39]
    s_nop 1
    s_branch L_sd_85
L_slow_84:
    global_store_dwordx2 v174, v[222:223], s[38:39] sc0 sc1
    global_store_dwordx4 v175, v[224:227], s[38:39] sc0 sc1
    global_store_dwordx4 v177, v[228:231], s[38:39] sc0 sc1
    s_nop 1
L_sd_85:
L_xd_81:
    s_waitcnt vmcnt(0) lgkmcnt(0)
    s_barrier
    s_cmp_lg_u32 s6, 0
    s_cbranch_scc1 L_iw_86
    s_lshl_b32 s50, s5, 3
    s_add_u32 s3, s28, 5
    v_mov_b32 v176, s3
    s_xor_b32 s3, s3, s29
    v_mov_b32 v177, s3
    v_mov_b32 v178, s50
    s_mov_b64 s[92:93], exec
    s_mov_b64 exec, 1
    s_cmp_eq_u32 s7, 0
    s_cbranch_scc0 L_slow_87
    global_store_dwordx2 v178, v[176:177], s[64:65]
    s_branch L_sd_88
L_slow_87:
    global_store_dwordx2 v178, v[176:177], s[64:65] sc0 sc1
L_sd_88:
    s_mov_b64 exec, s[92:93]
L_iw_86:
    v_pk_add_f32 v[28:29], v[150:151], v[152:153]
    v_pk_add_f32 v[30:31], v[154:155], v[156:157]
    v_pk_add_f32 v[28:29], v[28:29], v[158:159]
    v_pk_add_f32 v[30:31], v[30:31], v[160:161]
    v_pk_add_f32 v[28:29], v[28:29], v[162:163]
    v_pk_add_f32 v[30:31], v[30:31], v[164:165]
    v_pk_add_f32 v[28:29], v[28:29], v[166:167]
    v_pk_add_f32 v[30:31], v[30:31], v[168:169]
    v_pk_add_f32 v[28:29], v[28:29], v[30:31]
    v_add_f32 v28, v28, v29
    v_mov_b32 v32, v28
    s_nop 1
    v_permlane16_swap_b32 v28, v32
    v_add_f32 v28, v28, v32
    v_mov_b32 v32, v28
    s_nop 1
    v_permlane32_swap_b32 v28, v32
    v_add_f32 v28, v28, v32
    v_mul_f32 v28, 0x3c4ccccd, v28
    v_pk_add_f32 v[34:35], v[150:151], v[28:29] op_sel_hi:[1,0] neg_lo:[0,1] neg_hi:[0,1]
    v_pk_add_f32 v[36:37], v[152:153], v[28:29] op_sel_hi:[1,0] neg_lo:[0,1] neg_hi:[0,1]
    v_pk_add_f32 v[38:39], v[154:155], v[28:29] op_sel_hi:[1,0] neg_lo:[0,1] neg_hi:[0,1]
    v_pk_add_f32 v[40:41], v[156:157], v[28:29] op_sel_hi:[1,0] neg_lo:[0,1] neg_hi:[0,1]
    v_pk_add_f32 v[42:43], v[158:159], v[28:29] op_sel_hi:[1,0] neg_lo:[0,1] neg_hi:[0,1]
    v_pk_add_f32 v[44:45], v[160:161], v[28:29] op_sel_hi:[1,0] neg_lo:[0,1] neg_hi:[0,1]
    v_pk_add_f32 v[46:47], v[162:163], v[28:29] op_sel_hi:[1,0] neg_lo:[0,1] neg_hi:[0,1]
    v_pk_add_f32 v[48:49], v[164:165], v[28:29] op_sel_hi:[1,0] neg_lo:[0,1] neg_hi:[0,1]
    v_pk_add_f32 v[50:51], v[166:167], v[28:29] op_sel_hi:[1,0] neg_lo:[0,1] neg_hi:[0,1]
    v_pk_add_f32 v[52:53], v[168:169], v[28:29] op_sel_hi:[1,0] neg_lo:[0,1] neg_hi:[0,1]
    v_pk_mul_f32 v[54:55], v[34:35], v[34:35]
    v_pk_mul_f32 v[30:31], v[36:37], v[36:37]
    v_pk_fma_f32 v[54:55], v[38:39], v[38:39], v[54:55]
    v_pk_fma_f32 v[30:31], v[40:41], v[40:41], v[30:31]
    v_pk_fma_f32 v[54:55], v[42:43], v[42:43], v[54:55]
    v_pk_fma_f32 v[30:31], v[44:45], v[44:45], v[30:31]
    v_pk_fma_f32 v[54:55], v[46:47], v[46:47], v[54:55]
    v_pk_fma_f32 v[30:31], v[48:49], v[48:49], v[30:31]
    v_pk_fma_f32 v[54:55], v[50:51], v[50:51], v[54:55]
    v_pk_fma_f32 v[30:31], v[52:53], v[52:53], v[30:31]
    v_pk_add_f32 v[54:55], v[54:55], v[30:31]
    v_add_f32 v29, v54, v55
    s_add_u32 s3, s28, 3
    v_mov_b32 v30, s3
    v_mov_b32 v32, v29
    s_nop 1
    v_permlane16_swap_b32 v29, v32
    v_add_f32 v29, v29, v32
    v_mov_b32 v32, v29
    s_nop 1
    v_permlane32_swap_b32 v29, v32
    v_add_f32 v29, v29, v32
    s_xor_b32 s3, s3, s29
    v_mov_b32 v31, s3
    s_add_u32 s66, s38, 1835008
    s_addc_u32 s67, s39, 0
    s_mov_b64 s[92:93], exec
    s_mov_b64 exec, 0xffff
    s_cmp_eq_u32 s7, 0
    s_cbranch_scc0 L_slow_89
    global_store_dwordx4 v170, v[28:31], s[66:67]
    s_nop 1
    s_branch L_sd_90
L_slow_89:
    global_store_dwordx4 v170, v[28:31], s[66:67] sc0 sc1
    s_nop 1
L_sd_90:
    s_mov_b64 exec, s[92:93]
    s_lshl_b32 s3, s4, 4
    s_lshl_b32 s50, s42, 3
    s_add_u32 s3, s3, s50
    s_lshl_b32 s50, s6, 1
    s_add_u32 s63, s3, s50
    s_mul_i32 s3, s63, 20480
    s_add_u32 s3, s3, s91
    s_add_u32 s86, s38, 0
    s_addc_u32 s87, s39, 0
    s_add_u32 s86, s86, s3
    s_addc_u32 s87, s87, 0
    s_add_u32 s68, s86, 20480
    s_addc_u32 s69, s87, 0
    v_lshlrev_b32 v183, 4, v1
    v_lshlrev_b32 v182, 4, v1
    s_mul_i32 s53, s63, 55296
    s_add_u32 s53, s53, s96
    s_add_u32 s51, s44, 0
    s_lshr_b32 s52, s51, 1
    s_lshl_b32 s52, s52, 10
    s_and_b32 s51, s51, 1
    s_lshl_b32 s51, s51, 3
    s_add_u32 s51, s51, s52
    s_add_u32 s51, s51, s53
    s_add_u32 s72, s38, s51
    s_addc_u32 s73, s39, 0
    s_add_u32 s51, s44, 1
    s_lshr_b32 s52, s51, 1
    s_lshl_b32 s52, s52, 10
    s_and_b32 s51, s51, 1
    s_lshl_b32 s51, s51, 3
    s_add_u32 s51, s51, s52
    s_add_u32 s51, s51, s53
    s_add_u32 s74, s38, s51
    s_addc_u32 s75, s39, 0
    s_add_u32 s51, s44, 2
    s_lshr_b32 s52, s51, 1
    s_lshl_b32 s52, s52, 10
    s_and_b32 s51, s51, 1
    s_lshl_b32 s51, s51, 3
    s_add_u32 s51, s51, s52
    s_add_u32 s51, s51, s53
    s_add_u32 s76, s38, s51
    s_addc_u32 s77, s39, 0
    s_add_u32 s51, s44, 3
    s_lshr_b32 s52, s51, 1
    s_lshl_b32 s52, s52, 10
    s_and_b32 s51, s51, 1
    s_lshl_b32 s51, s51, 3
    s_add_u32 s51, s51, s52
    s_add_u32 s51, s51, s53
    s_add_u32 s78, s38, s51
    s_addc_u32 s79, s39, 0
    s_add_u32 s51, s44, 4
    s_lshr_b32 s52, s51, 1
    s_lshl_b32 s52, s52, 10
    s_and_b32 s51, s51, 1
    s_lshl_b32 s51, s51, 3
    s_add_u32 s51, s51, s52
    s_add_u32 s51, s51, s53
    s_add_u32 s80, s38, s51
    s_addc_u32 s81, s39, 0
    s_add_u32 s51, s44, 5
    s_lshr_b32 s52, s51, 1
    s_lshl_b32 s52, s52, 10
    s_and_b32 s51, s51, 1
    s_lshl_b32 s51, s51, 3
    s_add_u32 s51, s51, s52
    s_add_u32 s51, s51, s53
    s_add_u32 s82, s38, s51
    s_addc_u32 s83, s39, 0
    s_add_u32 s51, s44, 6
    s_lshr_b32 s52, s51, 1
    s_lshl_b32 s52, s52, 10
    s_and_b32 s51, s51, 1
    s_lshl_b32 s51, s51, 3
    s_add_u32 s51, s51, s52
    s_add_u32 s51, s51, s53
    s_add_u32 s84, s38, s51
    s_addc_u32 s85, s39, 0
    v_bfe_u32 v172, v1, 2, 2
    v_lshl_add_u32 v172, v3, 2, v172
    v_mul_u32_u24 v172, 224, v172
    v_and_b32 v59, 3, v1
    v_lshl_add_u32 v172, v59, 3, v172
    ds_read_b64_tr_b16 v[60:61], v172 offset:0
    ds_read_b64_tr_b16 v[62:63], v172 offset:3584
    ds_read_b64_tr_b16 v[64:65], v172 offset:32
    ds_read_b64_tr_b16 v[66:67], v172 offset:3616
    ds_read_b64_tr_b16 v[68:69], v172 offset:64
    ds_read_b64_tr_b16 v[70:71], v172 offset:3648
    ds_read_b64_tr_b16 v[72:73], v172 offset:96
    ds_read_b64_tr_b16 v[74:75], v172 offset:3680
    ds_read_b64_tr_b16 v[76:77], v172 offset:128
    ds_read_b64_tr_b16 v[78:79], v172 offset:3712
    ds_read_b64_tr_b16 v[80:81], v172 offset:160
    ds_read_b64_tr_b16 v[82:83], v172 offset:3744
    ds_read_b64_tr_b16 v[84:85], v172 offset:192
    ds_read_b64_tr_b16 v[86:87], v172 offset:3776
    v_add_u32 v172, 7168, v172
    s_cmp_lg_u32 s6, 0
    s_nop 0
    s_cbranch_scc1 L_iw_91
    v_and_b32 v180, 31, v1
    v_lshlrev_b32 v180, 3, v180
    s_add_u32 s55, s28, 5
    s_mov_b32 s71, 400000
L_poll_92:
    global_load_dwordx2 v[176:177], v180, s[64:65] sc1
    s_sub_u32 s71, s71, 1
    s_cmp_eq_u32 s71, 0
    s_cbranch_scc1 L_abort
    s_waitcnt vmcnt(0)
    v_subrev_u32 v178, s55, v176
    v_cmp_lt_u32 vcc, 2, v178
    v_xor_b32 v178, v176, v177
    v_cmp_ne_u32 s[88:89], s29, v178
    s_or_b64 s[88:89], vcc, s[88:89]
    s_nop 3
    s_cbranch_scc1 L_poll_92
L_iw_91:
    s_barrier
    global_load_dwordx4 v[116:119], v183, s[86:87] offset:0 sc1
    global_load_dwordx4 v[120:123], v183, s[68:69] offset:0 sc1
    global_load_dwordx4 v[124:127], v183, s[86:87] offset:1024 sc1
    global_load_dwordx4 v[128:131], v183, s[68:69] offset:1024 sc1
    global_load_dwordx4 v[132:135], v183, s[86:87] offset:2048 sc1
    global_load_dwordx4 v[136:139], v183, s[68:69] offset:2048 sc1
    s_lshl_b32 s3, s63, 11
    s_add_u32 s3, s3, 1835008
    v_lshlrev_b32 v169, 7, v2
    v_lshl_add_u32 v169, v3, 5, v169
    v_add_u32 v169, s3, v169
    s_add_u32 s101, s28, 3
    global_load_dwordx4 v[140:143], v183, s[86:87] offset:3072 sc1
    global_load_dwordx4 v[144:147], v183, s[68:69] offset:3072 sc1
    v_add_u32 v183, 4096, v183
    global_load_dwordx4 v[148:151], v183, s[86:87] offset:0 sc1
    global_load_dwordx4 v[152:155], v183, s[68:69] offset:0 sc1
    global_load_dwordx4 v[156:159], v183, s[86:87] offset:1024 sc1
    global_load_dwordx4 v[160:163], v183, s[68:69] offset:1024 sc1
    s_waitcnt lgkmcnt(0)
    s_waitcnt vmcnt(10)
    v_mfma_f32_16x16x32_bf16 v[4:7], v[60:63], v[116:119], 0
    ds_read_b64_tr_b16 v[88:89], v172 offset:0
    ds_read_b64_tr_b16 v[90:91], v172 offset:3584
    v_mfma_f32_16x16x32_bf16 v[32:35], v[60:63], v[120:123], 0
    ds_read_b64_tr_b16 v[92:93], v172 offset:32
    v_mfma_f32_16x16x32_bf16 v[8:11], v[64:67], v[116:119], 0
    ds_read_b64_tr_b16 v[94:95], v172 offset:3616
    v_mfma_f32_16x16x32_bf16 v[36:39], v[64:67], v[120:123], 0
    ds_read_b64_tr_b16 v[96:97], v172 offset:64
    v_mfma_f32_16x16x32_bf16 v[12:15], v[68:71], v[116:119], 0
    ds_read_b64_tr_b16 v[98:99], v172 offset:3648
    v_mfma_f32_16x16x32_bf16 v[40:43], v[68:71], v[120:123], 0
    ds_read_b64_tr_b16 v[100:101], v172 offset:96
    v_mfma_f32_16x16x32_bf16 v[16:19], v[72:75], v[116:119], 0
    ds_read_b64_tr_b16 v[102:103], v172 offset:3680
    v_mfma_f32_16x16x32_bf16 v[44:47], v[72:75], v[120:123], 0
    ds_read_b64_tr_b16 v[104:105], v172 offset:128
    v_mfma_f32_16x16x32_bf16 v[20:23], v[76:79], v[116:119], 0
    ds_read_b64_tr_b16 v[106:107], v172 offset:3712
    v_mfma_f32_16x16x32_bf16 v[48:51], v[76:79], v[120:123], 0
    ds_read_b64_tr_b16 v[108:109], v172 offset:160
    v_mfma_f32_16x16x32_bf16 v[24:27], v[80:83], v[116:119], 0
    ds_read_b64_tr_b16 v[110:111], v172 offset:3744
    v_mfma_f32_16x16x32_bf16 v[52:55], v[80:83], v[120:123], 0
    ds_read_b64_tr_b16 v[112:113], v172 offset:192
    v_mfma_f32_16x16x32_bf16 v[28:31], v[84:87], v[116:119], 0
    ds_read_b64_tr_b16 v[114:115], v172 offset:3776
    v_mfma_f32_16x16x32_bf16 v[56:59], v[84:87], v[120:123], 0
    v_add_u32 v172, 7168, v172
    global_load_dwordx4 v[116:119], v183, s[86:87] offset:2048 sc1
    global_load_dwordx4 v[120:123], v183, s[68:69] offset:2048 sc1
    s_waitcnt lgkmcnt(0)
    s_waitcnt vmcnt(10)
    v_mfma_f32_16x16x32_bf16 v[4:7], v[88:91], v[124:127], v[4:7]
    ds_read_b64_tr_b16 v[60:61], v172 offset:0
    ds_read_b64_tr_b16 v[62:63], v172 offset:3584
    v_mfma_f32_16x16x32_bf16 v[32:35], v[88:91], v[128:131], v[32:35]
    ds_read_b64_tr_b16 v[64:65], v172 offset:32
    v_mfma_f32_16x16x32_bf16 v[8:11], v[92:95], v[124:127], v[8:11]
    ds_read_b64_tr_b16 v[66:67], v172 offset:3616
    v_mfma_f32_16x16x32_bf16 v[36:39], v[92:95], v[128:131], v[36:39]
    ds_read_b64_tr_b16 v[68:69], v172 offset:64
    v_mfma_f32_16x16x32_bf16 v[12:15], v[96:99], v[124:127], v[12:15]
    ds_read_b64_tr_b16 v[70:71], v172 offset:3648
    v_mfma_f32_16x16x32_bf16 v[40:43], v[96:99], v[128:131], v[40:43]
    ds_read_b64_tr_b16 v[72:73], v172 offset:96
    v_mfma_f32_16x16x32_bf16 v[16:19], v[100:103], v[124:127], v[16:19]
    ds_read_b64_tr_b16 v[74:75], v172 offset:3680
    v_mfma_f32_16x16x32_bf16 v[44:47], v[100:103], v[128:131], v[44:47]
    ds_read_b64_tr_b16 v[76:77], v172 offset:128
    v_mfma_f32_16x16x32_bf16 v[20:23], v[104:107], v[124:127], v[20:23]
    ds_read_b64_tr_b16 v[78:79], v172 offset:3712
    v_mfma_f32_16x16x32_bf16 v[48:51], v[104:107], v[128:131], v[48:51]
    ds_read_b64_tr_b16 v[80:81], v172 offset:160
    v_mfma_f32_16x16x32_bf16 v[24:27], v[108:111], v[124:127], v[24:27]
    ds_read_b64_tr_b16 v[82:83], v172 offset:3744
    v_mfma_f32_16x16x32_bf16 v[52:55], v[108:111], v[128:131], v[52:55]
    ds_read_b64_tr_b16 v[84:85], v172 offset:192
    v_mfma_f32_16x16x32_bf16 v[28:31], v[112:115], v[124:127], v[28:31]
    ds_read_b64_tr_b16 v[86:87], v172 offset:3776
    v_mfma_f32_16x16x32_bf16 v[56:59], v[112:115], v[128:131], v[56:59]
    v_add_u32 v172, 7168, v172
    global_load_dwordx4 v[124:127], v183, s[86:87] offset:3072 sc1
    global_load_dwordx4 v[128:131], v183, s[68:69] offset:3072 sc1
    v_add_u32 v183, 4096, v183
    s_waitcnt lgkmcnt(0)
    s_waitcnt vmcnt(10)
    v_mfma_f32_16x16x32_bf16 v[4:7], v[60:63], v[132:135], v[4:7]
    ds_read_b64_tr_b16 v[88:89], v172 offset:0
    ds_read_b64_tr_b16 v[90:91], v172 offset:3584
    v_mfma_f32_16x16x32_bf16 v[32:35], v[60:63], v[136:139], v[32:35]
    ds_read_b64_tr_b16 v[92:93], v172 offset:32
    v_mfma_f32_16x16x32_bf16 v[8:11], v[64:67], v[132:135], v[8:11]
    ds_read_b64_tr_b16 v[94:95], v172 offset:3616
    v_mfma_f32_16x16x32_bf16 v[36:39], v[64:67], v[136:139], v[36:39]
    ds_read_b64_tr_b16 v[96:97], v172 offset:64
    v_mfma_f32_16x16x32_bf16 v[12:15], v[68:71], v[132:135], v[12:15]
    ds_read_b64_tr_b16 v[98:99], v172 offset:3648
    ds_read_b64_tr_b16 v[100:101], v172 offset:96
    v_mfma_f32_16x16x32_bf16 v[40:43], v[68:71], v[136:139], v[40:43]
    ds_read_b64_tr_b16 v[102:103], v172 offset:3680
    v_mfma_f32_16x16x32_bf16 v[16:19], v[72:75], v[132:135], v[16:19]
    ds_read_b64_tr_b16 v[104:105], v172 offset:128
    v_mfma_f32_16x16x32_bf16 v[44:47], v[72:75], v[136:139], v[44:47]
    ds_read_b64_tr_b16 v[106:107], v172 offset:3712
    v_mfma_f32_16x16x32_bf16 v[20:23], v[76:79], v[132:135], v[20:23]
    ds_read_b64_tr_b16 v[108:109], v172 offset:160
    ds_read_b64_tr_b16 v[110:111], v172 offset:3744
    v_mfma_f32_16x16x32_bf16 v[48:51], v[76:79], v[136:139], v[48:51]
    ds_read_b64_tr_b16 v[112:113], v172 offset:192
    v_mfma_f32_16x16x32_bf16 v[24:27], v[80:83], v[132:135], v[24:27]
    ds_read_b64_tr_b16 v[114:115], v172 offset:3776
    v_mfma_f32_16x16x32_bf16 v[52:55], v[80:83], v[136:139], v[52:55]
    global_load_dwordx4 v[174:177], v169, s[38:39] offset:0 sc1
    v_mfma_f32_16x16x32_bf16 v[28:31], v[84:87], v[132:135], v[28:31]
    global_load_dwordx4 v[178:181], v169, s[38:39] offset:16 sc1
    v_mfma_f32_16x16x32_bf16 v[56:59], v[84:87], v[136:139], v[56:59]
    v_add_u32 v172, 7168, v172
    global_load_dwordx4 v[132:135], v183, s[86:87] offset:0 sc1
    global_load_dwordx4 v[136:139], v183, s[68:69] offset:0 sc1
    s_waitcnt lgkmcnt(0)
    s_waitcnt vmcnt(12)
    v_mfma_f32_16x16x32_bf16 v[4:7], v[88:91], v[140:143], v[4:7]
    ds_read_b64_tr_b16 v[60:61], v172 offset:0
    ds_read_b64_tr_b16 v[62:63], v172 offset:3584
    v_mfma_f32_16x16x32_bf16 v[32:35], v[88:91], v[144:147], v[32:35]
    ds_read_b64_tr_b16 v[64:65], v172 offset:32
    v_mfma_f32_16x16x32_bf16 v[8:11], v[92:95], v[140:143], v[8:11]
    ds_read_b64_tr_b16 v[66:67], v172 offset:3616
    v_mfma_f32_16x16x32_bf16 v[36:39], v[92:95], v[144:147], v[36:39]
    ds_read_b64_tr_b16 v[68:69], v172 offset:64
    v_mfma_f32_16x16x32_bf16 v[12:15], v[96:99], v[140:143], v[12:15]
    ds_read_b64_tr_b16 v[70:71], v172 offset:3648
    v_mfma_f32_16x16x32_bf16 v[40:43], v[96:99], v[144:147], v[40:43]
    ds_read_b64_tr_b16 v[72:73], v172 offset:96
    v_mfma_f32_16x16x32_bf16 v[16:19], v[100:103], v[140:143], v[16:19]
    ds_read_b64_tr_b16 v[74:75], v172 offset:3680
    v_mfma_f32_16x16x32_bf16 v[44:47], v[100:103], v[144:147], v[44:47]
    ds_read_b64_tr_b16 v[76:77], v172 offset:128
    v_mfma_f32_16x16x32_bf16 v[20:23], v[104:107], v[140:143], v[20:23]
    ds_read_b64_tr_b16 v[78:79], v172 offset:3712
    v_mfma_f32_16x16x32_bf16 v[48:51], v[104:107], v[144:147], v[48:51]
    ds_read_b64_tr_b16 v[80:81], v172 offset:160
    v_mfma_f32_16x16x32_bf16 v[24:27], v[108:111], v[140:143], v[24:27]
    ds_read_b64_tr_b16 v[82:83], v172 offset:3744
    v_mfma_f32_16x16x32_bf16 v[52:55], v[108:111], v[144:147], v[52:55]
    ds_read_b64_tr_b16 v[84:85], v172 offset:192
    v_mfma_f32_16x16x32_bf16 v[28:31], v[112:115], v[140:143], v[28:31]
    ds_read_b64_tr_b16 v[86:87], v172 offset:3776
    v_mfma_f32_16x16x32_bf16 v[56:59], v[112:115], v[144:147], v[56:59]
    v_add_u32 v172, 7168, v172
    global_load_dwordx4 v[140:143], v183, s[86:87] offset:1024 sc1
    global_load_dwordx4 v[144:147], v183, s[68:69] offset:1024 sc1
    s_waitcnt lgkmcnt(0)
    s_waitcnt vmcnt(12)
    v_mfma_f32_16x16x32_bf16 v[4:7], v[60:63], v[148:151], v[4:7]
    ds_read_b64_tr_b16 v[88:89], v172 offset:0
    ds_read_b64_tr_b16 v[90:91], v172 offset:3584
    v_mfma_f32_16x16x32_bf16 v[32:35], v[60:63], v[152:155], v[32:35]
    ds_read_b64_tr_b16 v[92:93], v172 offset:32
    v_mfma_f32_16x16x32_bf16 v[8:11], v[64:67], v[148:151], v[8:11]
    ds_read_b64_tr_b16 v[94:95], v172 offset:3616
    v_mfma_f32_16x16x32_bf16 v[36:39], v[64:67], v[152:155], v[36:39]
    ds_read_b64_tr_b16 v[96:97], v172 offset:64
    v_mfma_f32_16x16x32_bf16 v[12:15], v[68:71], v[148:151], v[12:15]
    ds_read_b64_tr_b16 v[98:99], v172 offset:3648
    v_mfma_f32_16x16x32_bf16 v[40:43], v[68:71], v[152:155], v[40:43]
    ds_read_b64_tr_b16 v[100:101], v172 offset:96
    v_mfma_f32_16x16x32_bf16 v[16:19], v[72:75], v[148:151], v[16:19]
    ds_read_b64_tr_b16 v[102:103], v172 offset:3680
    v_mfma_f32_16x16x32_bf16 v[44:47], v[72:75], v[152:155], v[44:47]
    ds_read_b64_tr_b16 v[104:105], v172 offset:128
    v_mfma_f32_16x16x32_bf16 v[20:23], v[76:79], v[148:151], v[20:23]
    ds_read_b64_tr_b16 v[106:107], v172 offset:3712
    v_mfma_f32_16x16x32_bf16 v[48:51], v[76:79], v[152:155], v[48:51]
    ds_read_b64_tr_b16 v[108:109], v172 offset:160
    v_mfma_f32_16x16x32_bf16 v[24:27], v[80:83], v[148:151], v[24:27]
    ds_read_b64_tr_b16 v[110:111], v172 offset:3744
    v_mfma_f32_16x16x32_bf16 v[52:55], v[80:83], v[152:155], v[52:55]
    ds_read_b64_tr_b16 v[112:113], v172 offset:192
    v_mfma_f32_16x16x32_bf16 v[28:31], v[84:87], v[148:151], v[28:31]
    ds_read_b64_tr_b16 v[114:115], v172 offset:3776
    v_mfma_f32_16x16x32_bf16 v[56:59], v[84:87], v[152:155], v[56:59]
    v_add_u32 v172, 7168, v172
    global_load_dwordx4 v[148:151], v183, s[86:87] offset:2048 sc1
    global_load_dwordx4 v[152:155], v183, s[68:69] offset:2048 sc1
    s_waitcnt lgkmcnt(0)
    s_waitcnt vmcnt(12)
    v_mfma_f32_16x16x32_bf16 v[4:7], v[88:91], v[156:159], v[4:7]
    ds_read_b64_tr_b16 v[60:61], v172 offset:0
    ds_read_b64_tr_b16 v[62:63], v172 offset:3584
    v_mfma_f32_16x16x32_bf16 v[32:35], v[88:91], v[160:163], v[32:35]
    ds_read_b64_tr_b16 v[64:65], v172 offset:32
    v_mfma_f32_16x16x32_bf16 v[8:11], v[92:95], v[156:159], v[8:11]
    ds_read_b64_tr_b16 v[66:67], v172 offset:3616
    v_mfma_f32_16x16x32_bf16 v[36:39], v[92:95], v[160:163], v[36:39]
    ds_read_b64_tr_b16 v[68:69], v172 offset:64
    ds_read_b64_tr_b16 v[70:71], v172 offset:3648
    v_mfma_f32_16x16x32_bf16 v[12:15], v[96:99], v[156:159], v[12:15]
    ds_read_b64_tr_b16 v[72:73], v172 offset:96
    v_mfma_f32_16x16x32_bf16 v[40:43], v[96:99], v[160:163], v[40:43]
    ds_read_b64_tr_b16 v[74:75], v172 offset:3680
    v_mfma_f32_16x16x32_bf16 v[16:19], v[100:103], v[156:159], v[16:19]
    ds_read_b64_tr_b16 v[76:77], v172 offset:128
    ds_read_b64_tr_b16 v[78:79], v172 offset:3712
    v_mfma_f32_16x16x32_bf16 v[44:47], v[100:103], v[160:163], v[44:47]
    ds_read_b64_tr_b16 v[80:81], v172 offset:160
    v_mfma_f32_16x16x32_bf16 v[20:23], v[104:107], v[156:159], v[20:23]
    ds_read_b64_tr_b16 v[82:83], v172 offset:3744
    v_mfma_f32_16x16x32_bf16 v[48:51], v[104:107], v[160:163], v[48:51]
    ds_read_b64_tr_b16 v[84:85], v172 offset:192
    ds_read_b64_tr_b16 v[86:87], v172 offset:3776
    v_mfma_f32_16x16x32_bf16 v[24:27], v[108:111], v[156:159], v[24:27]
    s_waitcnt vmcnt(6)
    v_xor_b32 v170, s101, v176
    v_xor_b32 v171, s101, v180
    v_or_b32 v170, v170, v171
    v_xor_b32 v171, v176, v177
    v_xor_b32 v171, s29, v171
    v_or_b32 v170, v170, v171
    v_xor_b32 v171, v180, v181
    v_xor_b32 v171, s29, v171
    v_or_b32 v170, v170, v171
    v_cmp_ne_u32 vcc, 0, v170
    s_cbranch_vccnz L_str_93
L_stb_94:
    v_mfma_f32_16x16x32_bf16 v[52:55], v[108:111], v[160:163], v[52:55]
    v_mov_b32 v176, v178
    v_mfma_f32_16x16x32_bf16 v[28:31], v[112:115], v[156:159], v[28:31]
    v_mov_b32 v177, v179
    v_mfma_f32_16x16x32_bf16 v[56:59], v[112:115], v[160:163], v[56:59]
    v_add_u32 v172, 7168, v172
    global_load_dwordx4 v[156:159], v183, s[86:87] offset:3072 sc1
    global_load_dwordx4 v[160:163], v183, s[68:69] offset:3072 sc1
    v_add_u32 v183, 4096, v183
    s_waitcnt lgkmcnt(0)
    v_mfma_f32_16x16x32_bf16 v[4:7], v[60:63], v[116:119], v[4:7]
    ds_read_b64_tr_b16 v[88:89], v172 offset:0
    ds_read_b64_tr_b16 v[90:91], v172 offset:3584
    v_mfma_f32_16x16x32_bf16 v[32:35], v[60:63], v[120:123], v[32:35]
    ds_read_b64_tr_b16 v[92:93], v172 offset:32
    ds_read_b64_tr_b16 v[94:95], v172 offset:3616
    v_mfma_f32_16x16x32_bf16 v[8:11], v[64:67], v[116:119], v[8:11]
    ds_read_b64_tr_b16 v[96:97], v172 offset:64
    ds_read_b64_tr_b16 v[98:99], v172 offset:3648
    v_mfma_f32_16x16x32_bf16 v[36:39], v[64:67], v[120:123], v[36:39]
    ds_read_b64_tr_b16 v[100:101], v172 offset:96
    ds_read_b64_tr_b16 v[102:103], v172 offset:3680
    v_mfma_f32_16x16x32_bf16 v[12:15], v[68:71], v[116:119], v[12:15]
    ds_read_b64_tr_b16 v[104:105], v172 offset:128
    v_mfma_f32_16x16x32_bf16 v[40:43], v[68:71], v[120:123], v[40:43]
    ds_read_b64_tr_b16 v[106:107], v172 offset:3712
    ds_read_b64_tr_b16 v[108:109], v172 offset:160
    v_mfma_f32_16x16x32_bf16 v[16:19], v[72:75], v[116:119], v[16:19]
    ds_read_b64_tr_b16 v[110:111], v172 offset:3744
    ds_read_b64_tr_b16 v[112:113], v172 offset:192
    v_mfma_f32_16x16x32_bf16 v[44:47], v[72:75], v[120:123], v[44:47]
    ds_read_b64_tr_b16 v[114:115], v172 offset:3776
    v_add_f32 v178, v174, v176
    v_mfma_f32_16x16x32_bf16 v[20:23], v[76:79], v[116:119], v[20:23]
    v_mov_b32 v179, v178
    v_mfma_f32_16x16x32_bf16 v[48:51], v[76:79], v[120:123], v[48:51]
    s_nop 0
    v_permlane16_swap_b32 v178, v179
    v_add_f32 v178, v178, v179
    v_mfma_f32_16x16x32_bf16 v[24:27], v[80:83], v[116:119], v[24:27]
    v_mov_b32 v179, v178
    s_nop 1
    v_permlane32_swap_b32 v178, v179
    v_mfma_f32_16x16x32_bf16 v[52:55], v[80:83], v[120:123], v[52:55]
    v_add_f32 v178, v178, v179
    v_mul_f32 v178, 0x3e000000, v178
    v_mfma_f32_16x16x32_bf16 v[28:31], v[84:87], v[116:119], v[28:31]
    v_sub_f32 v174, v174, v178
    v_mfma_f32_16x16x32_bf16 v[56:59], v[84:87], v[120:123], v[56:59]
    v_add_u32 v172, 7168, v172
    global_load_dwordx4 v[116:119], v183, s[86:87] offset:0 sc1
    global_load_dwordx4 v[120:123], v183, s[68:69] offset:0 sc1
    s_waitcnt lgkmcnt(0)
    v_mfma_f32_16x16x32_bf16 v[4:7], v[88:91], v[124:127], v[4:7]
    ds_read_b64_tr_b16 v[60:61], v172 offset:0
    ds_read_b64_tr_b16 v[62:63], v172 offset:3584
    v_mfma_f32_16x16x32_bf16 v[32:35], v[88:91], v[128:131], v[32:35]
    ds_read_b64_tr_b16 v[64:65], v172 offset:32
    ds_read_b64_tr_b16 v[66:67], v172 offset:3616
    v_mfma_f32_16x16x32_bf16 v[8:11], v[92:95], v[124:127], v[8:11]
    ds_read_b64_tr_b16 v[68:69], v172 offset:64
    ds_read_b64_tr_b16 v[70:71], v172 offset:3648
    v_mfma_f32_16x16x32_bf16 v[36:39], v[92:95], v[128:131], v[36:39]
    ds_read_b64_tr_b16 v[72:73], v172 offset:96
    ds_read_b64_tr_b16 v[74:75], v172 offset:3680
    v_mfma_f32_16x16x32_bf16 v[12:15], v[96:99], v[124:127], v[12:15]
    ds_read_b64_tr_b16 v[76:77], v172 offset:128
    v_mfma_f32_16x16x32_bf16 v[40:43], v[96:99], v[128:131], v[40:43]
    ds_read_b64_tr_b16 v[78:79], v172 offset:3712
    ds_read_b64_tr_b16 v[80:81], v172 offset:160
    v_mfma_f32_16x16x32_bf16 v[16:19], v[100:103], v[124:127], v[16:19]
    ds_read_b64_tr_b16 v[82:83], v172 offset:3744
    ds_read_b64_tr_b16 v[84:85], v172 offset:192
    v_mfma_f32_16x16x32_bf16 v[44:47], v[100:103], v[128:131], v[44:47]
    ds_read_b64_tr_b16 v[86:87], v172 offset:3776
    v_sub_f32 v176, v176, v178
    v_mfma_f32_16x16x32_bf16 v[20:23], v[104:107], v[124:127], v[20:23]
    v_mul_f32 v174, v174, v174
    v_mfma_f32_16x16x32_bf16 v[48:51], v[104:107], v[128:131], v[48:51]
    v_fmac_f32 v174, v176, v176
    v_add_f32 v175, v175, v177
    v_mfma_f32_16x16x32_bf16 v[24:27], v[108:111], v[124:127], v[24:27]
    v_mov_b32 v179, 0x42a00000
    v_fmac_f32 v175, v174, v179
    v_mfma_f32_16x16x32_bf16 v[52:55], v[108:111], v[128:131], v[52:55]
    v_mov_b32 v179, v175
    s_nop 1
    v_permlane16_swap_b32 v175, v179
    v_mfma_f32_16x16x32_bf16 v[28:31], v[112:115], v[124:127], v[28:31]
    v_add_f32 v175, v175, v179
    v_mfma_f32_16x16x32_bf16 v[56:59], v[112:115], v[128:131], v[56:59]
    v_add_u32 v172, 7168, v172
    global_load_dwordx4 v[124:127], v183, s[86:87] offset:1024 sc1
    global_load_dwordx4 v[128:131], v183, s[68:69] offset:1024 sc1
    s_waitcnt lgkmcnt(0)
    s_waitcnt vmcnt(10)
    v_mfma_f32_16x16x32_bf16 v[4:7], v[60:63], v[132:135], v[4:7]
    ds_read_b64_tr_b16 v[88:89], v172 offset:0
    ds_read_b64_tr_b16 v[90:91], v172 offset:3584
    v_mfma_f32_16x16x32_bf16 v[32:35], v[60:63], v[136:139], v[32:35]
    ds_read_b64_tr_b16 v[92:93], v172 offset:32
    ds_read_b64_tr_b16 v[94:95], v172 offset:3616
    v_mfma_f32_16x16x32_bf16 v[8:11], v[64:67], v[132:135], v[8:11]
    ds_read_b64_tr_b16 v[96:97], v172 offset:64
    ds_read_b64_tr_b16 v[98:99], v172 offset:3648
    v_mfma_f32_16x16x32_bf16 v[36:39], v[64:67], v[136:139], v[36:39]
    ds_read_b64_tr_b16 v[100:101], v172 offset:96
    ds_read_b64_tr_b16 v[102:103], v172 offset:3680
    v_mfma_f32_16x16x32_bf16 v[12:15], v[68:71], v[132:135], v[12:15]
    ds_read_b64_tr_b16 v[104:105], v172 offset:128
    v_mfma_f32_16x16x32_bf16 v[40:43], v[68:71], v[136:139], v[40:43]
    ds_read_b64_tr_b16 v[106:107], v172 offset:3712
    ds_read_b64_tr_b16 v[108:109], v172 offset:160
    v_mfma_f32_16x16x32_bf16 v[16:19], v[72:75], v[132:135], v[16:19]
    ds_read_b64_tr_b16 v[110:111], v172 offset:3744
    ds_read_b64_tr_b16 v[112:113], v172 offset:192
    v_mfma_f32_16x16x32_bf16 v[44:47], v[72:75], v[136:139], v[44:47]
    ds_read_b64_tr_b16 v[114:115], v172 offset:3776
    v_mov_b32 v179, v175
    v_mfma_f32_16x16x32_bf16 v[20:23], v[76:79], v[132:135], v[20:23]
    s_nop 0
    v_permlane32_swap_b32 v175, v179
    v_mfma_f32_16x16x32_bf16 v[48:51], v[76:79], v[136:139], v[48:51]
    v_add_f32 v175, v175, v179
    v_mul_f32 v175, 0x3acccccd, v175
    v_mfma_f32_16x16x32_bf16 v[24:27], v[80:83], v[132:135], v[24:27]
    v_cvt_pk_bf16_f32 v179, v175, v175
    v_lshlrev_b32 v175, 16, v179
    v_mfma_f32_16x16x32_bf16 v[52:55], v[80:83], v[136:139], v[52:55]
    v_add_f32 v175, 0x3727c5ac, v175
    v_cvt_pk_bf16_f32 v179, v175, v175
    v_mfma_f32_16x16x32_bf16 v[28:31], v[84:87], v[132:135], v[28:31]
    v_lshlrev_b32 v175, 16, v179
    v_mfma_f32_16x16x32_bf16 v[56:59], v[84:87], v[136:139], v[56:59]
    v_add_u32 v172, 7168, v172
    global_load_dwordx4 v[132:135], v183, s[86:87] offset:2048 sc1
    global_load_dwordx4 v[136:139], v183, s[68:69] offset:2048 sc1
    s_waitcnt lgkmcnt(0)
    s_waitcnt vmcnt(10)
    v_mfma_f32_16x16x32_bf16 v[4:7], v[88:91], v[140:143], v[4:7]
    ds_read_b64_tr_b16 v[60:61], v172 offset:0
    ds_read_b64_tr_b16 v[62:63], v172 offset:3584
    v_mfma_f32_16x16x32_bf16 v[32:35], v[88:91], v[144:147], v[32:35]
    ds_read_b64_tr_b16 v[64:65], v172 offset:32
    ds_read_b64_tr_b16 v[66:67], v172 offset:3616
    v_mfma_f32_16x16x32_bf16 v[8:11], v[92:95], v[140:143], v[8:11]
    ds_read_b64_tr_b16 v[68:69], v172 offset:64
    ds_read_b64_tr_b16 v[70:71], v172 offset:3648
    v_mfma_f32_16x16x32_bf16 v[36:39], v[92:95], v[144:147], v[36:39]
    ds_read_b64_tr_b16 v[72:73], v172 offset:96
    v_mfma_f32_16x16x32_bf16 v[12:15], v[96:99], v[140:143], v[12:15]
    ds_read_b64_tr_b16 v[74:75], v172 offset:3680
    ds_read_b64_tr_b16 v[76:77], v172 offset:128
    v_mfma_f32_16x16x32_bf16 v[40:43], v[96:99], v[144:147], v[40:43]
    ds_read_b64_tr_b16 v[78:79], v172 offset:3712
    ds_read_b64_tr_b16 v[80:81], v172 offset:160
    v_mfma_f32_16x16x32_bf16 v[16:19], v[100:103], v[140:143], v[16:19]
    ds_read_b64_tr_b16 v[82:83], v172 offset:3744
    v_mfma_f32_16x16x32_bf16 v[44:47], v[100:103], v[144:147], v[44:47]
    ds_read_b64_tr_b16 v[84:85], v172 offset:192
    ds_read_b64_tr_b16 v[86:87], v172 offset:3776
    v_mfma_f32_16x16x32_bf16 v[20:23], v[104:107], v[140:143], v[20:23]
    v_sqrt_f32 v175, v175
    s_nop 0
    v_mfma_f32_16x16x32_bf16 v[48:51], v[104:107], v[144:147], v[48:51]
    v_cvt_pk_bf16_f32 v179, v175, v175
    v_mfma_f32_16x16x32_bf16 v[24:27], v[108:111], v[140:143], v[24:27]
    v_lshlrev_b32 v175, 16, v179
    v_rcp_f32 v165, v175
    v_mfma_f32_16x16x32_bf16 v[52:55], v[108:111], v[144:147], v[52:55]
    v_cvt_pk_bf16_f32 v179, v178, v178
    v_lshlrev_b32 v178, 16, v179
    v_mfma_f32_16x16x32_bf16 v[28:31], v[112:115], v[140:143], v[28:31]
    v_mov_b32 v164, v178
    v_mfma_f32_16x16x32_bf16 v[56:59], v[112:115], v[144:147], v[56:59]
    v_add_u32 v172, 7168, v172
    global_load_dwordx4 v[140:143], v183, s[86:87] offset:3072 sc1
    global_load_dwordx4 v[144:147], v183, s[68:69] offset:3072 sc1
    v_add_u32 v183, 4096, v183
    s_waitcnt lgkmcnt(0)
    s_waitcnt vmcnt(10)
    v_mfma_f32_16x16x32_bf16 v[4:7], v[60:63], v[148:151], v[4:7]
    ds_read_b64_tr_b16 v[88:89], v172 offset:0
    ds_read_b64_tr_b16 v[90:91], v172 offset:3584
    v_mfma_f32_16x16x32_bf16 v[32:35], v[60:63], v[152:155], v[32:35]
    ds_read_b64_tr_b16 v[92:93], v172 offset:32
    v_mfma_f32_16x16x32_bf16 v[8:11], v[64:67], v[148:151], v[8:11]
    ds_read_b64_tr_b16 v[94:95], v172 offset:3616
    v_mfma_f32_16x16x32_bf16 v[36:39], v[64:67], v[152:155], v[36:39]
    ds_read_b64_tr_b16 v[96:97], v172 offset:64
    v_mfma_f32_16x16x32_bf16 v[12:15], v[68:71], v[148:151], v[12:15]
    ds_read_b64_tr_b16 v[98:99], v172 offset:3648
    ds_read_b64_tr_b16 v[100:101], v172 offset:96
    v_mfma_f32_16x16x32_bf16 v[40:43], v[68:71], v[152:155], v[40:43]
    ds_read_b64_tr_b16 v[102:103], v172 offset:3680
    v_mfma_f32_16x16x32_bf16 v[16:19], v[72:75], v[148:151], v[16:19]
    ds_read_b64_tr_b16 v[104:105], v172 offset:128
    v_mfma_f32_16x16x32_bf16 v[44:47], v[72:75], v[152:155], v[44:47]
    ds_read_b64_tr_b16 v[106:107], v172 offset:3712
    v_mfma_f32_16x16x32_bf16 v[20:23], v[76:79], v[148:151], v[20:23]
    ds_read_b64_tr_b16 v[108:109], v172 offset:160
    ds_read_b64_tr_b16 v[110:111], v172 offset:3744
    v_mfma_f32_16x16x32_bf16 v[48:51], v[76:79], v[152:155], v[48:51]
    ds_read_b64_tr_b16 v[112:113], v172 offset:192
    v_mfma_f32_16x16x32_bf16 v[24:27], v[80:83], v[148:151], v[24:27]
    ds_read_b64_tr_b16 v[114:115], v172 offset:3776
    v_mfma_f32_16x16x32_bf16 v[52:55], v[80:83], v[152:155], v[52:55]
    global_load_dwordx4 v[174:177], v169, s[38:39] offset:2048 sc1
    v_mfma_f32_16x16x32_bf16 v[28:31], v[84:87], v[148:151], v[28:31]
    global_load_dwordx4 v[178:181], v169, s[38:39] offset:2064 sc1
    v_mfma_f32_16x16x32_bf16 v[56:59], v[84:87], v[152:155], v[56:59]
    v_add_u32 v172, 7168, v172
    global_load_dwordx4 v[148:151], v183, s[86:87] offset:0 sc1
    global_load_dwordx4 v[152:155], v183, s[68:69] offset:0 sc1
    s_waitcnt lgkmcnt(0)
    s_waitcnt vmcnt(12)
    v_mfma_f32_16x16x32_bf16 v[4:7], v[88:91], v[156:159], v[4:7]
    ds_read_b64_tr_b16 v[60:61], v172 offset:0
    ds_read_b64_tr_b16 v[62:63], v172 offset:3584
    v_mfma_f32_16x16x32_bf16 v[32:35], v[88:91], v[160:163], v[32:35]
    ds_read_b64_tr_b16 v[64:65], v172 offset:32
    v_mfma_f32_16x16x32_bf16 v[8:11], v[92:95], v[156:159], v[8:11]
    ds_read_b64_tr_b16 v[66:67], v172 offset:3616
    v_mfma_f32_16x16x32_bf16 v[36:39], v[92:95], v[160:163], v[36:39]
    ds_read_b64_tr_b16 v[68:69], v172 offset:64
    v_mfma_f32_16x16x32_bf16 v[12:15], v[96:99], v[156:159], v[12:15]
    ds_read_b64_tr_b16 v[70:71], v172 offset:3648
    v_mfma_f32_16x16x32_bf16 v[40:43], v[96:99], v[160:163], v[40:43]
    ds_read_b64_tr_b16 v[72:73], v172 offset:96
    v_mfma_f32_16x16x32_bf16 v[16:19], v[100:103], v[156:159], v[16:19]
    ds_read_b64_tr_b16 v[74:75], v172 offset:3680
    v_mfma_f32_16x16x32_bf16 v[44:47], v[100:103], v[160:163], v[44:47]
    ds_read_b64_tr_b16 v[76:77], v172 offset:128
    v_mfma_f32_16x16x32_bf16 v[20:23], v[104:107], v[156:159], v[20:23]
    ds_read_b64_tr_b16 v[78:79], v172 offset:3712
    v_mfma_f32_16x16x32_bf16 v[48:51], v[104:107], v[160:163], v[48:51]
    ds_read_b64_tr_b16 v[80:81], v172 offset:160
    v_mfma_f32_16x16x32_bf16 v[24:27], v[108:111], v[156:159], v[24:27]
    ds_read_b64_tr_b16 v[82:83], v172 offset:3744
    v_mfma_f32_16x16x32_bf16 v[52:55], v[108:111], v[160:163], v[52:55]
    ds_read_b64_tr_b16 v[84:85], v172 offset:192
    v_mfma_f32_16x16x32_bf16 v[28:31], v[112:115], v[156:159], v[28:31]
    ds_read_b64_tr_b16 v[86:87], v172 offset:3776
    v_mfma_f32_16x16x32_bf16 v[56:59], v[112:115], v[160:163], v[56:59]
    v_add_u32 v172, 7168, v172
    global_load_dwordx4 v[156:159], v183, s[86:87] offset:1024 sc1
    global_load_dwordx4 v[160:163], v183, s[68:69] offset:1024 sc1
    s_waitcnt lgkmcnt(0)
    s_waitcnt vmcnt(12)
    v_mfma_f32_16x16x32_bf16 v[4:7], v[60:63], v[116:119], v[4:7]
    ds_read_b64_tr_b16 v[88:89], v172 offset:0
    ds_read_b64_tr_b16 v[90:91], v172 offset:3584
    v_mfma_f32_16x16x32_bf16 v[32:35], v[60:63], v[120:123], v[32:35]
    ds_read_b64_tr_b16 v[92:93], v172 offset:32
    v_mfma_f32_16x16x32_bf16 v[8:11], v[64:67], v[116:119], v[8:11]
    ds_read_b64_tr_b16 v[94:95], v172 offset:3616
    v_mfma_f32_16x16x32_bf16 v[36:39], v[64:67], v[120:123], v[36:39]
    ds_read_b64_tr_b16 v[96:97], v172 offset:64
    v_mfma_f32_16x16x32_bf16 v[12:15], v[68:71], v[116:119], v[12:15]
    ds_read_b64_tr_b16 v[98:99], v172 offset:3648
    v_mfma_f32_16x16x32_bf16 v[40:43], v[68:71], v[120:123], v[40:43]
    ds_read_b64_tr_b16 v[100:101], v172 offset:96
    v_mfma_f32_16x16x32_bf16 v[16:19], v[72:75], v[116:119], v[16:19]
    ds_read_b64_tr_b16 v[102:103], v172 offset:3680
    v_mfma_f32_16x16x32_bf16 v[44:47], v[72:75], v[120:123], v[44:47]
    ds_read_b64_tr_b16 v[104:105], v172 offset:128
    v_mfma_f32_16x16x32_bf16 v[20:23], v[76:79], v[116:119], v[20:23]
    ds_read_b64_tr_b16 v[106:107], v172 offset:3712
    v_mfma_f32_16x16x32_bf16 v[48:51], v[76:79], v[120:123], v[48:51]
    ds_read_b64_tr_b16 v[108:109], v172 offset:160
    v_mfma_f32_16x16x32_bf16 v[24:27], v[80:83], v[116:119], v[24:27]
    ds_read_b64_tr_b16 v[110:111], v172 offset:3744
    v_mfma_f32_16x16x32_bf16 v[52:55], v[80:83], v[120:123], v[52:55]
    ds_read_b64_tr_b16 v[112:113], v172 offset:192
    v_mfma_f32_16x16x32_bf16 v[28:31], v[84:87], v[116:119], v[28:31]
    ds_read_b64_tr_b16 v[114:115], v172 offset:3776
    v_mfma_f32_16x16x32_bf16 v[56:59], v[84:87], v[120:123], v[56:59]
    v_add_u32 v172, 7168, v172
    global_load_dwordx4 v[116:119], v183, s[86:87] offset:2048 sc1
    global_load_dwordx4 v[120:123], v183, s[68:69] offset:2048 sc1
    s_waitcnt lgkmcnt(0)
    s_waitcnt vmcnt(12)
    v_mfma_f32_16x16x32_bf16 v[4:7], v[88:91], v[124:127], v[4:7]
    ds_read_b64_tr_b16 v[60:61], v172 offset:0
    ds_read_b64_tr_b16 v[62:63], v172 offset:3584
    v_mfma_f32_16x16x32_bf16 v[32:35], v[88:91], v[128:131], v[32:35]
    ds_read_b64_tr_b16 v[64:65], v172 offset:32
    v_mfma_f32_16x16x32_bf16 v[8:11], v[92:95], v[124:127], v[8:11]
    ds_read_b64_tr_b16 v[66:67], v172 offset:3616
    v_mfma_f32_16x16x32_bf16 v[36:39], v[92:95], v[128:131], v[36:39]
    ds_read_b64_tr_b16 v[68:69], v172 offset:64
    ds_read_b64_tr_b16 v[70:71], v172 offset:3648
    v_mfma_f32_16x16x32_bf16 v[12:15], v[96:99], v[124:127], v[12:15]
    ds_read_b64_tr_b16 v[72:73], v172 offset:96
    v_mfma_f32_16x16x32_bf16 v[40:43], v[96:99], v[128:131], v[40:43]
    ds_read_b64_tr_b16 v[74:75], v172 offset:3680
    v_mfma_f32_16x16x32_bf16 v[16:19], v[100:103], v[124:127], v[16:19]
    ds_read_b64_tr_b16 v[76:77], v172 offset:128
    ds_read_b64_tr_b16 v[78:79], v172 offset:3712
    v_mfma_f32_16x16x32_bf16 v[44:47], v[100:103], v[128:131], v[44:47]
    ds_read_b64_tr_b16 v[80:81], v172 offset:160
    v_mfma_f32_16x16x32_bf16 v[20:23], v[104:107], v[124:127], v[20:23]
    ds_read_b64_tr_b16 v[82:83], v172 offset:3744
    v_mfma_f32_16x16x32_bf16 v[48:51], v[104:107], v[128:131], v[48:51]
    ds_read_b64_tr_b16 v[84:85], v172 offset:192
    ds_read_b64_tr_b16 v[86:87], v172 offset:3776
    v_mfma_f32_16x16x32_bf16 v[24:27], v[108:111], v[124:127], v[24:27]
    s_waitcnt vmcnt(6)
    v_xor_b32 v170, s101, v176
    v_xor_b32 v171, s101, v180
    v_or_b32 v170, v170, v171
    v_xor_b32 v171, v176, v177
    v_xor_b32 v171, s29, v171
    v_or_b32 v170, v170, v171
    v_xor_b32 v171, v180, v181
    v_xor_b32 v171, s29, v171
    v_or_b32 v170, v170, v171
    v_cmp_ne_u32 vcc, 0, v170
    s_cbranch_vccnz L_str_95
L_stb_96:
    v_mfma_f32_16x16x32_bf16 v[52:55], v[108:111], v[128:131], v[52:55]
    v_mov_b32 v176, v178
    v_mfma_f32_16x16x32_bf16 v[28:31], v[112:115], v[124:127], v[28:31]
    v_mov_b32 v177, v179
    v_mfma_f32_16x16x32_bf16 v[56:59], v[112:115], v[128:131], v[56:59]
    v_add_u32 v172, 7168, v172
    global_load_dwordx4 v[124:127], v183, s[86:87] offset:3072 sc1
    global_load_dwordx4 v[128:131], v183, s[68:69] offset:3072 sc1
    v_add_u32 v183, 4096, v183
    s_waitcnt lgkmcnt(0)
    v_mfma_f32_16x16x32_bf16 v[4:7], v[60:63], v[132:135], v[4:7]
    ds_read_b64_tr_b16 v[88:89], v172 offset:0
    ds_read_b64_tr_b16 v[90:91], v172 offset:3584
    v_mfma_f32_16x16x32_bf16 v[32:35], v[60:63], v[136:139], v[32:35]
    ds_read_b64_tr_b16 v[92:93], v172 offset:32
    ds_read_b64_tr_b16 v[94:95], v172 offset:3616
    v_mfma_f32_16x16x32_bf16 v[8:11], v[64:67], v[132:135], v[8:11]
    ds_read_b64_tr_b16 v[96:97], v172 offset:64
    ds_read_b64_tr_b16 v[98:99], v172 offset:3648
    v_mfma_f32_16x16x32_bf16 v[36:39], v[64:67], v[136:139], v[36:39]
    ds_read_b64_tr_b16 v[100:101], v172 offset:96
    ds_read_b64_tr_b16 v[102:103], v172 offset:3680
    v_mfma_f32_16x16x32_bf16 v[12:15], v[68:71], v[132:135], v[12:15]
    ds_read_b64_tr_b16 v[104:105], v172 offset:128
    v_mfma_f32_16x16x32_bf16 v[40:43], v[68:71], v[136:139], v[40:43]
    ds_read_b64_tr_b16 v[106:107], v172 offset:3712
    ds_read_b64_tr_b16 v[108:109], v172 offset:160
    v_mfma_f32_16x16x32_bf16 v[16:19], v[72:75], v[132:135], v[16:19]
    ds_read_b64_tr_b16 v[110:111], v172 offset:3744
    ds_read_b64_tr_b16 v[112:113], v172 offset:192
    v_mfma_f32_16x16x32_bf16 v[44:47], v[72:75], v[136:139], v[44:47]
    ds_read_b64_tr_b16 v[114:115], v172 offset:3776
    v_add_f32 v178, v174, v176
    v_mfma_f32_16x16x32_bf16 v[20:23], v[76:79], v[132:135], v[20:23]
    v_mov_b32 v179, v178
    v_mfma_f32_16x16x32_bf16 v[48:51], v[76:79], v[136:139], v[48:51]
    s_nop 0
    v_permlane16_swap_b32 v178, v179
    v_add_f32 v178, v178, v179
    v_mfma_f32_16x16x32_bf16 v[24:27], v[80:83], v[132:135], v[24:27]
    v_mov_b32 v179, v178
    s_nop 1
    v_permlane32_swap_b32 v178, v179
    v_mfma_f32_16x16x32_bf16 v[52:55], v[80:83], v[136:139], v[52:55]
    v_add_f32 v178, v178, v179
    v_mul_f32 v178, 0x3e000000, v178
    v_mfma_f32_16x16x32_bf16 v[28:31], v[84:87], v[132:135], v[28:31]
    v_sub_f32 v174, v174, v178
    v_mfma_f32_16x16x32_bf16 v[56:59], v[84:87], v[136:139], v[56:59]
    v_add_u32 v172, 7168, v172
    s_waitcnt lgkmcnt(0)
    v_mfma_f32_16x16x32_bf16 v[4:7], v[88:91], v[140:143], v[4:7]
    ds_read_b64_tr_b16 v[60:61], v172 offset:0
    ds_read_b64_tr_b16 v[62:63], v172 offset:3584
    v_mfma_f32_16x16x32_bf16 v[32:35], v[88:91], v[144:147], v[32:35]
    ds_read_b64_tr_b16 v[64:65], v172 offset:32
    ds_read_b64_tr_b16 v[66:67], v172 offset:3616
    v_mfma_f32_16x16x32_bf16 v[8:11], v[92:95], v[140:143], v[8:11]
    ds_read_b64_tr_b16 v[68:69], v172 offset:64
    ds_read_b64_tr_b16 v[70:71], v172 offset:3648
    v_mfma_f32_16x16x32_bf16 v[36:39], v[92:95], v[144:147], v[36:39]
    ds_read_b64_tr_b16 v[72:73], v172 offset:96
    ds_read_b64_tr_b16 v[74:75], v172 offset:3680
    v_mfma_f32_16x16x32_bf16 v[12:15], v[96:99], v[140:143], v[12:15]
    ds_read_b64_tr_b16 v[76:77], v172 offset:128
    v_mfma_f32_16x16x32_bf16 v[40:43], v[96:99], v[144:147], v[40:43]
    ds_read_b64_tr_b16 v[78:79], v172 offset:3712
    ds_read_b64_tr_b16 v[80:81], v172 offset:160
    v_mfma_f32_16x16x32_bf16 v[16:19], v[100:103], v[140:143], v[16:19]
    ds_read_b64_tr_b16 v[82:83], v172 offset:3744
    ds_read_b64_tr_b16 v[84:85], v172 offset:192
    v_mfma_f32_16x16x32_bf16 v[44:47], v[100:103], v[144:147], v[44:47]
    ds_read_b64_tr_b16 v[86:87], v172 offset:3776
    v_sub_f32 v176, v176, v178
    v_mfma_f32_16x16x32_bf16 v[20:23], v[104:107], v[140:143], v[20:23]
    v_mul_f32 v174, v174, v174
    v_mfma_f32_16x16x32_bf16 v[48:51], v[104:107], v[144:147], v[48:51]
    v_fmac_f32 v174, v176, v176
    v_add_f32 v175, v175, v177
    v_mfma_f32_16x16x32_bf16 v[24:27], v[108:111], v[140:143], v[24:27]
    v_mov_b32 v179, 0x42a00000
    v_fmac_f32 v175, v174, v179
    v_mfma_f32_16x16x32_bf16 v[52:55], v[108:111], v[144:147], v[52:55]
    v_mov_b32 v179, v175
    s_nop 1
    v_permlane16_swap_b32 v175, v179
    v_mfma_f32_16x16x32_bf16 v[28:31], v[112:115], v[140:143], v[28:31]
    v_add_f32 v175, v175, v179
    v_mfma_f32_16x16x32_bf16 v[56:59], v[112:115], v[144:147], v[56:59]
    v_add_u32 v172, 7168, v172
    s_waitcnt lgkmcnt(0)
    s_waitcnt vmcnt(6)
    v_mfma_f32_16x16x32_bf16 v[4:7], v[60:63], v[148:151], v[4:7]
    ds_read_b64_tr_b16 v[88:89], v172 offset:0
    ds_read_b64_tr_b16 v[90:91], v172 offset:3584
    v_mfma_f32_16x16x32_bf16 v[32:35], v[60:63], v[152:155], v[32:35]
    ds_read_b64_tr_b16 v[92:93], v172 offset:32
    ds_read_b64_tr_b16 v[94:95], v172 offset:3616
    v_mfma_f32_16x16x32_bf16 v[8:11], v[64:67], v[148:151], v[8:11]
    ds_read_b64_tr_b16 v[96:97], v172 offset:64
    ds_read_b64_tr_b16 v[98:99], v172 offset:3648
    v_mfma_f32_16x16x32_bf16 v[36:39], v[64:67], v[152:155], v[36:39]
    ds_read_b64_tr_b16 v[100:101], v172 offset:96
    ds_read_b64_tr_b16 v[102:103], v172 offset:3680
    v_mfma_f32_16x16x32_bf16 v[12:15], v[68:71], v[148:151], v[12:15]
    ds_read_b64_tr_b16 v[104:105], v172 offset:128
    v_mfma_f32_16x16x32_bf16 v[40:43], v[68:71], v[152:155], v[40:43]
    ds_read_b64_tr_b16 v[106:107], v172 offset:3712
    ds_read_b64_tr_b16 v[108:109], v172 offset:160
    v_mfma_f32_16x16x32_bf16 v[16:19], v[72:75], v[148:151], v[16:19]
    ds_read_b64_tr_b16 v[110:111], v172 offset:3744
    ds_read_b64_tr_b16 v[112:113], v172 offset:192
    v_mfma_f32_16x16x32_bf16 v[44:47], v[72:75], v[152:155], v[44:47]
    ds_read_b64_tr_b16 v[114:115], v172 offset:3776
    v_mov_b32 v179, v175
    v_mfma_f32_16x16x32_bf16 v[20:23], v[76:79], v[148:151], v[20:23]
    s_nop 0
    v_permlane32_swap_b32 v175, v179
    v_mfma_f32_16x16x32_bf16 v[48:51], v[76:79], v[152:155], v[48:51]
    v_add_f32 v175, v175, v179
    v_mul_f32 v175, 0x3acccccd, v175
    v_mfma_f32_16x16x32_bf16 v[24:27], v[80:83], v[148:151], v[24:27]
    v_cvt_pk_bf16_f32 v179, v175, v175
    v_lshlrev_b32 v175, 16, v179
    v_mfma_f32_16x16x32_bf16 v[52:55], v[80:83], v[152:155], v[52:55]
    v_add_f32 v175, 0x3727c5ac, v175
    v_cvt_pk_bf16_f32 v179, v175, v175
    v_mfma_f32_16x16x32_bf16 v[28:31], v[84:87], v[148:151], v[28:31]
    v_lshlrev_b32 v175, 16, v179
    v_mfma_f32_16x16x32_bf16 v[56:59], v[84:87], v[152:155], v[56:59]
    v_add_u32 v172, 7168, v172
    s_waitcnt lgkmcnt(0)
    s_waitcnt vmcnt(4)
    v_mfma_f32_16x16x32_bf16 v[4:7], v[88:91], v[156:159], v[4:7]
    ds_read_b64_tr_b16 v[60:61], v172 offset:0
    ds_read_b64_tr_b16 v[62:63], v172 offset:3584
    v_mfma_f32_16x16x32_bf16 v[32:35], v[88:91], v[160:163], v[32:35]
    ds_read_b64_tr_b16 v[64:65], v172 offset:32
    ds_read_b64_tr_b16 v[66:67], v172 offset:3616
    v_mfma_f32_16x16x32_bf16 v[8:11], v[92:95], v[156:159], v[8:11]
    ds_read_b64_tr_b16 v[68:69], v172 offset:64
    ds_read_b64_tr_b16 v[70:71], v172 offset:3648
    v_mfma_f32_16x16x32_bf16 v[36:39], v[92:95], v[160:163], v[36:39]
    ds_read_b64_tr_b16 v[72:73], v172 offset:96
    v_mfma_f32_16x16x32_bf16 v[12:15], v[96:99], v[156:159], v[12:15]
    ds_read_b64_tr_b16 v[74:75], v172 offset:3680
    ds_read_b64_tr_b16 v[76:77], v172 offset:128
    v_mfma_f32_16x16x32_bf16 v[40:43], v[96:99], v[160:163], v[40:43]
    ds_read_b64_tr_b16 v[78:79], v172 offset:3712
    ds_read_b64_tr_b16 v[80:81], v172 offset:160
    v_mfma_f32_16x16x32_bf16 v[16:19], v[100:103], v[156:159], v[16:19]
    ds_read_b64_tr_b16 v[82:83], v172 offset:3744
    v_mfma_f32_16x16x32_bf16 v[44:47], v[100:103], v[160:163], v[44:47]
    ds_read_b64_tr_b16 v[84:85], v172 offset:192
    ds_read_b64_tr_b16 v[86:87], v172 offset:3776
    v_mfma_f32_16x16x32_bf16 v[20:23], v[104:107], v[156:159], v[20:23]
    v_sqrt_f32 v175, v175
    s_nop 0
    v_mfma_f32_16x16x32_bf16 v[48:51], v[104:107], v[160:163], v[48:51]
    v_cvt_pk_bf16_f32 v179, v175, v175
    v_mfma_f32_16x16x32_bf16 v[24:27], v[108:111], v[156:159], v[24:27]
    v_lshlrev_b32 v175, 16, v179
    v_rcp_f32 v167, v175
    v_mfma_f32_16x16x32_bf16 v[52:55], v[108:111], v[160:163], v[52:55]
    v_cvt_pk_bf16_f32 v179, v178, v178
    v_lshlrev_b32 v178, 16, v179
    v_mfma_f32_16x16x32_bf16 v[28:31], v[112:115], v[156:159], v[28:31]
    v_mov_b32 v166, v178
    v_mfma_f32_16x16x32_bf16 v[56:59], v[112:115], v[160:163], v[56:59]
    v_add_u32 v172, 7168, v172
    s_waitcnt lgkmcnt(0)
    s_waitcnt vmcnt(2)
    v_mfma_f32_16x16x32_bf16 v[4:7], v[60:63], v[116:119], v[4:7]
    ds_read_b64_tr_b16 v[88:89], v172 offset:0
    ds_read_b64_tr_b16 v[90:91], v172 offset:3584
    v_mfma_f32_16x16x32_bf16 v[32:35], v[60:63], v[120:123], v[32:35]
    ds_read_b64_tr_b16 v[92:93], v172 offset:32
    v_mfma_f32_16x16x32_bf16 v[8:11], v[64:67], v[116:119], v[8:11]
    ds_read_b64_tr_b16 v[94:95], v172 offset:3616
    v_mfma_f32_16x16x32_bf16 v[36:39], v[64:67], v[120:123], v[36:39]
    ds_read_b64_tr_b16 v[96:97], v172 offset:64
    v_mfma_f32_16x16x32_bf16 v[12:15], v[68:71], v[116:119], v[12:15]
    ds_read_b64_tr_b16 v[98:99], v172 offset:3648
    v_mfma_f32_16x16x32_bf16 v[40:43], v[68:71], v[120:123], v[40:43]
    ds_read_b64_tr_b16 v[100:101], v172 offset:96
    v_mfma_f32_16x16x32_bf16 v[16:19], v[72:75], v[116:119], v[16:19]
    ds_read_b64_tr_b16 v[102:103], v172 offset:3680
    v_mfma_f32_16x16x32_bf16 v[44:47], v[72:75], v[120:123], v[44:47]
    ds_read_b64_tr_b16 v[104:105], v172 offset:128
    v_mfma_f32_16x16x32_bf16 v[20:23], v[76:79], v[116:119], v[20:23]
    ds_read_b64_tr_b16 v[106:107], v172 offset:3712
    v_mfma_f32_16x16x32_bf16 v[48:51], v[76:79], v[120:123], v[48:51]
    ds_read_b64_tr_b16 v[108:109], v172 offset:160
    v_mfma_f32_16x16x32_bf16 v[24:27], v[80:83], v[116:119], v[24:27]
    ds_read_b64_tr_b16 v[110:111], v172 offset:3744
    v_mfma_f32_16x16x32_bf16 v[52:55], v[80:83], v[120:123], v[52:55]
    ds_read_b64_tr_b16 v[112:113], v172 offset:192
    v_mfma_f32_16x16x32_bf16 v[28:31], v[84:87], v[116:119], v[28:31]
    ds_read_b64_tr_b16 v[114:115], v172 offset:3776
    v_mfma_f32_16x16x32_bf16 v[56:59], v[84:87], v[120:123], v[56:59]
    v_add_u32 v172, 7168, v172
    s_waitcnt lgkmcnt(0)
    s_waitcnt vmcnt(0)
    v_mfma_f32_16x16x32_bf16 v[4:7], v[88:91], v[124:127], v[4:7]
    v_mfma_f32_16x16x32_bf16 v[32:35], v[88:91], v[128:131], v[32:35]
    v_mfma_f32_16x16x32_bf16 v[8:11], v[92:95], v[124:127], v[8:11]
    v_mfma_f32_16x16x32_bf16 v[36:39], v[92:95], v[128:131], v[36:39]
    v_mfma_f32_16x16x32_bf16 v[12:15], v[96:99], v[124:127], v[12:15]
    v_mfma_f32_16x16x32_bf16 v[40:43], v[96:99], v[128:131], v[40:43]
    v_mfma_f32_16x16x32_bf16 v[16:19], v[100:103], v[124:127], v[16:19]
    v_mfma_f32_16x16x32_bf16 v[44:47], v[100:103], v[128:131], v[44:47]
    v_mfma_f32_16x16x32_bf16 v[20:23], v[104:107], v[124:127], v[20:23]
    v_mfma_f32_16x16x32_bf16 v[48:51], v[104:107], v[128:131], v[48:51]
    v_mfma_f32_16x16x32_bf16 v[24:27], v[108:111], v[124:127], v[24:27]
    v_mfma_f32_16x16x32_bf16 v[52:55], v[108:111], v[128:131], v[52:55]
    v_mfma_f32_16x16x32_bf16 v[28:31], v[112:115], v[124:127], v[28:31]
    v_mfma_f32_16x16x32_bf16 v[56:59], v[112:115], v[128:131], v[56:59]
    s_mov_b32 s27, 0
    s_nop 6
    s_call_b64 s[30:31], L_g1epi
    s_branch L_stx_97
L_str_93:
    s_mov_b32 s71, 400000
L_sti_98:
    global_load_dwordx4 v[174:177], v169, s[38:39] offset:0 sc1
    global_load_dwordx4 v[178:181], v169, s[38:39] offset:16 sc1
    s_sub_u32 s71, s71, 1
    s_cmp_eq_u32 s71, 0
    s_cbranch_scc1 L_abort
    s_waitcnt vmcnt(0)
    v_xor_b32 v170, s101, v176
    v_xor_b32 v171, s101, v180
    v_or_b32 v170, v170, v171
    v_xor_b32 v171, v176, v177
    v_xor_b32 v171, s29, v171
    v_or_b32 v170, v170, v171
    v_xor_b32 v171, v180, v181
    v_xor_b32 v171, s29, v171
    v_or_b32 v170, v170, v171
    v_cmp_ne_u32 vcc, 0, v170
    s_nop 4
    s_cbranch_vccnz L_sti_98
    s_branch L_stb_94
L_str_95:
    s_mov_b32 s71, 400000
L_sti_99:
    global_load_dwordx4 v[174:177], v169, s[38:39] offset:2048 sc1
    global_load_dwordx4 v[178:181], v169, s[38:39] offset:2064 sc1
    s_sub_u32 s71, s71, 1
    s_cmp_eq_u32 s71, 0
    s_cbranch_scc1 L_abort
    s_waitcnt vmcnt(0)
    v_xor_b32 v170, s101, v176
    v_xor_b32 v171, s101, v180
    v_or_b32 v170, v170, v171
    v_xor_b32 v171, v176, v177
    v_xor_b32 v171, s29, v171
    v_or_b32 v170, v170, v171
    v_xor_b32 v171, v180, v181
    v_xor_b32 v171, s29, v171
    v_or_b32 v170, v170, v171
    v_cmp_ne_u32 vcc, 0, v170
    s_nop 4
    s_cbranch_vccnz L_sti_99
    s_branch L_stb_96
L_stx_97:
    s_waitcnt vmcnt(0) lgkmcnt(0)
    s_barrier
    s_cmp_lg_u32 s6, 0
    s_cbranch_scc1 L_iw_100
    s_lshl_b32 s50, s5, 3
    s_add_u32 s3, s28, 6
    v_mov_b32 v176, s3
    s_xor_b32 s3, s3, s29
    v_mov_b32 v177, s3
    v_mov_b32 v178, s50
    s_mov_b64 s[92:93], exec
    s_mov_b64 exec, 1
    s_cmp_eq_u32 s7, 0
    s_cbranch_scc0 L_slow_101
    global_store_dwordx2 v178, v[176:177], s[64:65]
    s_branch L_sd_102
L_slow_101:
    global_store_dwordx2 v178, v[176:177], s[64:65] sc0 sc1
L_sd_102:
    s_mov_b64 exec, s[92:93]
L_iw_100:
    s_mul_i32 s3, s6, 14
    s_add_u32 s3, s3, 0
    s_min_u32 s3, s3, 53
    s_lshl_b32 s72, s3, 10
    s_mul_i32 s3, s6, 14
    s_add_u32 s3, s3, 1
    s_min_u32 s3, s3, 53
    s_lshl_b32 s73, s3, 10
    s_mul_i32 s3, s6, 14
    s_add_u32 s3, s3, 2
    s_min_u32 s3, s3, 53
    s_lshl_b32 s74, s3, 10
    s_mul_i32 s3, s6, 14
    s_add_u32 s3, s3, 3
    s_min_u32 s3, s3, 53
    s_lshl_b32 s75, s3, 10
    s_mul_i32 s3, s6, 14
    s_add_u32 s3, s3, 4
    s_min_u32 s3, s3, 53
    s_lshl_b32 s76, s3, 10
    s_mul_i32 s3, s6, 14
    s_add_u32 s3, s3, 5
    s_min_u32 s3, s3, 53
    s_lshl_b32 s77, s3, 10
    s_mul_i32 s3, s6, 14
    s_add_u32 s3, s3, 6
    s_min_u32 s3, s3, 53
    s_lshl_b32 s78, s3, 10
    s_mul_i32 s3, s6, 14
    s_add_u32 s3, s3, 7
    s_min_u32 s3, s3, 53
    s_lshl_b32 s79, s3, 10
    s_mul_i32 s3, s6, 14
    s_add_u32 s3, s3, 8
    s_min_u32 s3, s3, 53
    s_lshl_b32 s80, s3, 10
    s_mul_i32 s3, s6, 14
    s_add_u32 s3, s3, 9
    s_min_u32 s3, s3, 53
    s_lshl_b32 s81, s3, 10
    s_mul_i32 s3, s6, 14
    s_add_u32 s3, s3, 10
    s_min_u32 s3, s3, 53
    s_lshl_b32 s82, s3, 10
    s_mul_i32 s3, s6, 14
    s_add_u32 s3, s3, 11
    s_min_u32 s3, s3, 53
    s_lshl_b32 s83, s3, 10
    s_mul_i32 s3, s6, 14
    s_add_u32 s3, s3, 12
    s_min_u32 s3, s3, 53
    s_lshl_b32 s84, s3, 10
    s_mul_i32 s3, s6, 14
    s_add_u32 s3, s3, 13
    s_min_u32 s3, s3, 53
    s_lshl_b32 s85, s3, 10
    s_add_u32 s8, s38, 0
    s_addc_u32 s9, s39, 0
    s_and_b32 s9, s9, 0xffff
    s_mov_b32 s10, 268435456
    s_mov_b32 s11, 0x20000
    s_add_u32 s3, s6, 1
    s_and_b32 s3, s3, 3
    s_mul_i32 s51, s3, 5120
    s_lshl_b32 s50, s4, 4
    s_add_u32 s3, s3, s50
    s_lshl_b32 s50, s40, 2
    s_add_u32 s3, s3, s50
    s_mul_i32 s3, s3, 55296
    s_add_u32 s3, s3, s96
    v_lshlrev_b32 v100, 4, v1
    v_add_u32 v100, s3, v100
    v_lshlrev_b32 v104, 4, v1
    s_add_u32 s3, s51, 143360
    v_add_u32 v104, s3, v104
    s_add_u32 s3, s6, 2
    s_and_b32 s3, s3, 3
    s_mul_i32 s51, s3, 5120
    s_lshl_b32 s50, s4, 4
    s_add_u32 s3, s3, s50
    s_lshl_b32 s50, s40, 2
    s_add_u32 s3, s3, s50
    s_mul_i32 s3, s3, 55296
    s_add_u32 s3, s3, s96
    v_lshlrev_b32 v101, 4, v1
    v_add_u32 v101, s3, v101
    v_lshlrev_b32 v105, 4, v1
    s_add_u32 s3, s51, 143360
    v_add_u32 v105, s3, v105
    s_add_u32 s3, s6, 3
    s_and_b32 s3, s3, 3
    s_mul_i32 s51, s3, 5120
    s_lshl_b32 s50, s4, 4
    s_add_u32 s3, s3, s50
    s_lshl_b32 s50, s40, 2
    s_add_u32 s3, s3, s50
    s_mul_i32 s3, s3, 55296
    s_add_u32 s3, s3, s96
    v_lshlrev_b32 v102, 4, v1
    v_add_u32 v102, s3, v102
    v_lshlrev_b32 v106, 4, v1
    s_add_u32 s3, s51, 143360
    v_add_u32 v106, s3, v106
    s_add_u32 s3, s6, 4
    s_and_b32 s3, s3, 3
    s_mul_i32 s51, s3, 5120
    s_lshl_b32 s50, s4, 4
    s_add_u32 s3, s3, s50
    s_lshl_b32 s50, s40, 2
    s_add_u32 s3, s3, s50
    s_mul_i32 s3, s3, 55296
    s_add_u32 s3, s3, s96
    v_lshlrev_b32 v103, 4, v1
    v_add_u32 v103, s3, v103
    v_lshlrev_b32 v107, 4, v1
    s_add_u32 s3, s51, 143360
    v_add_u32 v107, s3, v107
    s_cmp_lg_u32 s6, 0
    s_nop 0
    s_cbranch_scc1 L_iw_103
    v_and_b32 v180, 31, v1
    v_lshlrev_b32 v180, 3, v180
    s_add_u32 s55, s28, 6
    s_mov_b32 s71, 400000
L_poll_104:
    global_load_dwordx2 v[176:177], v180, s[64:65] sc1
    s_sub_u32 s71, s71, 1
    s_cmp_eq_u32 s71, 0
    s_cbranch_scc1 L_abort
    s_waitcnt vmcnt(0)
    v_subrev_u32 v178, s55, v176
    v_cmp_lt_u32 vcc, 1, v178
    v_xor_b32 v178, v176, v177
    v_cmp_ne_u32 s[88:89], s29, v178
    s_or_b64 s[88:89], vcc, s[88:89]
    s_nop 3
    s_cbranch_scc1 L_poll_104
L_iw_103:
    s_barrier
    buffer_load_dwordx4 v[44:47], v100, s[8:11], s72 offen sc1
    buffer_load_dwordx4 v[48:51], v100, s[8:11], s73 offen sc1
    buffer_load_dwordx4 v[52:55], v100, s[8:11], s74 offen sc1
    buffer_load_dwordx4 v[56:59], v100, s[8:11], s75 offen sc1
    buffer_load_dwordx4 v[60:63], v100, s[8:11], s76 offen sc1
    buffer_load_dwordx4 v[64:67], v100, s[8:11], s77 offen sc1
    buffer_load_dwordx4 v[68:71], v100, s[8:11], s78 offen sc1
    buffer_load_dwordx4 v[72:75], v100, s[8:11], s79 offen sc1
    buffer_load_dwordx4 v[76:79], v100, s[8:11], s80 offen sc1
    buffer_load_dwordx4 v[80:83], v100, s[8:11], s81 offen sc1
    buffer_load_dwordx4 v[84:87], v100, s[8:11], s82 offen sc1
    buffer_load_dwordx4 v[88:91], v100, s[8:11], s83 offen sc1
    buffer_load_dwordx4 v[92:95], v100, s[8:11], s84 offen sc1
    buffer_load_dwordx4 v[96:99], v100, s[8:11], s85 offen sc1
    s_waitcnt vmcnt(13)
    v_mfma_f32_16x16x32_bf16 v[4:7], a[0:3], v[44:47], 0
    v_lshlrev_b32 v150, 16, v222
    v_mfma_f32_16x16x32_bf16 v[8:11], a[4:7], v[44:47], 0
    v_and_b32 v151, s45, v222
    v_mfma_f32_16x16x32_bf16 v[12:15], a[8:11], v[44:47], 0
    v_lshlrev_b32 v152, 16, v223
    v_mfma_f32_16x16x32_bf16 v[16:19], a[12:15], v[44:47], 0
    v_and_b32 v153, s45, v223
    v_mfma_f32_16x16x32_bf16 v[20:23], a[16:19], v[44:47], 0
    v_lshlrev_b32 v154, 16, v224
    buffer_load_dwordx4 v[44:47], v101, s[8:11], s72 offen sc1
    s_waitcnt vmcnt(13)
    v_mfma_f32_16x16x32_bf16 v[4:7], a[20:23], v[48:51], v[4:7]
    v_and_b32 v155, s45, v224
    v_mfma_f32_16x16x32_bf16 v[8:11], a[24:27], v[48:51], v[8:11]
    v_lshlrev_b32 v156, 16, v225
    v_mfma_f32_16x16x32_bf16 v[12:15], a[28:31], v[48:51], v[12:15]
    v_and_b32 v157, s45, v225
    v_mfma_f32_16x16x32_bf16 v[16:19], a[32:35], v[48:51], v[16:19]
    v_lshlrev_b32 v158, 16, v226
    v_mfma_f32_16x16x32_bf16 v[20:23], a[36:39], v[48:51], v[20:23]
    v_and_b32 v159, s45, v226
    buffer_load_dwordx4 v[48:51], v101, s[8:11], s73 offen sc1
    s_waitcnt vmcnt(13)
    v_mfma_f32_16x16x32_bf16 v[4:7], a[40:43], v[52:55], v[4:7]
    v_lshlrev_b32 v160, 16, v227
    v_mfma_f32_16x16x32_bf16 v[8:11], a[44:47], v[52:55], v[8:11]
    v_and_b32 v161, s45, v227
    v_mfma_f32_16x16x32_bf16 v[12:15], a[48:51], v[52:55], v[12:15]
    v_lshlrev_b32 v162, 16, v228
    v_mfma_f32_16x16x32_bf16 v[16:19], a[52:55], v[52:55], v[16:19]
    v_and_b32 v163, s45, v228
    v_mfma_f32_16x16x32_bf16 v[20:23], a[56:59], v[52:55], v[20:23]
    v_lshlrev_b32 v164, 16, v229
    buffer_load_dwordx4 v[52:55], v101, s[8:11], s74 offen sc1
    s_waitcnt vmcnt(13)
    v_mfma_f32_16x16x32_bf16 v[4:7], a[60:63], v[56:59], v[4:7]
    v_and_b32 v165, s45, v229
    v_mfma_f32_16x16x32_bf16 v[8:11], a[64:67], v[56:59], v[8:11]
    v_lshlrev_b32 v166, 16, v230
    v_mfma_f32_16x16x32_bf16 v[12:15], a[68:71], v[56:59], v[12:15]
    v_and_b32 v167, s45, v230
    v_mfma_f32_16x16x32_bf16 v[16:19], a[72:75], v[56:59], v[16:19]
    v_lshlrev_b32 v168, 16, v231
    v_mfma_f32_16x16x32_bf16 v[20:23], a[76:79], v[56:59], v[20:23]
    v_and_b32 v169, s45, v231
    buffer_load_dwordx4 v[56:59], v101, s[8:11], s75 offen sc1
    s_waitcnt vmcnt(13)
    v_mfma_f32_16x16x32_bf16 v[4:7], a[80:83], v[60:63], v[4:7]
    s_lshl_b32 s97, s4, 8
    v_mfma_f32_16x16x32_bf16 v[8:11], a[84:87], v[60:63], v[8:11]
    s_lshl_b32 s100, s40, 6
    v_mfma_f32_16x16x32_bf16 v[12:15], a[88:91], v[60:63], v[12:15]
    s_add_u32 s97, s97, s100
    v_mfma_f32_16x16x32_bf16 v[16:19], a[92:95], v[60:63], v[16:19]
    s_lshl_b32 s100, s6, 4
    v_mfma_f32_16x16x32_bf16 v[20:23], a[96:99], v[60:63], v[20:23]
    s_add_u32 s97, s97, s100
    buffer_load_dwordx4 v[60:63], v101, s[8:11], s76 offen sc1
    s_waitcnt vmcnt(13)
    v_mfma_f32_16x16x32_bf16 v[4:7], a[100:103], v[64:67], v[4:7]
    v_add_u32 v170, s97, v2
    v_mfma_f32_16x16x32_bf16 v[8:11], a[104:107], v[64:67], v[8:11]
    v_mul_u32_u24 v170, 1280, v170
    v_mfma_f32_16x16x32_bf16 v[12:15], a[108:111], v[64:67], v[12:15]
    s_mul_i32 s97, s41, 160
    v_mfma_f32_16x16x32_bf16 v[16:19], a[112:115], v[64:67], v[16:19]
    v_lshlrev_b32 v171, 3, v3
    v_mfma_f32_16x16x32_bf16 v[20:23], a[116:119], v[64:67], v[20:23]
    v_add3_u32 v170, v170, v171, s97
    buffer_load_dwordx4 v[64:67], v101, s[8:11], s77 offen sc1
    s_waitcnt vmcnt(13)
    v_mfma_f32_16x16x32_bf16 v[4:7], a[120:123], v[68:71], v[4:7]
    v_mfma_f32_16x16x32_bf16 v[8:11], a[124:127], v[68:71], v[8:11]
    v_mfma_f32_16x16x32_bf16 v[12:15], a[128:131], v[68:71], v[12:15]
    v_mfma_f32_16x16x32_bf16 v[16:19], a[132:135], v[68:71], v[16:19]
    v_mfma_f32_16x16x32_bf16 v[20:23], a[136:139], v[68:71], v[20:23]
    buffer_load_dwordx4 v[68:71], v101, s[8:11], s78 offen sc1
    s_waitcnt vmcnt(13)
    v_mfma_f32_16x16x32_bf16 v[4:7], a[140:143], v[72:75], v[4:7]
    v_mfma_f32_16x16x32_bf16 v[8:11], a[144:147], v[72:75], v[8:11]
    v_mfma_f32_16x16x32_bf16 v[12:15], a[148:151], v[72:75], v[12:15]
    v_mfma_f32_16x16x32_bf16 v[16:19], a[152:155], v[72:75], v[16:19]
    v_mfma_f32_16x16x32_bf16 v[20:23], a[156:159], v[72:75], v[20:23]
    buffer_load_dwordx4 v[72:75], v101, s[8:11], s79 offen sc1
    s_waitcnt vmcnt(13)
    v_mfma_f32_16x16x32_bf16 v[4:7], a[160:163], v[76:79], v[4:7]
    v_mfma_f32_16x16x32_bf16 v[8:11], a[164:167], v[76:79], v[8:11]
    v_mfma_f32_16x16x32_bf16 v[12:15], a[168:171], v[76:79], v[12:15]
    v_mfma_f32_16x16x32_bf16 v[16:19], a[172:175], v[76:79], v[16:19]
    v_mfma_f32_16x16x32_bf16 v[20:23], a[176:179], v[76:79], v[20:23]
    buffer_load_dwordx4 v[76:79], v101, s[8:11], s80 offen sc1
    s_waitcnt vmcnt(13)
    v_mfma_f32_16x16x32_bf16 v[4:7], a[180:183], v[80:83], v[4:7]
    v_mfma_f32_16x16x32_bf16 v[8:11], a[184:187], v[80:83], v[8:11]
    v_mfma_f32_16x16x32_bf16 v[12:15], a[188:191], v[80:83], v[12:15]
    v_mfma_f32_16x16x32_bf16 v[16:19], a[192:195], v[80:83], v[16:19]
    v_mfma_f32_16x16x32_bf16 v[20:23], a[196:199], v[80:83], v[20:23]
    buffer_load_dwordx4 v[80:83], v101, s[8:11], s81 offen sc1
    s_waitcnt vmcnt(13)
    v_mfma_f32_16x16x32_bf16 v[4:7], a[200:203], v[84:87], v[4:7]
    v_mfma_f32_16x16x32_bf16 v[8:11], a[204:207], v[84:87], v[8:11]
    v_mfma_f32_16x16x32_bf16 v[12:15], a[208:211], v[84:87], v[12:15]
    v_mfma_f32_16x16x32_bf16 v[16:19], a[212:215], v[84:87], v[16:19]
    v_mfma_f32_16x16x32_bf16 v[20:23], a[216:219], v[84:87], v[20:23]
    buffer_load_dwordx4 v[84:87], v101, s[8:11], s82 offen sc1
    s_waitcnt vmcnt(13)
    v_mfma_f32_16x16x32_bf16 v[4:7], a[220:223], v[88:91], v[4:7]
    v_mfma_f32_16x16x32_bf16 v[8:11], a[224:227], v[88:91], v[8:11]
    v_mfma_f32_16x16x32_bf16 v[12:15], a[228:231], v[88:91], v[12:15]
    v_mfma_f32_16x16x32_bf16 v[16:19], a[232:235], v[88:91], v[16:19]
    v_mfma_f32_16x16x32_bf16 v[20:23], a[236:239], v[88:91], v[20:23]
    buffer_load_dwordx4 v[88:91], v101, s[8:11], s83 offen sc1
    s_waitcnt vmcnt(13)
    v_mfma_f32_16x16x32_bf16 v[4:7], a[240:243], v[92:95], v[4:7]
    v_mfma_f32_16x16x32_bf16 v[8:11], a[244:247], v[92:95], v[8:11]
    v_mfma_f32_16x16x32_bf16 v[12:15], a[248:251], v[92:95], v[12:15]
    v_mfma_f32_16x16x32_bf16 v[16:19], a[252:255], v[92:95], v[16:19]
    v_mfma_f32_16x16x32_bf16 v[20:23], v[232:235], v[92:95], v[20:23]
    buffer_load_dwordx4 v[92:95], v101, s[8:11], s84 offen sc1
    s_waitcnt vmcnt(13)
    v_mfma_f32_16x16x32_bf16 v[4:7], v[236:239], v[96:99], v[4:7]
    v_mfma_f32_16x16x32_bf16 v[8:11], v[240:243], v[96:99], v[8:11]
    v_mfma_f32_16x16x32_bf16 v[12:15], v[244:247], v[96:99], v[12:15]
    v_mfma_f32_16x16x32_bf16 v[16:19], v[248:251], v[96:99], v[16:19]
    v_mfma_f32_16x16x32_bf16 v[20:23], v[252:255], v[96:99], v[20:23]
    buffer_load_dwordx4 v[96:99], v101, s[8:11], s85 offen sc1
    s_waitcnt vmcnt(13)
    v_mfma_f32_16x16x32_bf16 v[24:27], a[0:3], v[44:47], 0
    v_mfma_f32_16x16x32_bf16 v[28:31], a[4:7], v[44:47], 0
    v_mfma_f32_16x16x32_bf16 v[32:35], a[8:11], v[44:47], 0
    v_mfma_f32_16x16x32_bf16 v[36:39], a[12:15], v[44:47], 0
    v_mfma_f32_16x16x32_bf16 v[40:43], a[16:19], v[44:47], 0
    buffer_load_dwordx4 v[44:47], v102, s[8:11], s72 offen sc1
    s_waitcnt vmcnt(13)
    v_mfma_f32_16x16x32_bf16 v[24:27], a[20:23], v[48:51], v[24:27]
    v_mfma_f32_16x16x32_bf16 v[28:31], a[24:27], v[48:51], v[28:31]
    v_mfma_f32_16x16x32_bf16 v[32:35], a[28:31], v[48:51], v[32:35]
    ds_write_b128 v104, v[4:7] offset:0
    v_mfma_f32_16x16x32_bf16 v[36:39], a[32:35], v[48:51], v[36:39]
    v_mfma_f32_16x16x32_bf16 v[40:43], a[36:39], v[48:51], v[40:43]
    buffer_load_dwordx4 v[48:51], v102, s[8:11], s73 offen sc1
    s_waitcnt vmcnt(13)
    v_mfma_f32_16x16x32_bf16 v[24:27], a[40:43], v[52:55], v[24:27]
    v_mfma_f32_16x16x32_bf16 v[28:31], a[44:47], v[52:55], v[28:31]
    v_mfma_f32_16x16x32_bf16 v[32:35], a[48:51], v[52:55], v[32:35]
    ds_write_b128 v104, v[8:11] offset:1024
    v_mfma_f32_16x16x32_bf16 v[36:39], a[52:55], v[52:55], v[36:39]
    v_mfma_f32_16x16x32_bf16 v[40:43], a[56:59], v[52:55], v[40:43]
    buffer_load_dwordx4 v[52:55], v102, s[8:11], s74 offen sc1
    s_waitcnt vmcnt(13)
    v_mfma_f32_16x16x32_bf16 v[24:27], a[60:63], v[56:59], v[24:27]
    v_mfma_f32_16x16x32_bf16 v[28:31], a[64:67], v[56:59], v[28:31]
    v_mfma_f32_16x16x32_bf16 v[32:35], a[68:71], v[56:59], v[32:35]
    ds_write_b128 v104, v[12:15] offset:2048
    v_mfma_f32_16x16x32_bf16 v[36:39], a[72:75], v[56:59], v[36:39]
    v_mfma_f32_16x16x32_bf16 v[40:43], a[76:79], v[56:59], v[40:43]
    buffer_load_dwordx4 v[56:59], v102, s[8:11], s75 offen sc1
    s_waitcnt vmcnt(13)
    v_mfma_f32_16x16x32_bf16 v[24:27], a[80:83], v[60:63], v[24:27]
    v_mfma_f32_16x16x32_bf16 v[28:31], a[84:87], v[60:63], v[28:31]
    v_mfma_f32_16x16x32_bf16 v[32:35], a[88:91], v[60:63], v[32:35]
    ds_write_b128 v104, v[16:19] offset:3072
    v_mfma_f32_16x16x32_bf16 v[36:39], a[92:95], v[60:63], v[36:39]
    v_mfma_f32_16x16x32_bf16 v[40:43], a[96:99], v[60:63], v[40:43]
    buffer_load_dwordx4 v[60:63], v102, s[8:11], s76 offen sc1
    s_waitcnt vmcnt(13)
    v_mfma_f32_16x16x32_bf16 v[24:27], a[100:103], v[64:67], v[24:27]
    v_mfma_f32_16x16x32_bf16 v[28:31], a[104:107], v[64:67], v[28:31]
    v_mfma_f32_16x16x32_bf16 v[32:35], a[108:111], v[64:67], v[32:35]
    ds_write_b128 v104, v[20:23] offset:4096
    v_mfma_f32_16x16x32_bf16 v[36:39], a[112:115], v[64:67], v[36:39]
    v_mfma_f32_16x16x32_bf16 v[40:43], a[116:119], v[64:67], v[40:43]
    buffer_load_dwordx4 v[64:67], v102, s[8:11], s77 offen sc1
    s_waitcnt vmcnt(13)
    v_mfma_f32_16x16x32_bf16 v[24:27], a[120:123], v[68:71], v[24:27]
    v_mfma_f32_16x16x32_bf16 v[28:31], a[124:127], v[68:71], v[28:31]
    v_mfma_f32_16x16x32_bf16 v[32:35], a[128:131], v[68:71], v[32:35]
    v_mfma_f32_16x16x32_bf16 v[36:39], a[132:135], v[68:71], v[36:39]
    v_mfma_f32_16x16x32_bf16 v[40:43], a[136:139], v[68:71], v[40:43]
    buffer_load_dwordx4 v[68:71], v102, s[8:11], s78 offen sc1
    s_waitcnt lgkmcnt(0)
    s_barrier
    s_waitcnt vmcnt(13)
    v_mfma_f32_16x16x32_bf16 v[24:27], a[140:143], v[72:75], v[24:27]
    ds_read_b128 v[128:131], v107 offset:0
    v_mfma_f32_16x16x32_bf16 v[28:31], a[144:147], v[72:75], v[28:31]
    ds_read_b128 v[132:135], v107 offset:1024
    v_mfma_f32_16x16x32_bf16 v[32:35], a[148:151], v[72:75], v[32:35]
    ds_read_b128 v[136:139], v107 offset:2048
    v_mfma_f32_16x16x32_bf16 v[36:39], a[152:155], v[72:75], v[36:39]
    ds_read_b128 v[140:143], v107 offset:3072
    v_mfma_f32_16x16x32_bf16 v[40:43], a[156:159], v[72:75], v[40:43]
    ds_read_b128 v[144:147], v107 offset:4096
    buffer_load_dwordx4 v[72:75], v102, s[8:11], s79 offen sc1
    s_waitcnt vmcnt(13)
    v_mfma_f32_16x16x32_bf16 v[24:27], a[160:163], v[76:79], v[24:27]
    v_mfma_f32_16x16x32_bf16 v[28:31], a[164:167], v[76:79], v[28:31]
    v_mfma_f32_16x16x32_bf16 v[32:35], a[168:171], v[76:79], v[32:35]
    v_mfma_f32_16x16x32_bf16 v[36:39], a[172:175], v[76:79], v[36:39]
    v_mfma_f32_16x16x32_bf16 v[40:43], a[176:179], v[76:79], v[40:43]
    buffer_load_dwordx4 v[76:79], v102, s[8:11], s80 offen sc1
    s_waitcnt vmcnt(13)
    v_mfma_f32_16x16x32_bf16 v[24:27], a[180:183], v[80:83], v[24:27]
    v_mfma_f32_16x16x32_bf16 v[28:31], a[184:187], v[80:83], v[28:31]
    v_mfma_f32_16x16x32_bf16 v[32:35], a[188:191], v[80:83], v[32:35]
    v_mfma_f32_16x16x32_bf16 v[36:39], a[192:195], v[80:83], v[36:39]
    v_mfma_f32_16x16x32_bf16 v[40:43], a[196:199], v[80:83], v[40:43]
    buffer_load_dwordx4 v[80:83], v102, s[8:11], s81 offen sc1
    s_waitcnt vmcnt(13)
    v_mfma_f32_16x16x32_bf16 v[24:27], a[200:203], v[84:87], v[24:27]
    v_mfma_f32_16x16x32_bf16 v[28:31], a[204:207], v[84:87], v[28:31]
    v_mfma_f32_16x16x32_bf16 v[32:35], a[208:211], v[84:87], v[32:35]
    v_mfma_f32_16x16x32_bf16 v[36:39], a[212:215], v[84:87], v[36:39]
    v_mfma_f32_16x16x32_bf16 v[40:43], a[216:219], v[84:87], v[40:43]
    buffer_load_dwordx4 v[84:87], v102, s[8:11], s82 offen sc1
    s_waitcnt lgkmcnt(0)
    s_barrier
    s_waitcnt vmcnt(13)
    v_mfma_f32_16x16x32_bf16 v[24:27], a[220:223], v[88:91], v[24:27]
    v_mfma_f32_16x16x32_bf16 v[28:31], a[224:227], v[88:91], v[28:31]
    v_mfma_f32_16x16x32_bf16 v[32:35], a[228:231], v[88:91], v[32:35]
    v_mfma_f32_16x16x32_bf16 v[36:39], a[232:235], v[88:91], v[36:39]
    v_mfma_f32_16x16x32_bf16 v[40:43], a[236:239], v[88:91], v[40:43]
    buffer_load_dwordx4 v[88:91], v102, s[8:11], s83 offen sc1
    s_waitcnt vmcnt(13)
    v_mfma_f32_16x16x32_bf16 v[24:27], a[240:243], v[92:95], v[24:27]
    v_mfma_f32_16x16x32_bf16 v[28:31], a[244:247], v[92:95], v[28:31]
    v_mfma_f32_16x16x32_bf16 v[32:35], a[248:251], v[92:95], v[32:35]
    v_mfma_f32_16x16x32_bf16 v[36:39], a[252:255], v[92:95], v[36:39]
    v_mfma_f32_16x16x32_bf16 v[40:43], v[232:235], v[92:95], v[40:43]
    buffer_load_dwordx4 v[92:95], v102, s[8:11], s84 offen sc1
    s_waitcnt vmcnt(13)
    v_mfma_f32_16x16x32_bf16 v[24:27], v[236:239], v[96:99], v[24:27]
    v_mfma_f32_16x16x32_bf16 v[28:31], v[240:243], v[96:99], v[28:31]
    v_mfma_f32_16x16x32_bf16 v[32:35], v[244:247], v[96:99], v[32:35]
    v_mfma_f32_16x16x32_bf16 v[36:39], v[248:251], v[96:99], v[36:39]
    v_mfma_f32_16x16x32_bf16 v[40:43], v[252:255], v[96:99], v[40:43]
    buffer_load_dwordx4 v[96:99], v102, s[8:11], s85 offen sc1
    s_waitcnt vmcnt(13)
    v_mfma_f32_16x16x32_bf16 v[4:7], a[0:3], v[44:47], 0
    v_mfma_f32_16x16x32_bf16 v[8:11], a[4:7], v[44:47], 0
    v_mfma_f32_16x16x32_bf16 v[12:15], a[8:11], v[44:47], 0
    v_mfma_f32_16x16x32_bf16 v[16:19], a[12:15], v[44:47], 0
    v_mfma_f32_16x16x32_bf16 v[20:23], a[16:19], v[44:47], 0
    buffer_load_dwordx4 v[44:47], v103, s[8:11], s72 offen sc1
    s_waitcnt vmcnt(13)
    v_mfma_f32_16x16x32_bf16 v[4:7], a[20:23], v[48:51], v[4:7]
    v_mfma_f32_16x16x32_bf16 v[8:11], a[24:27], v[48:51], v[8:11]
    v_mfma_f32_16x16x32_bf16 v[12:15], a[28:31], v[48:51], v[12:15]
    ds_write_b128 v105, v[24:27] offset:0
    v_mfma_f32_16x16x32_bf16 v[16:19], a[32:35], v[48:51], v[16:19]
    v_mfma_f32_16x16x32_bf16 v[20:23], a[36:39], v[48:51], v[20:23]
    buffer_load_dwordx4 v[48:51], v103, s[8:11], s73 offen sc1
    s_waitcnt vmcnt(13)
    v_mfma_f32_16x16x32_bf16 v[4:7], a[40:43], v[52:55], v[4:7]
    v_mfma_f32_16x16x32_bf16 v[8:11], a[44:47], v[52:55], v[8:11]
    v_mfma_f32_16x16x32_bf16 v[12:15], a[48:51], v[52:55], v[12:15]
    ds_write_b128 v105, v[28:31] offset:1024
    v_mfma_f32_16x16x32_bf16 v[16:19], a[52:55], v[52:55], v[16:19]
    v_mfma_f32_16x16x32_bf16 v[20:23], a[56:59], v[52:55], v[20:23]
    buffer_load_dwordx4 v[52:55], v103, s[8:11], s74 offen sc1
    s_waitcnt vmcnt(13)
    v_mfma_f32_16x16x32_bf16 v[4:7], a[60:63], v[56:59], v[4:7]
    v_mfma_f32_16x16x32_bf16 v[8:11], a[64:67], v[56:59], v[8:11]
    v_mfma_f32_16x16x32_bf16 v[12:15], a[68:71], v[56:59], v[12:15]
    ds_write_b128 v105, v[32:35] offset:2048
    v_mfma_f32_16x16x32_bf16 v[16:19], a[72:75], v[56:59], v[16:19]
    v_mfma_f32_16x16x32_bf16 v[20:23], a[76:79], v[56:59], v[20:23]
    buffer_load_dwordx4 v[56:59], v103, s[8:11], s75 offen sc1
    s_waitcnt vmcnt(13)
    v_mfma_f32_16x16x32_bf16 v[4:7], a[80:83], v[60:63], v[4:7]
    v_mfma_f32_16x16x32_bf16 v[8:11], a[84:87], v[60:63], v[8:11]
    v_mfma_f32_16x16x32_bf16 v[12:15], a[88:91], v[60:63], v[12:15]
    ds_write_b128 v105, v[36:39] offset:3072
    v_mfma_f32_16x16x32_bf16 v[16:19], a[92:95], v[60:63], v[16:19]
    v_mfma_f32_16x16x32_bf16 v[20:23], a[96:99], v[60:63], v[20:23]
    buffer_load_dwordx4 v[60:63], v103, s[8:11], s76 offen sc1
    s_waitcnt vmcnt(13)
    v_mfma_f32_16x16x32_bf16 v[4:7], a[100:103], v[64:67], v[4:7]
    v_mfma_f32_16x16x32_bf16 v[8:11], a[104:107], v[64:67], v[8:11]
    v_mfma_f32_16x16x32_bf16 v[12:15], a[108:111], v[64:67], v[12:15]
    ds_write_b128 v105, v[40:43] offset:4096
    v_mfma_f32_16x16x32_bf16 v[16:19], a[112:115], v[64:67], v[16:19]
    v_mfma_f32_16x16x32_bf16 v[20:23], a[116:119], v[64:67], v[20:23]
    buffer_load_dwordx4 v[64:67], v103, s[8:11], s77 offen sc1
    s_waitcnt vmcnt(13)
    v_mfma_f32_16x16x32_bf16 v[4:7], a[120:123], v[68:71], v[4:7]
    v_mfma_f32_16x16x32_bf16 v[8:11], a[124:127], v[68:71], v[8:11]
    v_mfma_f32_16x16x32_bf16 v[12:15], a[128:131], v[68:71], v[12:15]
    v_mfma_f32_16x16x32_bf16 v[16:19], a[132:135], v[68:71], v[16:19]
    v_mfma_f32_16x16x32_bf16 v[20:23], a[136:139], v[68:71], v[20:23]
    buffer_load_dwordx4 v[68:71], v103, s[8:11], s78 offen sc1
    s_waitcnt lgkmcnt(0)
    s_barrier
    s_waitcnt vmcnt(13)
    v_mfma_f32_16x16x32_bf16 v[4:7], a[140:143], v[72:75], v[4:7]
    ds_read_b128 v[108:111], v107 offset:0
    v_mfma_f32_16x16x32_bf16 v[8:11], a[144:147], v[72:75], v[8:11]
    ds_read_b128 v[112:115], v107 offset:1024
    v_mfma_f32_16x16x32_bf16 v[12:15], a[148:151], v[72:75], v[12:15]
    ds_read_b128 v[116:119], v107 offset:2048
    v_mfma_f32_16x16x32_bf16 v[16:19], a[152:155], v[72:75], v[16:19]
    ds_read_b128 v[120:123], v107 offset:3072
    v_mfma_f32_16x16x32_bf16 v[20:23], a[156:159], v[72:75], v[20:23]
    ds_read_b128 v[124:127], v107 offset:4096
    buffer_load_dwordx4 v[72:75], v103, s[8:11], s79 offen sc1
    s_waitcnt vmcnt(13)
    v_mfma_f32_16x16x32_bf16 v[4:7], a[160:163], v[76:79], v[4:7]
    v_mfma_f32_16x16x32_bf16 v[8:11], a[164:167], v[76:79], v[8:11]
    v_mfma_f32_16x16x32_bf16 v[12:15], a[168:171], v[76:79], v[12:15]
    v_mfma_f32_16x16x32_bf16 v[16:19], a[172:175], v[76:79], v[16:19]
    v_mfma_f32_16x16x32_bf16 v[20:23], a[176:179], v[76:79], v[20:23]
    buffer_load_dwordx4 v[76:79], v103, s[8:11], s80 offen sc1
    s_waitcnt vmcnt(13)
    v_mfma_f32_16x16x32_bf16 v[4:7], a[180:183], v[80:83], v[4:7]
    v_mfma_f32_16x16x32_bf16 v[8:11], a[184:187], v[80:83], v[8:11]
    v_mfma_f32_16x16x32_bf16 v[12:15], a[188:191], v[80:83], v[12:15]
    v_mfma_f32_16x16x32_bf16 v[16:19], a[192:195], v[80:83], v[16:19]
    v_mfma_f32_16x16x32_bf16 v[20:23], a[196:199], v[80:83], v[20:23]
    buffer_load_dwordx4 v[80:83], v103, s[8:11], s81 offen sc1
    s_waitcnt vmcnt(13)
    v_mfma_f32_16x16x32_bf16 v[4:7], a[200:203], v[84:87], v[4:7]
    v_mfma_f32_16x16x32_bf16 v[8:11], a[204:207], v[84:87], v[8:11]
    v_mfma_f32_16x16x32_bf16 v[12:15], a[208:211], v[84:87], v[12:15]
    v_mfma_f32_16x16x32_bf16 v[16:19], a[212:215], v[84:87], v[16:19]
    v_mfma_f32_16x16x32_bf16 v[20:23], a[216:219], v[84:87], v[20:23]
    buffer_load_dwordx4 v[84:87], v103, s[8:11], s82 offen sc1
    s_waitcnt lgkmcnt(0)
    s_barrier
    s_waitcnt vmcnt(13)
    v_mfma_f32_16x16x32_bf16 v[4:7], a[220:223], v[88:91], v[4:7]
    v_add_f32 v128, v128, v108
    v_add_f32 v129, v129, v109
    v_mfma_f32_16x16x32_bf16 v[8:11], a[224:227], v[88:91], v[8:11]
    v_add_f32 v130, v130, v110
    v_add_f32 v131, v131, v111
    v_mfma_f32_16x16x32_bf16 v[12:15], a[228:231], v[88:91], v[12:15]
    v_add_f32 v132, v132, v112
    v_add_f32 v133, v133, v113
    v_mfma_f32_16x16x32_bf16 v[16:19], a[232:235], v[88:91], v[16:19]
    v_add_f32 v134, v134, v114
    v_add_f32 v135, v135, v115
    v_mfma_f32_16x16x32_bf16 v[20:23], a[236:239], v[88:91], v[20:23]
    v_add_f32 v136, v136, v116
    v_add_f32 v137, v137, v117
    buffer_load_dwordx4 v[88:91], v103, s[8:11], s83 offen sc1
    s_waitcnt vmcnt(13)
    v_mfma_f32_16x16x32_bf16 v[4:7], a[240:243], v[92:95], v[4:7]
    v_add_f32 v138, v138, v118
    v_add_f32 v139, v139, v119
    v_mfma_f32_16x16x32_bf16 v[8:11], a[244:247], v[92:95], v[8:11]
    v_add_f32 v140, v140, v120
    v_add_f32 v141, v141, v121
    v_mfma_f32_16x16x32_bf16 v[12:15], a[248:251], v[92:95], v[12:15]
    v_add_f32 v142, v142, v122
    v_add_f32 v143, v143, v123
    v_mfma_f32_16x16x32_bf16 v[16:19], a[252:255], v[92:95], v[16:19]
    v_add_f32 v144, v144, v124
    v_add_f32 v145, v145, v125
    v_mfma_f32_16x16x32_bf16 v[20:23], v[232:235], v[92:95], v[20:23]
    v_add_f32 v146, v146, v126
    v_add_f32 v147, v147, v127
    buffer_load_dwordx4 v[92:95], v103, s[8:11], s84 offen sc1
    s_waitcnt vmcnt(13)
    v_mfma_f32_16x16x32_bf16 v[4:7], v[236:239], v[96:99], v[4:7]
    v_mfma_f32_16x16x32_bf16 v[8:11], v[240:243], v[96:99], v[8:11]
    v_mfma_f32_16x16x32_bf16 v[12:15], v[244:247], v[96:99], v[12:15]
    v_mfma_f32_16x16x32_bf16 v[16:19], v[248:251], v[96:99], v[16:19]
    v_mfma_f32_16x16x32_bf16 v[20:23], v[252:255], v[96:99], v[20:23]
    buffer_load_dwordx4 v[96:99], v103, s[8:11], s85 offen sc1
    s_waitcnt vmcnt(13)
    v_mfma_f32_16x16x32_bf16 v[24:27], a[0:3], v[44:47], 0
    v_mfma_f32_16x16x32_bf16 v[28:31], a[4:7], v[44:47], 0
    v_mfma_f32_16x16x32_bf16 v[32:35], a[8:11], v[44:47], 0
    v_mfma_f32_16x16x32_bf16 v[36:39], a[12:15], v[44:47], 0
    v_mfma_f32_16x16x32_bf16 v[40:43], a[16:19], v[44:47], 0
    s_waitcnt vmcnt(12)
    v_mfma_f32_16x16x32_bf16 v[24:27], a[20:23], v[48:51], v[24:27]
    v_mfma_f32_16x16x32_bf16 v[28:31], a[24:27], v[48:51], v[28:31]
    v_mfma_f32_16x16x32_bf16 v[32:35], a[28:31], v[48:51], v[32:35]
    ds_write_b128 v106, v[4:7] offset:0
    v_mfma_f32_16x16x32_bf16 v[36:39], a[32:35], v[48:51], v[36:39]
    v_mfma_f32_16x16x32_bf16 v[40:43], a[36:39], v[48:51], v[40:43]
    s_waitcnt vmcnt(11)
    v_mfma_f32_16x16x32_bf16 v[24:27], a[40:43], v[52:55], v[24:27]
    v_mfma_f32_16x16x32_bf16 v[28:31], a[44:47], v[52:55], v[28:31]
    v_mfma_f32_16x16x32_bf16 v[32:35], a[48:51], v[52:55], v[32:35]
    ds_write_b128 v106, v[8:11] offset:1024
    v_mfma_f32_16x16x32_bf16 v[36:39], a[52:55], v[52:55], v[36:39]
    v_mfma_f32_16x16x32_bf16 v[40:43], a[56:59], v[52:55], v[40:43]
    s_waitcnt vmcnt(10)
    v_mfma_f32_16x16x32_bf16 v[24:27], a[60:63], v[56:59], v[24:27]
    v_mfma_f32_16x16x32_bf16 v[28:31], a[64:67], v[56:59], v[28:31]
    v_mfma_f32_16x16x32_bf16 v[32:35], a[68:71], v[56:59], v[32:35]
    ds_write_b128 v106, v[12:15] offset:2048
    v_mfma_f32_16x16x32_bf16 v[36:39], a[72:75], v[56:59], v[36:39]
    v_mfma_f32_16x16x32_bf16 v[40:43], a[76:79], v[56:59], v[40:43]
    s_waitcnt vmcnt(9)
    v_mfma_f32_16x16x32_bf16 v[24:27], a[80:83], v[60:63], v[24:27]
    v_mfma_f32_16x16x32_bf16 v[28:31], a[84:87], v[60:63], v[28:31]
    v_mfma_f32_16x16x32_bf16 v[32:35], a[88:91], v[60:63], v[32:35]
    ds_write_b128 v106, v[16:19] offset:3072
    v_mfma_f32_16x16x32_bf16 v[36:39], a[92:95], v[60:63], v[36:39]
    v_mfma_f32_16x16x32_bf16 v[40:43], a[96:99], v[60:63], v[40:43]
    s_waitcnt vmcnt(8)
    v_mfma_f32_16x16x32_bf16 v[24:27], a[100:103], v[64:67], v[24:27]
    v_mfma_f32_16x16x32_bf16 v[28:31], a[104:107], v[64:67], v[28:31]
    v_mfma_f32_16x16x32_bf16 v[32:35], a[108:111], v[64:67], v[32:35]
    ds_write_b128 v106, v[20:23] offset:4096
    v_mfma_f32_16x16x32_bf16 v[36:39], a[112:115], v[64:67], v[36:39]
    v_mfma_f32_16x16x32_bf16 v[40:43], a[116:119], v[64:67], v[40:43]
    s_waitcnt vmcnt(7)
    v_mfma_f32_16x16x32_bf16 v[24:27], a[120:123], v[68:71], v[24:27]
    v_mfma_f32_16x16x32_bf16 v[28:31], a[124:127], v[68:71], v[28:31]
    v_mfma_f32_16x16x32_bf16 v[32:35], a[128:131], v[68:71], v[32:35]
    v_mfma_f32_16x16x32_bf16 v[36:39], a[132:135], v[68:71], v[36:39]
    v_mfma_f32_16x16x32_bf16 v[40:43], a[136:139], v[68:71], v[40:43]
    s_waitcnt lgkmcnt(0)
    s_barrier
    s_waitcnt vmcnt(6)
    v_mfma_f32_16x16x32_bf16 v[24:27], a[140:143], v[72:75], v[24:27]
    ds_read_b128 v[108:111], v107 offset:0
    v_mfma_f32_16x16x32_bf16 v[28:31], a[144:147], v[72:75], v[28:31]
    ds_read_b128 v[112:115], v107 offset:1024
    v_mfma_f32_16x16x32_bf16 v[32:35], a[148:151], v[72:75], v[32:35]
    ds_read_b128 v[116:119], v107 offset:2048
    v_mfma_f32_16x16x32_bf16 v[36:39], a[152:155], v[72:75], v[36:39]
    ds_read_b128 v[120:123], v107 offset:3072
    v_mfma_f32_16x16x32_bf16 v[40:43], a[156:159], v[72:75], v[40:43]
    ds_read_b128 v[124:127], v107 offset:4096
    s_waitcnt vmcnt(5)
    v_mfma_f32_16x16x32_bf16 v[24:27], a[160:163], v[76:79], v[24:27]
    v_mfma_f32_16x16x32_bf16 v[28:31], a[164:167], v[76:79], v[28:31]
    v_mfma_f32_16x16x32_bf16 v[32:35], a[168:171], v[76:79], v[32:35]
    v_mfma_f32_16x16x32_bf16 v[36:39], a[172:175], v[76:79], v[36:39]
    v_mfma_f32_16x16x32_bf16 v[40:43], a[176:179], v[76:79], v[40:43]
    s_waitcnt vmcnt(4)
    v_mfma_f32_16x16x32_bf16 v[24:27], a[180:183], v[80:83], v[24:27]
    v_mfma_f32_16x16x32_bf16 v[28:31], a[184:187], v[80:83], v[28:31]
    v_mfma_f32_16x16x32_bf16 v[32:35], a[188:191], v[80:83], v[32:35]
    v_mfma_f32_16x16x32_bf16 v[36:39], a[192:195], v[80:83], v[36:39]
    v_mfma_f32_16x16x32_bf16 v[40:43], a[196:199], v[80:83], v[40:43]
    s_waitcnt vmcnt(3)
    v_mfma_f32_16x16x32_bf16 v[24:27], a[200:203], v[84:87], v[24:27]
    v_mfma_f32_16x16x32_bf16 v[28:31], a[204:207], v[84:87], v[28:31]
    v_mfma_f32_16x16x32_bf16 v[32:35], a[208:211], v[84:87], v[32:35]
    v_mfma_f32_16x16x32_bf16 v[36:39], a[212:215], v[84:87], v[36:39]
    v_mfma_f32_16x16x32_bf16 v[40:43], a[216:219], v[84:87], v[40:43]
    s_waitcnt lgkmcnt(0)
    s_barrier
    s_waitcnt vmcnt(2)
    v_mfma_f32_16x16x32_bf16 v[24:27], a[220:223], v[88:91], v[24:27]
    v_add_f32 v128, v128, v108
    v_add_f32 v129, v129, v109
    v_mfma_f32_16x16x32_bf16 v[28:31], a[224:227], v[88:91], v[28:31]
    v_add_f32 v130, v130, v110
    v_add_f32 v131, v131, v111
    v_mfma_f32_16x16x32_bf16 v[32:35], a[228:231], v[88:91], v[32:35]
    v_add_f32 v132, v132, v112
    v_add_f32 v133, v133, v113
    v_mfma_f32_16x16x32_bf16 v[36:39], a[232:235], v[88:91], v[36:39]
    v_add_f32 v134, v134, v114
    v_add_f32 v135, v135, v115
    v_mfma_f32_16x16x32_bf16 v[40:43], a[236:239], v[88:91], v[40:43]
    v_add_f32 v136, v136, v116
    v_add_f32 v137, v137, v117
    s_waitcnt vmcnt(1)
    v_mfma_f32_16x16x32_bf16 v[24:27], a[240:243], v[92:95], v[24:27]
    v_add_f32 v138, v138, v118
    v_add_f32 v139, v139, v119
    v_mfma_f32_16x16x32_bf16 v[28:31], a[244:247], v[92:95], v[28:31]
    v_add_f32 v140, v140, v120
    v_add_f32 v141, v141, v121
    v_mfma_f32_16x16x32_bf16 v[32:35], a[248:251], v[92:95], v[32:35]
    v_add_f32 v142, v142, v122
    v_add_f32 v143, v143, v123
    v_mfma_f32_16x16x32_bf16 v[36:39], a[252:255], v[92:95], v[36:39]
    v_add_f32 v144, v144, v124
    v_add_f32 v145, v145, v125
    v_mfma_f32_16x16x32_bf16 v[40:43], v[232:235], v[92:95], v[40:43]
    v_add_f32 v146, v146, v126
    v_add_f32 v147, v147, v127
    s_waitcnt vmcnt(0)
    v_mfma_f32_16x16x32_bf16 v[24:27], v[236:239], v[96:99], v[24:27]
    v_mfma_f32_16x16x32_bf16 v[28:31], v[240:243], v[96:99], v[28:31]
    v_mfma_f32_16x16x32_bf16 v[32:35], v[244:247], v[96:99], v[32:35]
    v_mfma_f32_16x16x32_bf16 v[36:39], v[248:251], v[96:99], v[36:39]
    v_mfma_f32_16x16x32_bf16 v[40:43], v[252:255], v[96:99], v[40:43]
    s_nop 3
    v_pk_add_f32 v[128:129], v[128:129], v[24:25]
    v_pk_add_f32 v[130:131], v[130:131], v[26:27]
    v_pk_add_f32 v[132:133], v[132:133], v[28:29]
    v_pk_add_f32 v[134:135], v[134:135], v[30:31]
    v_pk_add_f32 v[136:137], v[136:137], v[32:33]
    v_pk_add_f32 v[138:139], v[138:139], v[34:35]
    v_pk_add_f32 v[140:141], v[140:141], v[36:37]
    v_pk_add_f32 v[142:143], v[142:143], v[38:39]
    v_pk_add_f32 v[144:145], v[144:145], v[40:41]
    v_pk_add_f32 v[146:147], v[146:147], v[42:43]
    v_cvt_pk_bf16_f32 v180, v128, v129
    v_lshlrev_b32 v128, 16, v180
    v_and_b32 v129, s45, v180
    v_pk_add_f32 v[150:151], v[150:151], v[128:129]
    v_cvt_pk_bf16_f32 v222, v150, v151
    v_cvt_pk_bf16_f32 v181, v130, v131
    v_lshlrev_b32 v130, 16, v181
    v_and_b32 v131, s45, v181
    v_pk_add_f32 v[152:153], v[152:153], v[130:131]
    v_cvt_pk_bf16_f32 v223, v152, v153
    v_cvt_pk_bf16_f32 v180, v132, v133
    v_lshlrev_b32 v132, 16, v180
    v_and_b32 v133, s45, v180
    v_pk_add_f32 v[154:155], v[154:155], v[132:133]
    v_cvt_pk_bf16_f32 v224, v154, v155
    v_cvt_pk_bf16_f32 v181, v134, v135
    v_lshlrev_b32 v134, 16, v181
    v_and_b32 v135, s45, v181
    v_pk_add_f32 v[156:157], v[156:157], v[134:135]
    v_cvt_pk_bf16_f32 v225, v156, v157
    v_cvt_pk_bf16_f32 v180, v136, v137
    v_lshlrev_b32 v136, 16, v180
    v_and_b32 v137, s45, v180
    v_pk_add_f32 v[158:159], v[158:159], v[136:137]
    v_cvt_pk_bf16_f32 v226, v158, v159
    v_cvt_pk_bf16_f32 v181, v138, v139
    v_lshlrev_b32 v138, 16, v181
    v_and_b32 v139, s45, v181
    v_pk_add_f32 v[160:161], v[160:161], v[138:139]
    v_cvt_pk_bf16_f32 v227, v160, v161
    v_cvt_pk_bf16_f32 v180, v140, v141
    v_lshlrev_b32 v140, 16, v180
    v_and_b32 v141, s45, v180
    v_pk_add_f32 v[162:163], v[162:163], v[140:141]
    v_cvt_pk_bf16_f32 v228, v162, v163
    v_cvt_pk_bf16_f32 v181, v142, v143
    v_lshlrev_b32 v142, 16, v181
    v_and_b32 v143, s45, v181
    v_pk_add_f32 v[164:165], v[164:165], v[142:143]
    v_cvt_pk_bf16_f32 v229, v164, v165
    v_cvt_pk_bf16_f32 v180, v144, v145
    v_lshlrev_b32 v144, 16, v180
    v_and_b32 v145, s45, v180
    v_pk_add_f32 v[166:167], v[166:167], v[144:145]
    v_cvt_pk_bf16_f32 v230, v166, v167
    v_cvt_pk_bf16_f32 v181, v146, v147
    v_lshlrev_b32 v146, 16, v181
    v_and_b32 v147, s45, v181
    v_pk_add_f32 v[168:169], v[168:169], v[146:147]
    v_cvt_pk_bf16_f32 v231, v168, v169
    global_store_dwordx2 v170, v[222:223], s[34:35] offset:0
    global_store_dwordx2 v170, v[224:225], s[34:35] offset:32
    global_store_dwordx2 v170, v[226:227], s[34:35] offset:64
    global_store_dwordx2 v170, v[228:229], s[34:35] offset:96
    global_store_dwordx2 v170, v[230:231], s[34:35] offset:128
    s_add_u32 s3, s2, s6
    s_cmp_lg_u32 s3, 0
    s_cbranch_scc1 L_ep_105
    s_sub_u32 s3, s28, 0x9e3779b9
    s_add_u32 s3, s3, 16
    v_mov_b32 v176, s3
    v_mov_b32 v177, 0
    s_mov_b64 s[92:93], exec
    s_mov_b64 exec, 1
    global_store_dword v177, v176, s[38:39] sc0 sc1
    s_mov_b64 exec, s[92:93]
L_ep_105:
    s_waitcnt vmcnt(0)
    s_waitcnt vmcnt(0)
    s_branch L_end
L_g1epi:
    v_add_u32 v80, 55296, v182
    s_and_b32 s3, s44, 1
    s_lshl_b32 s51, s7, 1
    s_or_b32 s3, s3, s51
    s_cmp_eq_u32 s3, 1
    s_cbranch_scc1 L_he_108
    s_cmp_eq_u32 s3, 2
    s_cbranch_scc1 L_he_109
    s_cmp_eq_u32 s3, 3
    s_cbranch_scc1 L_he_110
    v_pk_fma_f32 v[4:5], v[184:185], v[164:165], v[4:5] op_sel_hi:[1,0,1] neg_lo:[0,1,0] neg_hi:[0,1,0]
    v_pk_mul_f32 v[4:5], v[4:5], v[164:165] op_sel:[0,1] op_sel_hi:[1,1]
    v_cvt_pk_bf16_f32 v100, v4, v5
    v_pk_max_i16 v100, v100, 0
    v_pk_fma_f32 v[6:7], v[186:187], v[164:165], v[6:7] op_sel_hi:[1,0,1] neg_lo:[0,1,0] neg_hi:[0,1,0]
    v_pk_mul_f32 v[6:7], v[6:7], v[164:165] op_sel:[0,1] op_sel_hi:[1,1]
    v_cvt_pk_bf16_f32 v101, v6, v7
    v_pk_max_i16 v101, v101, 0
    v_pk_fma_f32 v[8:9], v[188:189], v[164:165], v[8:9] op_sel_hi:[1,0,1] neg_lo:[0,1,0] neg_hi:[0,1,0]
    v_pk_mul_f32 v[8:9], v[8:9], v[164:165] op_sel:[0,1] op_sel_hi:[1,1]
    v_cvt_pk_bf16_f32 v102, v8, v9
    v_pk_max_i16 v102, v102, 0
    v_pk_fma_f32 v[10:11], v[190:191], v[164:165], v[10:11] op_sel_hi:[1,0,1] neg_lo:[0,1,0] neg_hi:[0,1,0]
    v_pk_mul_f32 v[10:11], v[10:11], v[164:165] op_sel:[0,1] op_sel_hi:[1,1]
    v_cvt_pk_bf16_f32 v103, v10, v11
    v_pk_max_i16 v103, v103, 0
    global_store_dwordx4 v182, v[100:103], s[72:73]
    v_pk_fma_f32 v[12:13], v[192:193], v[164:165], v[12:13] op_sel_hi:[1,0,1] neg_lo:[0,1,0] neg_hi:[0,1,0]
    v_pk_mul_f32 v[12:13], v[12:13], v[164:165] op_sel:[0,1] op_sel_hi:[1,1]
    v_cvt_pk_bf16_f32 v104, v12, v13
    v_pk_max_i16 v104, v104, 0
    v_pk_fma_f32 v[14:15], v[194:195], v[164:165], v[14:15] op_sel_hi:[1,0,1] neg_lo:[0,1,0] neg_hi:[0,1,0]
    v_pk_mul_f32 v[14:15], v[14:15], v[164:165] op_sel:[0,1] op_sel_hi:[1,1]
    v_cvt_pk_bf16_f32 v105, v14, v15
    v_pk_max_i16 v105, v105, 0
    v_pk_fma_f32 v[16:17], v[196:197], v[164:165], v[16:17] op_sel_hi:[1,0,1] neg_lo:[0,1,0] neg_hi:[0,1,0]
    v_pk_mul_f32 v[16:17], v[16:17], v[164:165] op_sel:[0,1] op_sel_hi:[1,1]
    v_cvt_pk_bf16_f32 v106, v16, v17
    v_pk_max_i16 v106, v106, 0
    v_pk_fma_f32 v[18:19], v[198:199], v[164:165], v[18:19] op_sel_hi:[1,0,1] neg_lo:[0,1,0] neg_hi:[0,1,0]
    v_pk_mul_f32 v[18:19], v[18:19], v[164:165] op_sel:[0,1] op_sel_hi:[1,1]
    v_cvt_pk_bf16_f32 v107, v18, v19
    v_pk_max_i16 v107, v107, 0
    global_store_dwordx4 v182, v[104:107], s[76:77]
    v_pk_fma_f32 v[20:21], v[200:201], v[164:165], v[20:21] op_sel_hi:[1,0,1] neg_lo:[0,1,0] neg_hi:[0,1,0]
    v_pk_mul_f32 v[20:21], v[20:21], v[164:165] op_sel:[0,1] op_sel_hi:[1,1]
    v_cvt_pk_bf16_f32 v108, v20, v21
    v_pk_max_i16 v108, v108, 0
    v_pk_fma_f32 v[22:23], v[202:203], v[164:165], v[22:23] op_sel_hi:[1,0,1] neg_lo:[0,1,0] neg_hi:[0,1,0]
    v_pk_mul_f32 v[22:23], v[22:23], v[164:165] op_sel:[0,1] op_sel_hi:[1,1]
    v_cvt_pk_bf16_f32 v109, v22, v23
    v_pk_max_i16 v109, v109, 0
    v_pk_fma_f32 v[24:25], v[204:205], v[164:165], v[24:25] op_sel_hi:[1,0,1] neg_lo:[0,1,0] neg_hi:[0,1,0]
    v_pk_mul_f32 v[24:25], v[24:25], v[164:165] op_sel:[0,1] op_sel_hi:[1,1]
    v_cvt_pk_bf16_f32 v110, v24, v25
    v_pk_max_i16 v110, v110, 0
    v_pk_fma_f32 v[26:27], v[206:207], v[164:165], v[26:27] op_sel_hi:[1,0,1] neg_lo:[0,1,0] neg_hi:[0,1,0]
    v_pk_mul_f32 v[26:27], v[26:27], v[164:165] op_sel:[0,1] op_sel_hi:[1,1]
    v_cvt_pk_bf16_f32 v111, v26, v27
    v_pk_max_i16 v111, v111, 0
    global_store_dwordx4 v182, v[108:111], s[80:81]
    v_pk_fma_f32 v[28:29], v[208:209], v[164:165], v[28:29] op_sel_hi:[1,0,1] neg_lo:[0,1,0] neg_hi:[0,1,0]
    v_pk_mul_f32 v[28:29], v[28:29], v[164:165] op_sel:[0,1] op_sel_hi:[1,1]
    v_cvt_pk_bf16_f32 v112, v28, v29
    v_pk_max_i16 v112, v112, 0
    v_pk_fma_f32 v[30:31], v[210:211], v[164:165], v[30:31] op_sel_hi:[1,0,1] neg_lo:[0,1,0] neg_hi:[0,1,0]
    v_pk_mul_f32 v[30:31], v[30:31], v[164:165] op_sel:[0,1] op_sel_hi:[1,1]
    v_cvt_pk_bf16_f32 v113, v30, v31
    v_pk_max_i16 v113, v113, 0
    global_store_dwordx2 v182, v[112:113], s[84:85]
    v_pk_fma_f32 v[32:33], v[184:185], v[166:167], v[32:33] op_sel_hi:[1,0,1] neg_lo:[0,1,0] neg_hi:[0,1,0]
    v_pk_mul_f32 v[32:33], v[32:33], v[166:167] op_sel:[0,1] op_sel_hi:[1,1]
    v_cvt_pk_bf16_f32 v114, v32, v33
    v_pk_max_i16 v114, v114, 0
    v_pk_fma_f32 v[34:35], v[186:187], v[166:167], v[34:35] op_sel_hi:[1,0,1] neg_lo:[0,1,0] neg_hi:[0,1,0]
    v_pk_mul_f32 v[34:35], v[34:35], v[166:167] op_sel:[0,1] op_sel_hi:[1,1]
    v_cvt_pk_bf16_f32 v115, v34, v35
    v_pk_max_i16 v115, v115, 0
    v_pk_fma_f32 v[36:37], v[188:189], v[166:167], v[36:37] op_sel_hi:[1,0,1] neg_lo:[0,1,0] neg_hi:[0,1,0]
    v_pk_mul_f32 v[36:37], v[36:37], v[166:167] op_sel:[0,1] op_sel_hi:[1,1]
    v_cvt_pk_bf16_f32 v116, v36, v37
    v_pk_max_i16 v116, v116, 0
    v_pk_fma_f32 v[38:39], v[190:191], v[166:167], v[38:39] op_sel_hi:[1,0,1] neg_lo:[0,1,0] neg_hi:[0,1,0]
    v_pk_mul_f32 v[38:39], v[38:39], v[166:167] op_sel:[0,1] op_sel_hi:[1,1]
    v_cvt_pk_bf16_f32 v117, v38, v39
    v_pk_max_i16 v117, v117, 0
    global_store_dwordx4 v80, v[114:117], s[72:73]
    v_pk_fma_f32 v[40:41], v[192:193], v[166:167], v[40:41] op_sel_hi:[1,0,1] neg_lo:[0,1,0] neg_hi:[0,1,0]
    v_pk_mul_f32 v[40:41], v[40:41], v[166:167] op_sel:[0,1] op_sel_hi:[1,1]
    v_cvt_pk_bf16_f32 v118, v40, v41
    v_pk_max_i16 v118, v118, 0
    v_pk_fma_f32 v[42:43], v[194:195], v[166:167], v[42:43] op_sel_hi:[1,0,1] neg_lo:[0,1,0] neg_hi:[0,1,0]
    v_pk_mul_f32 v[42:43], v[42:43], v[166:167] op_sel:[0,1] op_sel_hi:[1,1]
    v_cvt_pk_bf16_f32 v119, v42, v43
    v_pk_max_i16 v119, v119, 0
    v_pk_fma_f32 v[44:45], v[196:197], v[166:167], v[44:45] op_sel_hi:[1,0,1] neg_lo:[0,1,0] neg_hi:[0,1,0]
    v_pk_mul_f32 v[44:45], v[44:45], v[166:167] op_sel:[0,1] op_sel_hi:[1,1]
    v_cvt_pk_bf16_f32 v120, v44, v45
    v_pk_max_i16 v120, v120, 0
    v_pk_fma_f32 v[46:47], v[198:199], v[166:167], v[46:47] op_sel_hi:[1,0,1] neg_lo:[0,1,0] neg_hi:[0,1,0]
    v_pk_mul_f32 v[46:47], v[46:47], v[166:167] op_sel:[0,1] op_sel_hi:[1,1]
    v_cvt_pk_bf16_f32 v121, v46, v47
    v_pk_max_i16 v121, v121, 0
    global_store_dwordx4 v80, v[118:121], s[76:77]
    v_pk_fma_f32 v[48:49], v[200:201], v[166:167], v[48:49] op_sel_hi:[1,0,1] neg_lo:[0,1,0] neg_hi:[0,1,0]
    v_pk_mul_f32 v[48:49], v[48:49], v[166:167] op_sel:[0,1] op_sel_hi:[1,1]
    v_cvt_pk_bf16_f32 v122, v48, v49
    v_pk_max_i16 v122, v122, 0
    v_pk_fma_f32 v[50:51], v[202:203], v[166:167], v[50:51] op_sel_hi:[1,0,1] neg_lo:[0,1,0] neg_hi:[0,1,0]
    v_pk_mul_f32 v[50:51], v[50:51], v[166:167] op_sel:[0,1] op_sel_hi:[1,1]
    v_cvt_pk_bf16_f32 v123, v50, v51
    v_pk_max_i16 v123, v123, 0
    v_pk_fma_f32 v[52:53], v[204:205], v[166:167], v[52:53] op_sel_hi:[1,0,1] neg_lo:[0,1,0] neg_hi:[0,1,0]
    v_pk_mul_f32 v[52:53], v[52:53], v[166:167] op_sel:[0,1] op_sel_hi:[1,1]
    v_cvt_pk_bf16_f32 v124, v52, v53
    v_pk_max_i16 v124, v124, 0
    v_pk_fma_f32 v[54:55], v[206:207], v[166:167], v[54:55] op_sel_hi:[1,0,1] neg_lo:[0,1,0] neg_hi:[0,1,0]
    v_pk_mul_f32 v[54:55], v[54:55], v[166:167] op_sel:[0,1] op_sel_hi:[1,1]
    v_cvt_pk_bf16_f32 v125, v54, v55
    v_pk_max_i16 v125, v125, 0
    global_store_dwordx4 v80, v[122:125], s[80:81]
    v_pk_fma_f32 v[56:57], v[208:209], v[166:167], v[56:57] op_sel_hi:[1,0,1] neg_lo:[0,1,0] neg_hi:[0,1,0]
    v_pk_mul_f32 v[56:57], v[56:57], v[166:167] op_sel:[0,1] op_sel_hi:[1,1]
    v_cvt_pk_bf16_f32 v126, v56, v57
    v_pk_max_i16 v126, v126, 0
    v_pk_fma_f32 v[58:59], v[210:211], v[166:167], v[58:59] op_sel_hi:[1,0,1] neg_lo:[0,1,0] neg_hi:[0,1,0]
    v_pk_mul_f32 v[58:59], v[58:59], v[166:167] op_sel:[0,1] op_sel_hi:[1,1]
    v_cvt_pk_bf16_f32 v127, v58, v59
    v_pk_max_i16 v127, v127, 0
    global_store_dwordx2 v80, v[126:127], s[84:85]
    s_nop 0
    s_branch L_hd_106
L_he_108:
    v_pk_fma_f32 v[4:5], v[184:185], v[164:165], v[4:5] op_sel_hi:[1,0,1] neg_lo:[0,1,0] neg_hi:[0,1,0]
    v_pk_mul_f32 v[4:5], v[4:5], v[164:165] op_sel:[0,1] op_sel_hi:[1,1]
    v_cvt_pk_bf16_f32 v100, v4, v5
    v_pk_max_i16 v100, v100, 0
    v_pk_fma_f32 v[6:7], v[186:187], v[164:165], v[6:7] op_sel_hi:[1,0,1] neg_lo:[0,1,0] neg_hi:[0,1,0]
    v_pk_mul_f32 v[6:7], v[6:7], v[164:165] op_sel:[0,1] op_sel_hi:[1,1]
    v_cvt_pk_bf16_f32 v101, v6, v7
    v_pk_max_i16 v101, v101, 0
    global_store_dwordx2 v182, v[100:101], s[72:73]
    v_pk_fma_f32 v[8:9], v[188:189], v[164:165], v[8:9] op_sel_hi:[1,0,1] neg_lo:[0,1,0] neg_hi:[0,1,0]
    v_pk_mul_f32 v[8:9], v[8:9], v[164:165] op_sel:[0,1] op_sel_hi:[1,1]
    v_cvt_pk_bf16_f32 v102, v8, v9
    v_pk_max_i16 v102, v102, 0
    v_pk_fma_f32 v[10:11], v[190:191], v[164:165], v[10:11] op_sel_hi:[1,0,1] neg_lo:[0,1,0] neg_hi:[0,1,0]
    v_pk_mul_f32 v[10:11], v[10:11], v[164:165] op_sel:[0,1] op_sel_hi:[1,1]
    v_cvt_pk_bf16_f32 v103, v10, v11
    v_pk_max_i16 v103, v103, 0
    v_pk_fma_f32 v[12:13], v[192:193], v[164:165], v[12:13] op_sel_hi:[1,0,1] neg_lo:[0,1,0] neg_hi:[0,1,0]
    v_pk_mul_f32 v[12:13], v[12:13], v[164:165] op_sel:[0,1] op_sel_hi:[1,1]
    v_cvt_pk_bf16_f32 v104, v12, v13
    v_pk_max_i16 v104, v104, 0
    v_pk_fma_f32 v[14:15], v[194:195], v[164:165], v[14:15] op_sel_hi:[1,0,1] neg_lo:[0,1,0] neg_hi:[0,1,0]
    v_pk_mul_f32 v[14:15], v[14:15], v[164:165] op_sel:[0,1] op_sel_hi:[1,1]
    v_cvt_pk_bf16_f32 v105, v14, v15
    v_pk_max_i16 v105, v105, 0
    global_store_dwordx4 v182, v[102:105], s[74:75]
    v_pk_fma_f32 v[16:17], v[196:197], v[164:165], v[16:17] op_sel_hi:[1,0,1] neg_lo:[0,1,0] neg_hi:[0,1,0]
    v_pk_mul_f32 v[16:17], v[16:17], v[164:165] op_sel:[0,1] op_sel_hi:[1,1]
    v_cvt_pk_bf16_f32 v106, v16, v17
    v_pk_max_i16 v106, v106, 0
    v_pk_fma_f32 v[18:19], v[198:199], v[164:165], v[18:19] op_sel_hi:[1,0,1] neg_lo:[0,1,0] neg_hi:[0,1,0]
    v_pk_mul_f32 v[18:19], v[18:19], v[164:165] op_sel:[0,1] op_sel_hi:[1,1]
    v_cvt_pk_bf16_f32 v107, v18, v19
    v_pk_max_i16 v107, v107, 0
    v_pk_fma_f32 v[20:21], v[200:201], v[164:165], v[20:21] op_sel_hi:[1,0,1] neg_lo:[0,1,0] neg_hi:[0,1,0]
    v_pk_mul_f32 v[20:21], v[20:21], v[164:165] op_sel:[0,1] op_sel_hi:[1,1]
    v_cvt_pk_bf16_f32 v108, v20, v21
    v_pk_max_i16 v108, v108, 0
    v_pk_fma_f32 v[22:23], v[202:203], v[164:165], v[22:23] op_sel_hi:[1,0,1] neg_lo:[0,1,0] neg_hi:[0,1,0]
    v_pk_mul_f32 v[22:23], v[22:23], v[164:165] op_sel:[0,1] op_sel_hi:[1,1]
    v_cvt_pk_bf16_f32 v109, v22, v23
    v_pk_max_i16 v109, v109, 0
    global_store_dwordx4 v182, v[106:109], s[78:79]
    v_pk_fma_f32 v[24:25], v[204:205], v[164:165], v[24:25] op_sel_hi:[1,0,1] neg_lo:[0,1,0] neg_hi:[0,1,0]
    v_pk_mul_f32 v[24:25], v[24:25], v[164:165] op_sel:[0,1] op_sel_hi:[1,1]
    v_cvt_pk_bf16_f32 v110, v24, v25
    v_pk_max_i16 v110, v110, 0
    v_pk_fma_f32 v[26:27], v[206:207], v[164:165], v[26:27] op_sel_hi:[1,0,1] neg_lo:[0,1,0] neg_hi:[0,1,0]
    v_pk_mul_f32 v[26:27], v[26:27], v[164:165] op_sel:[0,1] op_sel_hi:[1,1]
    v_cvt_pk_bf16_f32 v111, v26, v27
    v_pk_max_i16 v111, v111, 0
    v_pk_fma_f32 v[28:29], v[208:209], v[164:165], v[28:29] op_sel_hi:[1,0,1] neg_lo:[0,1,0] neg_hi:[0,1,0]
    v_pk_mul_f32 v[28:29], v[28:29], v[164:165] op_sel:[0,1] op_sel_hi:[1,1]
    v_cvt_pk_bf16_f32 v112, v28, v29
    v_pk_max_i16 v112, v112, 0
    v_pk_fma_f32 v[30:31], v[210:211], v[164:165], v[30:31] op_sel_hi:[1,0,1] neg_lo:[0,1,0] neg_hi:[0,1,0]
    v_pk_mul_f32 v[30:31], v[30:31], v[164:165] op_sel:[0,1] op_sel_hi:[1,1]
    v_cvt_pk_bf16_f32 v113, v30, v31
    v_pk_max_i16 v113, v113, 0
    global_store_dwordx4 v182, v[110:113], s[82:83]
    v_pk_fma_f32 v[32:33], v[184:185], v[166:167], v[32:33] op_sel_hi:[1,0,1] neg_lo:[0,1,0] neg_hi:[0,1,0]
    v_pk_mul_f32 v[32:33], v[32:33], v[166:167] op_sel:[0,1] op_sel_hi:[1,1]
    v_cvt_pk_bf16_f32 v114, v32, v33
    v_pk_max_i16 v114, v114, 0
    v_pk_fma_f32 v[34:35], v[186:187], v[166:167], v[34:35] op_sel_hi:[1,0,1] neg_lo:[0,1,0] neg_hi:[0,1,0]
    v_pk_mul_f32 v[34:35], v[34:35], v[166:167] op_sel:[0,1] op_sel_hi:[1,1]
    v_cvt_pk_bf16_f32 v115, v34, v35
    v_pk_max_i16 v115, v115, 0
    global_store_dwordx2 v80, v[114:115], s[72:73]
    v_pk_fma_f32 v[36:37], v[188:189], v[166:167], v[36:37] op_sel_hi:[1,0,1] neg_lo:[0,1,0] neg_hi:[0,1,0]
    v_pk_mul_f32 v[36:37], v[36:37], v[166:167] op_sel:[0,1] op_sel_hi:[1,1]
    v_cvt_pk_bf16_f32 v116, v36, v37
    v_pk_max_i16 v116, v116, 0
    v_pk_fma_f32 v[38:39], v[190:191], v[166:167], v[38:39] op_sel_hi:[1,0,1] neg_lo:[0,1,0] neg_hi:[0,1,0]
    v_pk_mul_f32 v[38:39], v[38:39], v[166:167] op_sel:[0,1] op_sel_hi:[1,1]
    v_cvt_pk_bf16_f32 v117, v38, v39
    v_pk_max_i16 v117, v117, 0
    v_pk_fma_f32 v[40:41], v[192:193], v[166:167], v[40:41] op_sel_hi:[1,0,1] neg_lo:[0,1,0] neg_hi:[0,1,0]
    v_pk_mul_f32 v[40:41], v[40:41], v[166:167] op_sel:[0,1] op_sel_hi:[1,1]
    v_cvt_pk_bf16_f32 v118, v40, v41
    v_pk_max_i16 v118, v118, 0
    v_pk_fma_f32 v[42:43], v[194:195], v[166:167], v[42:43] op_sel_hi:[1,0,1] neg_lo:[0,1,0] neg_hi:[0,1,0]
    v_pk_mul_f32 v[42:43], v[42:43], v[166:167] op_sel:[0,1] op_sel_hi:[1,1]
    v_cvt_pk_bf16_f32 v119, v42, v43
    v_pk_max_i16 v119, v119, 0
    global_store_dwordx4 v80, v[116:119], s[74:75]
    v_pk_fma_f32 v[44:45], v[196:197], v[166:167], v[44:45] op_sel_hi:[1,0,1] neg_lo:[0,1,0] neg_hi:[0,1,0]
    v_pk_mul_f32 v[44:45], v[44:45], v[166:167] op_sel:[0,1] op_sel_hi:[1,1]
    v_cvt_pk_bf16_f32 v120, v44, v45
    v_pk_max_i16 v120, v120, 0
    v_pk_fma_f32 v[46:47], v[198:199], v[166:167], v[46:47] op_sel_hi:[1,0,1] neg_lo:[0,1,0] neg_hi:[0,1,0]
    v_pk_mul_f32 v[46:47], v[46:47], v[166:167] op_sel:[0,1] op_sel_hi:[1,1]
    v_cvt_pk_bf16_f32 v121, v46, v47
    v_pk_max_i16 v121, v121, 0
    v_pk_fma_f32 v[48:49], v[200:201], v[166:167], v[48:49] op_sel_hi:[1,0,1] neg_lo:[0,1,0] neg_hi:[0,1,0]
    v_pk_mul_f32 v[48:49], v[48:49], v[166:167] op_sel:[0,1] op_sel_hi:[1,1]
    v_cvt_pk_bf16_f32 v122, v48, v49
    v_pk_max_i16 v122, v122, 0
    v_pk_fma_f32 v[50:51], v[202:203], v[166:167], v[50:51] op_sel_hi:[1,0,1] neg_lo:[0,1,0] neg_hi:[0,1,0]
    v_pk_mul_f32 v[50:51], v[50:51], v[166:167] op_sel:[0,1] op_sel_hi:[1,1]
    v_cvt_pk_bf16_f32 v123, v50, v51
    v_pk_max_i16 v123, v123, 0
    global_store_dwordx4 v80, v[120:123], s[78:79]
    v_pk_fma_f32 v[52:53], v[204:205], v[166:167], v[52:53] op_sel_hi:[1,0,1] neg_lo:[0,1,0] neg_hi:[0,1,0]
    v_pk_mul_f32 v[52:53], v[52:53], v[166:167] op_sel:[0,1] op_sel_hi:[1,1]
    v_cvt_pk_bf16_f32 v124, v52, v53
    v_pk_max_i16 v124, v124, 0
    v_pk_fma_f32 v[54:55], v[206:207], v[166:167], v[54:55] op_sel_hi:[1,0,1] neg_lo:[0,1,0] neg_hi:[0,1,0]
    v_pk_mul_f32 v[54:55], v[54:55], v[166:167] op_sel:[0,1] op_sel_hi:[1,1]
    v_cvt_pk_bf16_f32 v125, v54, v55
    v_pk_max_i16 v125, v125, 0
    v_pk_fma_f32 v[56:57], v[208:209], v[166:167], v[56:57] op_sel_hi:[1,0,1] neg_lo:[0,1,0] neg_hi:[0,1,0]
    v_pk_mul_f32 v[56:57], v[56:57], v[166:167] op_sel:[0,1] op_sel_hi:[1,1]
    v_cvt_pk_bf16_f32 v126, v56, v57
    v_pk_max_i16 v126, v126, 0
    v_pk_fma_f32 v[58:59], v[210:211], v[166:167], v[58:59] op_sel_hi:[1,0,1] neg_lo:[0,1,0] neg_hi:[0,1,0]
    v_pk_mul_f32 v[58:59], v[58:59], v[166:167] op_sel:[0,1] op_sel_hi:[1,1]
    v_cvt_pk_bf16_f32 v127, v58, v59
    v_pk_max_i16 v127, v127, 0
    global_store_dwordx4 v80, v[124:127], s[82:83]
    s_nop 1
    s_branch L_hd_106
L_he_109:
    v_pk_fma_f32 v[4:5], v[184:185], v[164:165], v[4:5] op_sel_hi:[1,0,1] neg_lo:[0,1,0] neg_hi:[0,1,0]
    v_pk_mul_f32 v[4:5], v[4:5], v[164:165] op_sel:[0,1] op_sel_hi:[1,1]
    v_cvt_pk_bf16_f32 v100, v4, v5
    v_pk_max_i16 v100, v100, 0
    v_pk_fma_f32 v[6:7], v[186:187], v[164:165], v[6:7] op_sel_hi:[1,0,1] neg_lo:[0,1,0] neg_hi:[0,1,0]
    v_pk_mul_f32 v[6:7], v[6:7], v[164:165] op_sel:[0,1] op_sel_hi:[1,1]
    v_cvt_pk_bf16_f32 v101, v6, v7
    v_pk_max_i16 v101, v101, 0
    v_pk_fma_f32 v[8:9], v[188:189], v[164:165], v[8:9] op_sel_hi:[1,0,1] neg_lo:[0,1,0] neg_hi:[0,1,0]
    v_pk_mul_f32 v[8:9], v[8:9], v[164:165] op_sel:[0,1] op_sel_hi:[1,1]
    v_cvt_pk_bf16_f32 v102, v8, v9
    v_pk_max_i16 v102, v102, 0
    v_pk_fma_f32 v[10:11], v[190:191], v[164:165], v[10:11] op_sel_hi:[1,0,1] neg_lo:[0,1,0] neg_hi:[0,1,0]
    v_pk_mul_f32 v[10:11], v[10:11], v[164:165] op_sel:[0,1] op_sel_hi:[1,1]
    v_cvt_pk_bf16_f32 v103, v10, v11
    v_pk_max_i16 v103, v103, 0
    global_store_dwordx4 v182, v[100:103], s[72:73] sc0 sc1
    v_pk_fma_f32 v[12:13], v[192:193], v[164:165], v[12:13] op_sel_hi:[1,0,1] neg_lo:[0,1,0] neg_hi:[0,1,0]
    v_pk_mul_f32 v[12:13], v[12:13], v[164:165] op_sel:[0,1] op_sel_hi:[1,1]
    v_cvt_pk_bf16_f32 v104, v12, v13
    v_pk_max_i16 v104, v104, 0
    v_pk_fma_f32 v[14:15], v[194:195], v[164:165], v[14:15] op_sel_hi:[1,0,1] neg_lo:[0,1,0] neg_hi:[0,1,0]
    v_pk_mul_f32 v[14:15], v[14:15], v[164:165] op_sel:[0,1] op_sel_hi:[1,1]
    v_cvt_pk_bf16_f32 v105, v14, v15
    v_pk_max_i16 v105, v105, 0
    v_pk_fma_f32 v[16:17], v[196:197], v[164:165], v[16:17] op_sel_hi:[1,0,1] neg_lo:[0,1,0] neg_hi:[0,1,0]
    v_pk_mul_f32 v[16:17], v[16:17], v[164:165] op_sel:[0,1] op_sel_hi:[1,1]
    v_cvt_pk_bf16_f32 v106, v16, v17
    v_pk_max_i16 v106, v106, 0
    v_pk_fma_f32 v[18:19], v[198:199], v[164:165], v[18:19] op_sel_hi:[1,0,1] neg_lo:[0,1,0] neg_hi:[0,1,0]
    v_pk_mul_f32 v[18:19], v[18:19], v[164:165] op_sel:[0,1] op_sel_hi:[1,1]
    v_cvt_pk_bf16_f32 v107, v18, v19
    v_pk_max_i16 v107, v107, 0
    global_store_dwordx4 v182, v[104:107], s[76:77] sc0 sc1
    v_pk_fma_f32 v[20:21], v[200:201], v[164:165], v[20:21] op_sel_hi:[1,0,1] neg_lo:[0,1,0] neg_hi:[0,1,0]
    v_pk_mul_f32 v[20:21], v[20:21], v[164:165] op_sel:[0,1] op_sel_hi:[1,1]
    v_cvt_pk_bf16_f32 v108, v20, v21
    v_pk_max_i16 v108, v108, 0
    v_pk_fma_f32 v[22:23], v[202:203], v[164:165], v[22:23] op_sel_hi:[1,0,1] neg_lo:[0,1,0] neg_hi:[0,1,0]
    v_pk_mul_f32 v[22:23], v[22:23], v[164:165] op_sel:[0,1] op_sel_hi:[1,1]
    v_cvt_pk_bf16_f32 v109, v22, v23
    v_pk_max_i16 v109, v109, 0
    v_pk_fma_f32 v[24:25], v[204:205], v[164:165], v[24:25] op_sel_hi:[1,0,1] neg_lo:[0,1,0] neg_hi:[0,1,0]
    v_pk_mul_f32 v[24:25], v[24:25], v[164:165] op_sel:[0,1] op_sel_hi:[1,1]
    v_cvt_pk_bf16_f32 v110, v24, v25
    v_pk_max_i16 v110, v110, 0
    v_pk_fma_f32 v[26:27], v[206:207], v[164:165], v[26:27] op_sel_hi:[1,0,1] neg_lo:[0,1,0] neg_hi:[0,1,0]
    v_pk_mul_f32 v[26:27], v[26:27], v[164:165] op_sel:[0,1] op_sel_hi:[1,1]
    v_cvt_pk_bf16_f32 v111, v26, v27
    v_pk_max_i16 v111, v111, 0
    global_store_dwordx4 v182, v[108:111], s[80:81] sc0 sc1
    v_pk_fma_f32 v[28:29], v[208:209], v[164:165], v[28:29] op_sel_hi:[1,0,1] neg_lo:[0,1,0] neg_hi:[0,1,0]
    v_pk_mul_f32 v[28:29], v[28:29], v[164:165] op_sel:[0,1] op_sel_hi:[1,1]
    v_cvt_pk_bf16_f32 v112, v28, v29
    v_pk_max_i16 v112, v112, 0
    v_pk_fma_f32 v[30:31], v[210:211], v[164:165], v[30:31] op_sel_hi:[1,0,1] neg_lo:[0,1,0] neg_hi:[0,1,0]
    v_pk_mul_f32 v[30:31], v[30:31], v[164:165] op_sel:[0,1] op_sel_hi:[1,1]
    v_cvt_pk_bf16_f32 v113, v30, v31
    v_pk_max_i16 v113, v113, 0
    global_store_dwordx2 v182, v[112:113], s[84:85] sc0 sc1
    v_pk_fma_f32 v[32:33], v[184:185], v[166:167], v[32:33] op_sel_hi:[1,0,1] neg_lo:[0,1,0] neg_hi:[0,1,0]
    v_pk_mul_f32 v[32:33], v[32:33], v[166:167] op_sel:[0,1] op_sel_hi:[1,1]
    v_cvt_pk_bf16_f32 v114, v32, v33
    v_pk_max_i16 v114, v114, 0
    v_pk_fma_f32 v[34:35], v[186:187], v[166:167], v[34:35] op_sel_hi:[1,0,1] neg_lo:[0,1,0] neg_hi:[0,1,0]
    v_pk_mul_f32 v[34:35], v[34:35], v[166:167] op_sel:[0,1] op_sel_hi:[1,1]
    v_cvt_pk_bf16_f32 v115, v34, v35
    v_pk_max_i16 v115, v115, 0
    v_pk_fma_f32 v[36:37], v[188:189], v[166:167], v[36:37] op_sel_hi:[1,0,1] neg_lo:[0,1,0] neg_hi:[0,1,0]
    v_pk_mul_f32 v[36:37], v[36:37], v[166:167] op_sel:[0,1] op_sel_hi:[1,1]
    v_cvt_pk_bf16_f32 v116, v36, v37
    v_pk_max_i16 v116, v116, 0
    v_pk_fma_f32 v[38:39], v[190:191], v[166:167], v[38:39] op_sel_hi:[1,0,1] neg_lo:[0,1,0] neg_hi:[0,1,0]
    v_pk_mul_f32 v[38:39], v[38:39], v[166:167] op_sel:[0,1] op_sel_hi:[1,1]
    v_cvt_pk_bf16_f32 v117, v38, v39
    v_pk_max_i16 v117, v117, 0
    global_store_dwordx4 v80, v[114:117], s[72:73] sc0 sc1
    v_pk_fma_f32 v[40:41], v[192:193], v[166:167], v[40:41] op_sel_hi:[1,0,1] neg_lo:[0,1,0] neg_hi:[0,1,0]
    v_pk_mul_f32 v[40:41], v[40:41], v[166:167] op_sel:[0,1] op_sel_hi:[1,1]
    v_cvt_pk_bf16_f32 v118, v40, v41
    v_pk_max_i16 v118, v118, 0
    v_pk_fma_f32 v[42:43], v[194:195], v[166:167], v[42:43] op_sel_hi:[1,0,1] neg_lo:[0,1,0] neg_hi:[0,1,0]
    v_pk_mul_f32 v[42:43], v[42:43], v[166:167] op_sel:[0,1] op_sel_hi:[1,1]
    v_cvt_pk_bf16_f32 v119, v42, v43
    v_pk_max_i16 v119, v119, 0
    v_pk_fma_f32 v[44:45], v[196:197], v[166:167], v[44:45] op_sel_hi:[1,0,1] neg_lo:[0,1,0] neg_hi:[0,1,0]
    v_pk_mul_f32 v[44:45], v[44:45], v[166:167] op_sel:[0,1] op_sel_hi:[1,1]
    v_cvt_pk_bf16_f32 v120, v44, v45
    v_pk_max_i16 v120, v120, 0
    v_pk_fma_f32 v[46:47], v[198:199], v[166:167], v[46:47] op_sel_hi:[1,0,1] neg_lo:[0,1,0] neg_hi:[0,1,0]
    v_pk_mul_f32 v[46:47], v[46:47], v[166:167] op_sel:[0,1] op_sel_hi:[1,1]
    v_cvt_pk_bf16_f32 v121, v46, v47
    v_pk_max_i16 v121, v121, 0
    global_store_dwordx4 v80, v[118:121], s[76:77] sc0 sc1
    v_pk_fma_f32 v[48:49], v[200:201], v[166:167], v[48:49] op_sel_hi:[1,0,1] neg_lo:[0,1,0] neg_hi:[0,1,0]
    v_pk_mul_f32 v[48:49], v[48:49], v[166:167] op_sel:[0,1] op_sel_hi:[1,1]
    v_cvt_pk_bf16_f32 v122, v48, v49
    v_pk_max_i16 v122, v122, 0
    v_pk_fma_f32 v[50:51], v[202:203], v[166:167], v[50:51] op_sel_hi:[1,0,1] neg_lo:[0,1,0] neg_hi:[0,1,0]
    v_pk_mul_f32 v[50:51], v[50:51], v[166:167] op_sel:[0,1] op_sel_hi:[1,1]
    v_cvt_pk_bf16_f32 v123, v50, v51
    v_pk_max_i16 v123, v123, 0
    v_pk_fma_f32 v[52:53], v[204:205], v[166:167], v[52:53] op_sel_hi:[1,0,1] neg_lo:[0,1,0] neg_hi:[0,1,0]
    v_pk_mul_f32 v[52:53], v[52:53], v[166:167] op_sel:[0,1] op_sel_hi:[1,1]
    v_cvt_pk_bf16_f32 v124, v52, v53
    v_pk_max_i16 v124, v124, 0
    v_pk_fma_f32 v[54:55], v[206:207], v[166:167], v[54:55] op_sel_hi:[1,0,1] neg_lo:[0,1,0] neg_hi:[0,1,0]
    v_pk_mul_f32 v[54:55], v[54:55], v[166:167] op_sel:[0,1] op_sel_hi:[1,1]
    v_cvt_pk_bf16_f32 v125, v54, v55
    v_pk_max_i16 v125, v125, 0
    global_store_dwordx4 v80, v[122:125], s[80:81] sc0 sc1
    v_pk_fma_f32 v[56:57], v[208:209], v[166:167], v[56:57] op_sel_hi:[1,0,1] neg_lo:[0,1,0] neg_hi:[0,1,0]
    v_pk_mul_f32 v[56:57], v[56:57], v[166:167] op_sel:[0,1] op_sel_hi:[1,1]
    v_cvt_pk_bf16_f32 v126, v56, v57
    v_pk_max_i16 v126, v126, 0
    v_pk_fma_f32 v[58:59], v[210:211], v[166:167], v[58:59] op_sel_hi:[1,0,1] neg_lo:[0,1,0] neg_hi:[0,1,0]
    v_pk_mul_f32 v[58:59], v[58:59], v[166:167] op_sel:[0,1] op_sel_hi:[1,1]
    v_cvt_pk_bf16_f32 v127, v58, v59
    v_pk_max_i16 v127, v127, 0
    global_store_dwordx2 v80, v[126:127], s[84:85] sc0 sc1
    s_nop 0
    s_branch L_hd_106
L_he_110:
    v_pk_fma_f32 v[4:5], v[184:185], v[164:165], v[4:5] op_sel_hi:[1,0,1] neg_lo:[0,1,0] neg_hi:[0,1,0]
    v_pk_mul_f32 v[4:5], v[4:5], v[164:165] op_sel:[0,1] op_sel_hi:[1,1]
    v_cvt_pk_bf16_f32 v100, v4, v5
    v_pk_max_i16 v100, v100, 0
    v_pk_fma_f32 v[6:7], v[186:187], v[164:165], v[6:7] op_sel_hi:[1,0,1] neg_lo:[0,1,0] neg_hi:[0,1,0]
    v_pk_mul_f32 v[6:7], v[6:7], v[164:165] op_sel:[0,1] op_sel_hi:[1,1]
    v_cvt_pk_bf16_f32 v101, v6, v7
    v_pk_max_i16 v101, v101, 0
    global_store_dwordx2 v182, v[100:101], s[72:73] sc0 sc1
    v_pk_fma_f32 v[8:9], v[188:189], v[164:165], v[8:9] op_sel_hi:[1,0,1] neg_lo:[0,1,0] neg_hi:[0,1,0]
    v_pk_mul_f32 v[8:9], v[8:9], v[164:165] op_sel:[0,1] op_sel_hi:[1,1]
    v_cvt_pk_bf16_f32 v102, v8, v9
    v_pk_max_i16 v102, v102, 0
    v_pk_fma_f32 v[10:11], v[190:191], v[164:165], v[10:11] op_sel_hi:[1,0,1] neg_lo:[0,1,0] neg_hi:[0,1,0]
    v_pk_mul_f32 v[10:11], v[10:11], v[164:165] op_sel:[0,1] op_sel_hi:[1,1]
    v_cvt_pk_bf16_f32 v103, v10, v11
    v_pk_max_i16 v103, v103, 0
    v_pk_fma_f32 v[12:13], v[192:193], v[164:165], v[12:13] op_sel_hi:[1,0,1] neg_lo:[0,1,0] neg_hi:[0,1,0]
    v_pk_mul_f32 v[12:13], v[12:13], v[164:165] op_sel:[0,1] op_sel_hi:[1,1]
    v_cvt_pk_bf16_f32 v104, v12, v13
    v_pk_max_i16 v104, v104, 0
    v_pk_fma_f32 v[14:15], v[194:195], v[164:165], v[14:15] op_sel_hi:[1,0,1] neg_lo:[0,1,0] neg_hi:[0,1,0]
    v_pk_mul_f32 v[14:15], v[14:15], v[164:165] op_sel:[0,1] op_sel_hi:[1,1]
    v_cvt_pk_bf16_f32 v105, v14, v15
    v_pk_max_i16 v105, v105, 0
    global_store_dwordx4 v182, v[102:105], s[74:75] sc0 sc1
    v_pk_fma_f32 v[16:17], v[196:197], v[164:165], v[16:17] op_sel_hi:[1,0,1] neg_lo:[0,1,0] neg_hi:[0,1,0]
    v_pk_mul_f32 v[16:17], v[16:17], v[164:165] op_sel:[0,1] op_sel_hi:[1,1]
    v_cvt_pk_bf16_f32 v106, v16, v17
    v_pk_max_i16 v106, v106, 0
    v_pk_fma_f32 v[18:19], v[198:199], v[164:165], v[18:19] op_sel_hi:[1,0,1] neg_lo:[0,1,0] neg_hi:[0,1,0]
    v_pk_mul_f32 v[18:19], v[18:19], v[164:165] op_sel:[0,1] op_sel_hi:[1,1]
    v_cvt_pk_bf16_f32 v107, v18, v19
    v_pk_max_i16 v107, v107, 0
    v_pk_fma_f32 v[20:21], v[200:201], v[164:165], v[20:21] op_sel_hi:[1,0,1] neg_lo:[0,1,0] neg_hi:[0,1,0]
    v_pk_mul_f32 v[20:21], v[20:21], v[164:165] op_sel:[0,1] op_sel_hi:[1,1]
    v_cvt_pk_bf16_f32 v108, v20, v21
    v_pk_max_i16 v108, v108, 0
    v_pk_fma_f32 v[22:23], v[202:203], v[164:165], v[22:23] op_sel_hi:[1,0,1] neg_lo:[0,1,0] neg_hi:[0,1,0]
    v_pk_mul_f32 v[22:23], v[22:23], v[164:165] op_sel:[0,1] op_sel_hi:[1,1]
    v_cvt_pk_bf16_f32 v109, v22, v23
    v_pk_max_i16 v109, v109, 0
    global_store_dwordx4 v182, v[106:109], s[78:79] sc0 sc1
    v_pk_fma_f32 v[24:25], v[204:205], v[164:165], v[24:25] op_sel_hi:[1,0,1] neg_lo:[0,1,0] neg_hi:[0,1,0]
    v_pk_mul_f32 v[24:25], v[24:25], v[164:165] op_sel:[0,1] op_sel_hi:[1,1]
    v_cvt_pk_bf16_f32 v110, v24, v25
    v_pk_max_i16 v110, v110, 0
    v_pk_fma_f32 v[26:27], v[206:207], v[164:165], v[26:27] op_sel_hi:[1,0,1] neg_lo:[0,1,0] neg_hi:[0,1,0]
    v_pk_mul_f32 v[26:27], v[26:27], v[164:165] op_sel:[0,1] op_sel_hi:[1,1]
    v_cvt_pk_bf16_f32 v111, v26, v27
    v_pk_max_i16 v111, v111, 0
    v_pk_fma_f32 v[28:29], v[208:209], v[164:165], v[28:29] op_sel_hi:[1,0,1] neg_lo:[0,1,0] neg_hi:[0,1,0]
    v_pk_mul_f32 v[28:29], v[28:29], v[164:165] op_sel:[0,1] op_sel_hi:[1,1]
    v_cvt_pk_bf16_f32 v112, v28, v29
    v_pk_max_i16 v112, v112, 0
    v_pk_fma_f32 v[30:31], v[210:211], v[164:165], v[30:31] op_sel_hi:[1,0,1] neg_lo:[0,1,0] neg_hi:[0,1,0]
    v_pk_mul_f32 v[30:31], v[30:31], v[164:165] op_sel:[0,1] op_sel_hi:[1,1]
    v_cvt_pk_bf16_f32 v113, v30, v31
    v_pk_max_i16 v113, v113, 0
    global_store_dwordx4 v182, v[110:113], s[82:83] sc0 sc1
    v_pk_fma_f32 v[32:33], v[184:185], v[166:167], v[32:33] op_sel_hi:[1,0,1] neg_lo:[0,1,0] neg_hi:[0,1,0]
    v_pk_mul_f32 v[32:33], v[32:33], v[166:167] op_sel:[0,1] op_sel_hi:[1,1]
    v_cvt_pk_bf16_f32 v114, v32, v33
    v_pk_max_i16 v114, v114, 0
    v_pk_fma_f32 v[34:35], v[186:187], v[166:167], v[34:35] op_sel_hi:[1,0,1] neg_lo:[0,1,0] neg_hi:[0,1,0]
    v_pk_mul_f32 v[34:35], v[34:35], v[166:167] op_sel:[0,1] op_sel_hi:[1,1]
    v_cvt_pk_bf16_f32 v115, v34, v35
    v_pk_max_i16 v115, v115, 0
    global_store_dwordx2 v80, v[114:115], s[72:73] sc0 sc1
    v_pk_fma_f32 v[36:37], v[188:189], v[166:167], v[36:37] op_sel_hi:[1,0,1] neg_lo:[0,1,0] neg_hi:[0,1,0]
    v_pk_mul_f32 v[36:37], v[36:37], v[166:167] op_sel:[0,1] op_sel_hi:[1,1]
    v_cvt_pk_bf16_f32 v116, v36, v37
    v_pk_max_i16 v116, v116, 0
    v_pk_fma_f32 v[38:39], v[190:191], v[166:167], v[38:39] op_sel_hi:[1,0,1] neg_lo:[0,1,0] neg_hi:[0,1,0]
    v_pk_mul_f32 v[38:39], v[38:39], v[166:167] op_sel:[0,1] op_sel_hi:[1,1]
    v_cvt_pk_bf16_f32 v117, v38, v39
    v_pk_max_i16 v117, v117, 0
    v_pk_fma_f32 v[40:41], v[192:193], v[166:167], v[40:41] op_sel_hi:[1,0,1] neg_lo:[0,1,0] neg_hi:[0,1,0]
    v_pk_mul_f32 v[40:41], v[40:41], v[166:167] op_sel:[0,1] op_sel_hi:[1,1]
    v_cvt_pk_bf16_f32 v118, v40, v41
    v_pk_max_i16 v118, v118, 0
    v_pk_fma_f32 v[42:43], v[194:195], v[166:167], v[42:43] op_sel_hi:[1,0,1] neg_lo:[0,1,0] neg_hi:[0,1,0]
    v_pk_mul_f32 v[42:43], v[42:43], v[166:167] op_sel:[0,1] op_sel_hi:[1,1]
    v_cvt_pk_bf16_f32 v119, v42, v43
    v_pk_max_i16 v119, v119, 0
    global_store_dwordx4 v80, v[116:119], s[74:75] sc0 sc1
    v_pk_fma_f32 v[44:45], v[196:197], v[166:167], v[44:45] op_sel_hi:[1,0,1] neg_lo:[0,1,0] neg_hi:[0,1,0]
    v_pk_mul_f32 v[44:45], v[44:45], v[166:167] op_sel:[0,1] op_sel_hi:[1,1]
    v_cvt_pk_bf16_f32 v120, v44, v45
    v_pk_max_i16 v120, v120, 0
    v_pk_fma_f32 v[46:47], v[198:199], v[166:167], v[46:47] op_sel_hi:[1,0,1] neg_lo:[0,1,0] neg_hi:[0,1,0]
    v_pk_mul_f32 v[46:47], v[46:47], v[166:167] op_sel:[0,1] op_sel_hi:[1,1]
    v_cvt_pk_bf16_f32 v121, v46, v47
    v_pk_max_i16 v121, v121, 0
    v_pk_fma_f32 v[48:49], v[200:201], v[166:167], v[48:49] op_sel_hi:[1,0,1] neg_lo:[0,1,0] neg_hi:[0,1,0]
    v_pk_mul_f32 v[48:49], v[48:49], v[166:167] op_sel:[0,1] op_sel_hi:[1,1]
    v_cvt_pk_bf16_f32 v122, v48, v49
    v_pk_max_i16 v122, v122, 0
    v_pk_fma_f32 v[50:51], v[202:203], v[166:167], v[50:51] op_sel_hi:[1,0,1] neg_lo:[0,1,0] neg_hi:[0,1,0]
    v_pk_mul_f32 v[50:51], v[50:51], v[166:167] op_sel:[0,1] op_sel_hi:[1,1]
    v_cvt_pk_bf16_f32 v123, v50, v51
    v_pk_max_i16 v123, v123, 0
    global_store_dwordx4 v80, v[120:123], s[78:79] sc0 sc1
    v_pk_fma_f32 v[52:53], v[204:205], v[166:167], v[52:53] op_sel_hi:[1,0,1] neg_lo:[0,1,0] neg_hi:[0,1,0]
    v_pk_mul_f32 v[52:53], v[52:53], v[166:167] op_sel:[0,1] op_sel_hi:[1,1]
    v_cvt_pk_bf16_f32 v124, v52, v53
    v_pk_max_i16 v124, v124, 0
    v_pk_fma_f32 v[54:55], v[206:207], v[166:167], v[54:55] op_sel_hi:[1,0,1] neg_lo:[0,1,0] neg_hi:[0,1,0]
    v_pk_mul_f32 v[54:55], v[54:55], v[166:167] op_sel:[0,1] op_sel_hi:[1,1]
    v_cvt_pk_bf16_f32 v125, v54, v55
    v_pk_max_i16 v125, v125, 0
    v_pk_fma_f32 v[56:57], v[208:209], v[166:167], v[56:57] op_sel_hi:[1,0,1] neg_lo:[0,1,0] neg_hi:[0,1,0]
    v_pk_mul_f32 v[56:57], v[56:57], v[166:167] op_sel:[0,1] op_sel_hi:[1,1]
    v_cvt_pk_bf16_f32 v126, v56, v57
    v_pk_max_i16 v126, v126, 0
    v_pk_fma_f32 v[58:59], v[210:211], v[166:167], v[58:59] op_sel_hi:[1,0,1] neg_lo:[0,1,0] neg_hi:[0,1,0]
    v_pk_mul_f32 v[58:59], v[58:59], v[166:167] op_sel:[0,1] op_sel_hi:[1,1]
    v_cvt_pk_bf16_f32 v127, v58, v59
    v_pk_max_i16 v127, v127, 0
    global_store_dwordx4 v80, v[124:127], s[82:83] sc0 sc1
    s_nop 1
L_hd_106:
    s_setpc_b64 s[30:31]
L_abort:
L_end:
    s_endpgm
.section .rodata,"a"
.p2align 6
.amdhsa_kernel interleave_layers__ssm_conv_h3__dense_activation_relu__prompt_kernel
  .amdhsa_next_free_vgpr 512
  .amdhsa_next_free_sgpr 102
  .amdhsa_accum_offset 256
  .amdhsa_group_segment_fixed_size 0
  .amdhsa_kernarg_size 96
  .amdhsa_user_sgpr_count 2
  .amdhsa_user_sgpr_kernarg_segment_ptr 1
  .amdhsa_system_sgpr_workgroup_id_x 1
.end_amdhsa_kernel
```
